```python
import torch

def _softmax(x, axis=-1):
    return torch.softmax(x, dim=axis)
def _gelu(x):
    return torch.nn.functional.gelu(x, approximate="tanh")
def _silu(x):
    return torch.nn.functional.silu(x)
def _sigmoid(x):
    return torch.sigmoid(x)
def _layernorm(x, axis=-1, eps=1e-5):
    m = x.mean(dim=axis, keepdim=True)
    v = x.var(dim=axis, keepdim=True, unbiased=False)
    return (x - m) / torch.sqrt(v + eps)
def _scatter_add(tgt, idx, src, axis=0):
    return tgt.clone().index_add_(axis, idx, src)
def _segment_sum(src, seg, n):
    out = torch.zeros((n,) + src.shape[1:], dtype=src.dtype)
    return out.index_add_(0, seg, src)
def _pad(x, pw):
    flat = tuple(v for pair in reversed(pw) for v in pair)
    return torch.nn.functional.pad(x, flat)

kernel_name = 'sequential_preLN__sliding_block__moe_arch_mod__prompt'

def setup_inputs():

    _w = (lambda a: (lambda t: t.to(torch.bfloat16) if t.is_floating_point() else t)(torch.as_tensor(a)))
    def _A_setup():
        B, S, D = 1, 2048, 640
        return {
            "x": _w((lambda *s: torch.randn(*s, dtype=torch.bfloat16) * 0.05)(B, S, D)),
            "wqkv": _w((lambda *s: torch.randn(*s, dtype=torch.bfloat16) * 0.05)(D, 3 * D)),
            "wo": _w((lambda *s: torch.randn(*s, dtype=torch.bfloat16) * 0.05)(D, D)),
        }
    _A_in = _A_setup()

    def _B_setup():
        B, S, D, F, C = 1, 2048, 640, 1536, 8
        return {
            "x": _w((lambda *s: torch.randn(*s, dtype=torch.bfloat16) * 0.05)(B, S, D)),
            "w_r": _w((lambda *s: torch.randn(*s, dtype=torch.bfloat16) * 0.05)(D)),
            "w_gate": _w((lambda *s: torch.randn(*s, dtype=torch.bfloat16) * 0.05)(D, F)),
            "w_up": _w((lambda *s: torch.randn(*s, dtype=torch.bfloat16) * 0.05)(D, F)),
            "w_down": _w((lambda *s: torch.randn(*s, dtype=torch.bfloat16) * 0.05)(F, D)),
        }
    _B_in = _B_setup()

    return {
        "A_x": _A_in["x"],
        "A_wqkv": _A_in["wqkv"],
        "A_wo": _A_in["wo"],
        "B_x": _B_in["x"],
        "B_w_r": _B_in["w_r"],
        "B_w_gate": _B_in["w_gate"],
        "B_w_up": _B_in["w_up"],
        "B_w_down": _B_in["w_down"],
    }

def reference(A_x, A_wqkv, A_wo, B_x, B_w_r, B_w_gate, B_w_up, B_w_down):
    def _A_ref(x, wqkv, wo):
        B, S, D = x.shape
        H = 32; Dh = D // H; W = 256
        qkv = (lambda x, *d: x.permute(*d))((x @ wqkv).reshape(B, S, 3, H, Dh), 2, 0, 3, 1, 4)
        q, k, v = qkv[0], qkv[1], qkv[2]
        scores = torch.einsum("bhqd,bhkd->bhqk", q, k) * (Dh ** -0.5)
        idx = torch.arange(S)
        mask = (idx[:, None] - idx[None, :] >= 0) & (idx[:, None] - idx[None, :] < W)
        scores = torch.where(mask[None, None], scores, -1e9)
        p = _softmax(scores, axis=-1)
        o = torch.einsum("bhqk,bhkd->bhqd", p, v)
        return (lambda x, *d: x.permute(*d))(o, 0, 2, 1, 3).reshape(B, S, D) @ wo

    def _B_ref(x, w_r, w_gate, w_up, w_down):
        B, S, D = x.shape
        C = 8
        r = x @ w_r
        idx = torch.argsort(-r, axis=-1)[:, :C]
        idx_e = (lambda x, n, axis: torch.repeat_interleave(x, n, dim=axis))(idx.reshape(B, C, 1), D, axis=2)
        x_sel = (lambda x, i, axis: torch.take_along_dim(x, i, dim=axis))(x, idx_e, axis=1)
        g = _silu(x_sel @ w_gate)
        u = x_sel @ w_up
        y = (g * u) @ w_down
        r_sel = _sigmoid((lambda x, i, axis: torch.take_along_dim(x, i, dim=axis))(r, idx, axis=1))
        y = y * r_sel.reshape(B, C, 1)
        b_off = (torch.arange(B) * S).reshape(B, 1)
        flat_idx = (idx + b_off).reshape(B * C)
        zero = (x * 0.0).reshape(B * S, D)
        upd = _scatter_add(zero, flat_idx, y.reshape(B * C, D), axis=0)
        return x + upd.reshape(B, S, D)

    x = A_x
    h = x + _A_ref(_layernorm(x, axis=-1), A_wqkv, A_wo)
    h2 = h + _B_ref(_layernorm(h, axis=-1), B_w_r, B_w_gate, B_w_up, B_w_down)
    return h2
```

```asm
; @launch grid=(256,1,1) block=(512,1,1) lds=163840
.amdgcn_target "amdgcn-amd-amdhsa--gfx950"
.text
.globl sequential_preLN__sliding_block__moe_arch_mod__prompt_kernel
.p2align 12

.p2align 8
.type sequential_preLN__sliding_block__moe_arch_mod__prompt_kernel,@function
sequential_preLN__sliding_block__moe_arch_mod__prompt_kernel:
  s_cmp_ge_u32 s2, 256
  s_cbranch_scc1 L_exit
  s_load_dwordx2 s[4:5], s[0:1], 0
  s_load_dwordx2 s[8:9], s[0:1], 8
  s_load_dwordx2 s[32:33], s[0:1], 80
  v_lshrrev_b32 v1, 6, v0
  v_and_b32 v0, 63, v0
  v_readfirstlane_b32 s44, v1
  s_and_b32 s45, s2, 7
  s_lshr_b32 s46, s2, 3
  s_lshr_b32 s47, s45, 1
  s_and_b32 s48, s45, 1
  s_and_b32 s49, s46, 3
  s_lshr_b32 s50, s46, 2
  s_lshl_b32 s3, s47, 2
  s_add_u32 s3, s3, s49
  s_cmp_gt_u32 s50, 2
  s_subb_u32 s3, s3, 0
  s_and_b32 s3, s3, 15
  s_cmp_lt_u32 s44, 4
  s_cbranch_scc0 L_help
  s_getpc_b64 s[72:73]
L_pc0:
  s_lshl_b32 s74, s44, 3
  s_lshr_b32 s74, ((((sequential_preLN__sliding_block__moe_arch_mod__prompt_kernel+0x400-L_pc0)>>8)&0xff)<<0)|((((L_comp-L_pc0)>>8)&0xff)<<8)|((((L_comp+0x1000-L_pc0)>>8)&0xff)<<16)|((((sequential_preLN__sliding_block__moe_arch_mod__prompt_kernel+0x1400-L_pc0)>>8)&0xff)<<24), s74
  s_and_b32 s74, s74, 0xff
  s_and_b32 s75, s46, 3
  s_lshl_b32 s74, s74, 8
  s_mul_i32 s75, s75, 1024
  s_and_b32 s72, s72, 0xffffff80
  s_add_u32 s74, s74, s75
  v_lshl_add_u32 v1, v0, 7, s74
  s_mov_b64 exec, 0xff
  global_load_dwordx2 v[228:229], v1, s[72:73] offset:60
  s_lshl_b32 s74, s46, 2
  s_add_u32 s74, s74, s44
  s_mul_i32 s74, s74, 512
  s_add_u32 s74, s74, (sequential_preLN__sliding_block__moe_arch_mod__prompt_kernel+0x2400-L_pc0)&0xffffff00
  s_min_u32 s74, s74, (L_exit-L_pc0-512)&0xffffff80
  s_mov_b64 exec, 15
  v_lshl_add_u32 v1, v0, 7, s74
  global_load_dwordx2 v[194:195], v1, s[72:73] offset:60
  s_mov_b64 exec, -1
  s_branch L_comp
L_help:
  s_sub_u32 s54, s44, 4
  s_lshl_b32 s61, s50, 1
  s_cmp_gt_u32 s50, 2
  s_subb_u32 s61, s61, 0
  s_cmp_lg_u32 s50, 2
  s_addc_u32 s62, s61, 0
  s_mul_i32 s72, s61, 52
  s_lshr_b32 s72, s72, 8
  s_add_u32 s72, s72, s48
  s_mul_i32 s72, s72, 640
  s_lshl_b32 s55, s61, 7
  s_add_u32 s55, s55, s72
  s_mul_i32 s72, s62, 52
  s_lshr_b32 s72, s72, 8
  s_add_u32 s72, s72, s48
  s_mul_i32 s72, s72, 640
  s_lshl_b32 s56, s62, 7
  s_add_u32 s56, s56, s72
  v_lshrrev_b32 v10, 3, v0
  v_mul_u32_u24 v2, 1280, v10
  v_lshrrev_b32 v11, 4, v0
  v_and_b32 v12, 7, v0
  v_xor_b32 v12, v12, v11
  v_lshl_add_u32 v2, v12, 4, v2
  v_xor_b32 v3, 64, v2
  v_add_u32 v3, 9216, v3
  v_add_u32 v4, 9216, v3
  v_add_u32 v5, 27648, v2
  v_lshlrev_b32 v12, 2, v11
  v_and_b32 v13, 15, v0
  v_xor_b32 v12, v12, v13
  v_cmp_lt_u32 vcc, 7, v12
  v_mov_b32 v13, s55
  v_mov_b32 v14, s56
  v_cndmask_b32 v13, v13, v14, vcc
  v_and_b32 v12, 7, v12
  v_lshl_add_u32 v13, v12, 4, v13
  v_mul_u32_u24 v6, 3840, v11
  v_add_u32 v6, v6, v13
  v_add_u32 v7, 14336, v6
  v_add_u32 v8, 28672, v6
  v_add_u32 v9, 43008, v6
  v_xor_b32 v8, 32, v8
  v_xor_b32 v9, 32, v9
  s_and_b32 s61, s3, 3
  s_lshl_b32 s61, s61, 2
  s_lshr_b32 s57, 21760, s61
  s_and_b32 s57, s57, 15
  s_lshl_b32 s61, s50, 2
  s_lshr_b32 s61, 0x85749063, s61
  s_and_b32 s61, s61, 15
  s_add_u32 s57, s57, s61
  s_lshr_b32 s61, s3, 2
  s_lshl_b32 s61, s61, 1
  s_add_u32 s61, s61, s48
  s_lshl_b32 s61, s61, 2
  s_lshr_b32 s61, 0x83726150, s61
  s_and_b32 s63, s61, 15
  s_add_u32 s57, s57, s63
  s_mul_i32 s61, s57, 205
  s_lshr_b32 s61, s61, 11
  s_mul_i32 s61, s61, 10
  s_sub_u32 s57, s57, s61
  s_lshl_b32 s61, s3, 2
  s_add_u32 s61, s61, s54
  s_mul_i32 s58, s61, 40960
  s_mul_i32 s59, s54, 61440
  s_lshl_b32 s60, s54, 12
  s_mov_b32 s64, s57
  s_mov_b32 s6, 2621440
  s_mov_b32 s7, 0x20000
  s_mov_b32 s10, 2457600
  s_mov_b32 s11, 0x20000
  s_mov_b32 s53, 19406848
  s_waitcnt lgkmcnt(0)
  s_load_dword s52, s[32:33], s53
  s_lshl_b32 s61, s57, 7
  s_add_u32 m0, s60, 0
  s_add_u32 s61, s61, s58
  buffer_load_dwordx4 v2, s[4:7], s61 offen offset:0  lds
  buffer_load_dwordx4 v3, s[4:7], s61 offen offset:1024  lds
  buffer_load_dwordx4 v4, s[4:7], s61 offen offset:2048  lds
  buffer_load_dwordx4 v5, s[4:7], s61 offen offset:3072  lds
  s_add_u32 s57, s57, 1
  s_cmp_eq_u32 s57, 10
  s_cselect_b32 s57, 0, s57
  s_mul_i32 s61, s64, 245760
  s_add_u32 m0, s60, 16384
  s_add_u32 s61, s61, s59
  buffer_load_dwordx4 v6, s[8:11], s61 offen offset:0  lds
  buffer_load_dwordx4 v7, s[8:11], s61 offen offset:1024  lds
  buffer_load_dwordx4 v8, s[8:11], s61 offen offset:2048  lds
  buffer_load_dwordx4 v9, s[8:11], s61 offen offset:3072  lds
  s_add_u32 s64, s64, 1
  s_cmp_eq_u32 s64, 10
  s_cselect_b32 s64, 0, s64
  s_load_dwordx2 s[12:13], s[0:1], 16
  s_load_dwordx2 s[40:41], s[0:1], 32
  s_load_dwordx2 s[16:17], s[0:1], 40
  s_load_dwordx2 s[20:21], s[0:1], 48
  s_load_dwordx2 s[24:25], s[0:1], 56
  s_load_dwordx2 s[28:29], s[0:1], 64
  s_mov_b32 s34, 268435456
  s_mov_b32 s35, 0x20000
  s_mov_b32 s14, 819200
  s_mov_b32 s15, 0x20000
  s_mov_b32 s42, 1280
  s_mov_b32 s43, 0x20000
  s_mov_b32 s18, 1966080
  s_mov_b32 s19, 0x20000
  s_mov_b32 s22, 1966080
  s_mov_b32 s23, 0x20000
  s_mov_b32 s26, 1966080
  s_mov_b32 s27, 0x20000
  s_mov_b32 s30, 2621440
  s_mov_b32 s31, 0x20000
  s_mov_b32 s76, -1
  s_mov_b32 s77, 0
  s_mov_b32 s78, 0xfffff
  s_mov_b32 s79, 0xfffff
  v_cmp_lt_u32 vcc, 7, v0
  v_lshlrev_b32 v10, 4, v0
  v_add_u32 v10, 159808, v10
  v_cndmask_b32 v12, 0, -1, vcc
  v_cndmask_b32 v13, 0, -1, vcc
  v_cndmask_b32 v14, 0, -1, vcc
  v_cndmask_b32 v15, 0, -1, vcc
  ds_write_b128 v10, v[12:15]
  s_lshr_b32 s74, s46, 3
  s_sub_u32 s39, s46, s74
  s_sub_u32 s39, s39, 1
  s_add_u32 s74, s74, 28
  s_and_b32 s75, s46, 7
  s_cselect_b32 s39, s39, s74
  s_lshl_b32 s74, s46, 2
  s_add_u32 s74, s74, s54
  s_mul_i32 s74, s74, 60
  v_min_u32 v10, 59, v0
  v_add_u32 v10, s74, v10
  v_mul_u32_u24 v11, 6554, v10
  v_lshrrev_b32 v11, 20, v11
  v_mul_u32_u24 v12, 160, v11
  v_sub_u32 v10, v10, v12
  v_lshlrev_b32 v10, 7, v10
  v_cmp_gt_u32 vcc, 32, v11
  v_and_b32 v12, 1, v11
  v_mul_u32_u24 v12, 20480, v12
  v_lshrrev_b32 v13, 4, v11
  v_mul_u32_u24 v14, 10240, v13
  s_mul_i32 s74, s47, 40960
  v_add3_u32 v12, v12, v10, s74
  v_sub_u32 v12, v12, v14
  v_add_u32 v14, 163840, v12
  v_min_u32 v12, v12, v14
  v_mul_u32_u24 v13, 2621440, v13
  v_bfe_u32 v14, v11, 1, 3
  v_mul_u32_u24 v14, 163840, v14
  v_add3_u32 v12, v12, v13, v14
  s_mul_i32 s74, s47, 20480
  s_sub_u32 s74, s74, 5120
  v_add_u32 v10, s74, v10
  v_add_u32 v14, 81920, v10
  v_min_u32 v10, v10, v14
  v_and_b32 v13, 15, v11
  v_mul_u32_u24 v13, 81920, v13
  s_mov_b32 s74, 5242880
  v_add3_u32 v13, v13, v10, s74
  v_cndmask_b32 v12, v13, v12, vcc
  s_mul_i32 s74, s48, 1310720
  v_add_u32 v21, s74, v12
  s_mul_i32 s74, s45, 5
  s_lshr_b32 s74, s74, 1
  s_mul_i32 s74, s74, 5
  s_lshr_b32 s75, s54, 1
  s_mul_i32 s75, s75, 50
  s_add_u32 s74, s74, s75
  s_add_u32 s74, s74, 0
  v_min_u32 v10, 49, v0
  v_add_u32 v10, s74, v10
  v_subrev_u32 v11, 100, v10
  v_min_u32 v10, v10, v11
  s_lshl_b32 s74, s46, 1
  s_and_b32 s75, s54, 1
  s_add_u32 s74, s74, s75
  s_mul_i32 s74, s74, 12800
  v_lshl_add_u32 v22, v10, 7, s74
  v_min_u32 v10, 59, v0
  v_mul_u32_u24 v11, 86, v10
  v_lshrrev_b32 v11, 8, v11
  v_mul_u32_u24 v11, 2688, v11
  v_lshl_add_u32 v10, v10, 7, v11
  s_mul_i32 s74, s46, 61440
  s_mul_i32 s75, s45, 384
  s_add_u32 s74, s74, s75
  v_add_u32 v24, s74, v10
  s_sub_u32 s74, s39, 17
  s_lshl_b32 s74, s74, 2
  s_add_u32 s74, s74, s54
  s_mul_i32 s74, s74, 35
  v_min_u32 v10, 63, v0
  v_lshrrev_b32 v11, 1, v10
  v_add_u32 v11, s74, v11
  v_min_u32 v11, 1535, v11
  v_mul_u32_u24 v11, 1280, v11
  v_and_b32 v10, 1, v10
  v_lshl_add_u32 v10, v10, 7, v11
  s_mul_i32 s75, s45, 160
  s_and_b32 s75, s75, -128
  v_add_u32 v25, s75, v10
  s_add_u32 s74, s74, 32
  v_min_u32 v10, 5, v0
  v_lshrrev_b32 v11, 1, v10
  v_add_u32 v11, s74, v11
  v_min_u32 v11, 1535, v11
  v_mul_u32_u24 v11, 1280, v11
  v_and_b32 v10, 1, v10
  v_lshl_add_u32 v10, v10, 7, v11
  v_add_u32 v27, s75, v10
  s_waitcnt lgkmcnt(0)
  s_mul_i32 s53, s52, 0x9e3779b1
  s_add_u32 s53, s53, 0x7f4a7c15
  s_and_b32 s53, s53, -16
  s_lshl_b32 s70, s54, 12
  v_bfe_u32 v10, v0, 1, 3
  v_lshrrev_b32 v11, 5, v0
  v_lshlrev_b32 v11, 2, v11
  v_xor_b32 v10, v10, v11
  v_lshlrev_b32 v10, 4, v10
  v_and_b32 v11, 31, v0
  v_lshl_add_u32 v10, v11, 7, v10
  v_add_u32 v44, s70, v10
  v_mov_b32 v43, 0x3f803f80
  s_and_b32 s37, s3, 12
  s_add_u32 s37, s37, s3
  s_lshl_b32 s70, s48, 2
  s_add_u32 s37, s37, s70
  s_lshl_b32 s37, s37, 14
  s_lshl_b32 s70, s54, 9
  s_add_u32 s37, s37, s70
  s_add_u32 s37, s37, 23592960
  v_lshrrev_b32 v10, 5, v0
  v_lshlrev_b32 v10, 11, v10
  v_lshl_add_u32 v48, v11, 4, v10
  s_lshl_b32 s70, s50, 11
  s_cmp_eq_u32 s50, 2
  s_cselect_b32 s70, 1048576, s70
  v_lshl_add_u32 v49, v11, 4, s70
  v_xor_b32 v45, 16, v44
  v_xor_b32 v46, 32, v44
  v_xor_b32 v47, 48, v44
  v_mov_b32 v60, 0
  v_mov_b32 v61, 0
  v_mov_b32 v62, 0
  v_mov_b32 v63, 0
  s_cmp_ge_u32 s54, 2
  s_cbranch_scc1 L_helperB
  s_lshl_b32 s61, s57, 7
  s_add_u32 m0, s60, 32768
  s_add_u32 s61, s61, s58
  buffer_load_dwordx4 v2, s[4:7], s61 offen offset:0  lds
  buffer_load_dwordx4 v3, s[4:7], s61 offen offset:1024  lds
  buffer_load_dwordx4 v4, s[4:7], s61 offen offset:2048  lds
  buffer_load_dwordx4 v5, s[4:7], s61 offen offset:3072  lds
  s_add_u32 s57, s57, 1
  s_cmp_eq_u32 s57, 10
  s_cselect_b32 s57, 0, s57
  s_mul_i32 s61, s64, 245760
  s_add_u32 m0, s60, 49152
  s_add_u32 s61, s61, s59
  buffer_load_dwordx4 v6, s[8:11], s61 offen offset:0  lds
  buffer_load_dwordx4 v7, s[8:11], s61 offen offset:1024  lds
  buffer_load_dwordx4 v8, s[8:11], s61 offen offset:2048  lds
  buffer_load_dwordx4 v9, s[8:11], s61 offen offset:3072  lds
  s_add_u32 s64, s64, 1
  s_cmp_eq_u32 s64, 10
  s_cselect_b32 s64, 0, s64
  s_and_b32 s74, s54, 1
  s_lshl_b32 s65, s46, 1
  s_add_u32 s74, s74, s65
  s_mul_i32 s65, s74, 30720
  s_mul_i32 s74, s45, 384
  s_add_u32 s65, s65, s74
  s_lshl_b32 s74, s2, 2
  s_add_u32 s74, s74, s54
  s_mul_i32 s66, s74, 800
  s_and_b32 s66, s66, -128
  s_waitcnt vmcnt(8)
  s_barrier
  ds_read_b128 v[64:67], v44 offset:0
  ds_read_b128 v[68:71], v45 offset:0
  ds_read_b128 v[72:75], v46 offset:0
  ds_read_b128 v[76:79], v47 offset:0
  s_lshl_b32 s61, s57, 7
  s_add_u32 m0, s60, 65536
  s_add_u32 s61, s61, s58
  buffer_load_dwordx4 v2, s[4:7], s61 offen offset:0  lds
  buffer_load_dwordx4 v3, s[4:7], s61 offen offset:1024  lds
  buffer_load_dwordx4 v4, s[4:7], s61 offen offset:2048  lds
  buffer_load_dwordx4 v5, s[4:7], s61 offen offset:3072  lds
  s_add_u32 s57, s57, 1
  s_cmp_eq_u32 s57, 10
  s_cselect_b32 s57, 0, s57
  s_mul_i32 s61, s64, 245760
  s_add_u32 m0, s60, 81920
  s_add_u32 s61, s61, s59
  buffer_load_dwordx4 v6, s[8:11], s61 offen offset:0  lds
  buffer_load_dwordx4 v7, s[8:11], s61 offen offset:1024  lds
  buffer_load_dwordx4 v8, s[8:11], s61 offen offset:2048  lds
  buffer_load_dwordx4 v9, s[8:11], s61 offen offset:3072  lds
  s_add_u32 s64, s64, 1
  s_cmp_eq_u32 s64, 10
  s_cselect_b32 s64, 0, s64
  s_waitcnt lgkmcnt(0)
  s_waitcnt vmcnt(8)
  s_barrier
  s_lshl_b32 s61, s57, 7
  s_add_u32 m0, s60, 98304
  s_add_u32 s61, s61, s58
  buffer_load_dwordx4 v2, s[4:7], s61 offen offset:0  lds
  buffer_load_dwordx4 v3, s[4:7], s61 offen offset:1024  lds
  buffer_load_dwordx4 v4, s[4:7], s61 offen offset:2048  lds
  buffer_load_dwordx4 v5, s[4:7], s61 offen offset:3072  lds
  s_add_u32 s57, s57, 1
  s_cmp_eq_u32 s57, 10
  s_cselect_b32 s57, 0, s57
  s_mul_i32 s61, s64, 245760
  s_add_u32 m0, s60, 114688
  s_add_u32 s61, s61, s59
  buffer_load_dwordx4 v6, s[8:11], s61 offen offset:0  lds
  buffer_load_dwordx4 v7, s[8:11], s61 offen offset:1024  lds
  buffer_load_dwordx4 v8, s[8:11], s61 offen offset:2048  lds
  buffer_load_dwordx4 v9, s[8:11], s61 offen offset:3072  lds
  s_add_u32 s64, s64, 1
  s_cmp_eq_u32 s64, 10
  s_cselect_b32 s64, 0, s64
  s_waitcnt lgkmcnt(3)
  v_dot2_f32_bf16 v60, v64, v43, v60
  v_dot2_f32_bf16 v62, v64, v64, v62
  v_dot2_f32_bf16 v61, v65, v43, v61
  v_dot2_f32_bf16 v63, v65, v65, v63
  v_dot2_f32_bf16 v60, v66, v43, v60
  v_dot2_f32_bf16 v62, v66, v66, v62
  v_dot2_f32_bf16 v61, v67, v43, v61
  v_dot2_f32_bf16 v63, v67, v67, v63
  s_waitcnt lgkmcnt(2)
  v_dot2_f32_bf16 v60, v68, v43, v60
  v_dot2_f32_bf16 v62, v68, v68, v62
  v_dot2_f32_bf16 v61, v69, v43, v61
  v_dot2_f32_bf16 v63, v69, v69, v63
  v_dot2_f32_bf16 v60, v70, v43, v60
  v_dot2_f32_bf16 v62, v70, v70, v62
  v_dot2_f32_bf16 v61, v71, v43, v61
  v_dot2_f32_bf16 v63, v71, v71, v63
  s_waitcnt lgkmcnt(1)
  v_dot2_f32_bf16 v60, v72, v43, v60
  v_dot2_f32_bf16 v62, v72, v72, v62
  v_dot2_f32_bf16 v61, v73, v43, v61
  v_dot2_f32_bf16 v63, v73, v73, v63
  v_dot2_f32_bf16 v60, v74, v43, v60
  v_dot2_f32_bf16 v62, v74, v74, v62
  v_dot2_f32_bf16 v61, v75, v43, v61
  v_dot2_f32_bf16 v63, v75, v75, v63
  s_waitcnt lgkmcnt(0)
  v_dot2_f32_bf16 v60, v76, v43, v60
  v_dot2_f32_bf16 v62, v76, v76, v62
  v_dot2_f32_bf16 v61, v77, v43, v61
  v_dot2_f32_bf16 v63, v77, v77, v63
  v_dot2_f32_bf16 v60, v78, v43, v60
  v_dot2_f32_bf16 v62, v78, v78, v62
  v_dot2_f32_bf16 v61, v79, v43, v61
  v_dot2_f32_bf16 v63, v79, v79, v63
  s_nop 1
  v_add_f32 v60, v60, v61
  v_add_f32 v61, v62, v63
  v_mov_b32 v62, s53
  s_nop 0
  v_permlane32_swap_b32 v60, v61
  s_nop 0
  v_add_f32 v60, v60, v61
  v_mov_b32 v61, v60
  s_nop 1
  v_permlane32_swap_b32 v60, v61
  s_mov_b64 exec, s[76:77]
  buffer_store_dwordx4 v[60:63], v49, s[32:35], s37 offen sc1
  s_mov_b64 exec, -1
  s_waitcnt vmcnt(9)
  s_barrier
  s_lshl_b32 s61, s57, 7
  s_add_u32 m0, s60, 0
  s_add_u32 s61, s61, s58
  buffer_load_dwordx4 v2, s[4:7], s61 offen offset:0  lds
  buffer_load_dwordx4 v3, s[4:7], s61 offen offset:1024  lds
  buffer_load_dwordx4 v4, s[4:7], s61 offen offset:2048  lds
  buffer_load_dwordx4 v5, s[4:7], s61 offen offset:3072  lds
  s_add_u32 s57, s57, 1
  s_cmp_eq_u32 s57, 10
  s_cselect_b32 s57, 0, s57
  s_mul_i32 s61, s64, 245760
  s_add_u32 m0, s60, 16384
  s_add_u32 s61, s61, s59
  buffer_load_dwordx4 v6, s[8:11], s61 offen offset:0  lds
  buffer_load_dwordx4 v7, s[8:11], s61 offen offset:1024  lds
  buffer_load_dwordx4 v8, s[8:11], s61 offen offset:2048  lds
  buffer_load_dwordx4 v9, s[8:11], s61 offen offset:3072  lds
  s_add_u32 s64, s64, 1
  s_cmp_eq_u32 s64, 10
  s_cselect_b32 s64, 0, s64
  s_waitcnt vmcnt(9)
  s_barrier
  s_lshl_b32 s61, s57, 7
  s_add_u32 m0, s60, 32768
  s_add_u32 s61, s61, s58
  buffer_load_dwordx4 v2, s[4:7], s61 offen offset:0  lds
  buffer_load_dwordx4 v3, s[4:7], s61 offen offset:1024  lds
  buffer_load_dwordx4 v4, s[4:7], s61 offen offset:2048  lds
  buffer_load_dwordx4 v5, s[4:7], s61 offen offset:3072  lds
  s_add_u32 s57, s57, 1
  s_cmp_eq_u32 s57, 10
  s_cselect_b32 s57, 0, s57
  s_mul_i32 s61, s64, 245760
  s_add_u32 m0, s60, 49152
  s_add_u32 s61, s61, s59
  buffer_load_dwordx4 v6, s[8:11], s61 offen offset:0  lds
  buffer_load_dwordx4 v7, s[8:11], s61 offen offset:1024  lds
  buffer_load_dwordx4 v8, s[8:11], s61 offen offset:2048  lds
  buffer_load_dwordx4 v9, s[8:11], s61 offen offset:3072  lds
  s_add_u32 s64, s64, 1
  s_cmp_eq_u32 s64, 10
  s_cselect_b32 s64, 0, s64
  s_load_dword s100, s[12:13], s66 offset:0
  s_load_dword s100, s[12:13], s66 offset:128
  s_waitcnt vmcnt(8)
  s_barrier
  s_lshl_b32 s61, s57, 7
  s_add_u32 m0, s60, 65536
  s_add_u32 s61, s61, s58
  buffer_load_dwordx4 v2, s[4:7], s61 offen offset:0  lds
  buffer_load_dwordx4 v3, s[4:7], s61 offen offset:1024  lds
  buffer_load_dwordx4 v4, s[4:7], s61 offen offset:2048  lds
  buffer_load_dwordx4 v5, s[4:7], s61 offen offset:3072  lds
  s_add_u32 s57, s57, 1
  s_cmp_eq_u32 s57, 10
  s_cselect_b32 s57, 0, s57
  s_mul_i32 s61, s64, 245760
  s_add_u32 m0, s60, 81920
  s_add_u32 s61, s61, s59
  buffer_load_dwordx4 v6, s[8:11], s61 offen offset:0  lds
  buffer_load_dwordx4 v7, s[8:11], s61 offen offset:1024  lds
  buffer_load_dwordx4 v8, s[8:11], s61 offen offset:2048  lds
  buffer_load_dwordx4 v9, s[8:11], s61 offen offset:3072  lds
  s_add_u32 s64, s64, 1
  s_cmp_eq_u32 s64, 10
  s_cselect_b32 s64, 0, s64
  s_load_dword s100, s[12:13], s66 offset:256
  s_load_dword s100, s[12:13], s66 offset:384
  s_waitcnt vmcnt(8)
  s_barrier
  s_lshl_b32 s61, s57, 7
  s_add_u32 m0, s60, 98304
  s_add_u32 s61, s61, s58
  buffer_load_dwordx4 v2, s[4:7], s61 offen offset:0  lds
  buffer_load_dwordx4 v3, s[4:7], s61 offen offset:1024  lds
  buffer_load_dwordx4 v4, s[4:7], s61 offen offset:2048  lds
  buffer_load_dwordx4 v5, s[4:7], s61 offen offset:3072  lds
  s_add_u32 s57, s57, 1
  s_cmp_eq_u32 s57, 10
  s_cselect_b32 s57, 0, s57
  s_mul_i32 s61, s64, 245760
  s_add_u32 m0, s60, 114688
  s_add_u32 s61, s61, s59
  buffer_load_dwordx4 v6, s[8:11], s61 offen offset:0  lds
  buffer_load_dwordx4 v7, s[8:11], s61 offen offset:1024  lds
  buffer_load_dwordx4 v8, s[8:11], s61 offen offset:2048  lds
  buffer_load_dwordx4 v9, s[8:11], s61 offen offset:3072  lds
  s_add_u32 s64, s64, 1
  s_cmp_eq_u32 s64, 10
  s_cselect_b32 s64, 0, s64
  s_load_dword s100, s[12:13], s66 offset:512
  s_load_dword s100, s[12:13], s66 offset:640
  s_load_dword s100, s[12:13], s66 offset:768
  s_waitcnt vmcnt(8)
  s_barrier
  s_lshl_b32 s61, s57, 7
  s_add_u32 m0, s60, 0
  s_add_u32 s61, s61, s58
  buffer_load_dwordx4 v2, s[4:7], s61 offen offset:0  lds
  buffer_load_dwordx4 v3, s[4:7], s61 offen offset:1024  lds
  buffer_load_dwordx4 v4, s[4:7], s61 offen offset:2048  lds
  buffer_load_dwordx4 v5, s[4:7], s61 offen offset:3072  lds
  s_add_u32 s57, s57, 1
  s_cmp_eq_u32 s57, 10
  s_cselect_b32 s57, 0, s57
  s_mul_i32 s61, s64, 245760
  s_add_u32 m0, s60, 16384
  s_add_u32 s61, s61, s59
  buffer_load_dwordx4 v6, s[8:11], s61 offen offset:0  lds
  buffer_load_dwordx4 v7, s[8:11], s61 offen offset:1024  lds
  buffer_load_dwordx4 v8, s[8:11], s61 offen offset:2048  lds
  buffer_load_dwordx4 v9, s[8:11], s61 offen offset:3072  lds
  s_add_u32 s64, s64, 1
  s_cmp_eq_u32 s64, 10
  s_cselect_b32 s64, 0, s64
  s_add_u32 s38, s37, 0
  buffer_load_dwordx4 v[64:67], v48, s[32:35], s38 offen sc1
  s_add_u32 s38, s37, 4096
  buffer_load_dwordx4 v[68:71], v48, s[32:35], s38 offen sc1
  s_add_u32 s38, s37, 8192
  buffer_load_dwordx4 v[72:75], v48, s[32:35], s38 offen sc1
  s_add_u32 s38, s37, 12288
  buffer_load_dwordx4 v[76:79], v48, s[32:35], s38 offen sc1
  s_waitcnt vmcnt(12)
  s_barrier
  s_lshl_b32 s61, s57, 7
  s_add_u32 m0, s60, 32768
  s_add_u32 s61, s61, s58
  buffer_load_dwordx4 v2, s[4:7], s61 offen offset:0  lds
  buffer_load_dwordx4 v3, s[4:7], s61 offen offset:1024  lds
  buffer_load_dwordx4 v4, s[4:7], s61 offen offset:2048  lds
  buffer_load_dwordx4 v5, s[4:7], s61 offen offset:3072  lds
  s_add_u32 s57, s57, 1
  s_cmp_eq_u32 s57, 10
  s_cselect_b32 s57, 0, s57
  s_mul_i32 s61, s64, 245760
  s_add_u32 m0, s60, 49152
  s_add_u32 s61, s61, s59
  buffer_load_dwordx4 v6, s[8:11], s61 offen offset:0  lds
  buffer_load_dwordx4 v7, s[8:11], s61 offen offset:1024  lds
  buffer_load_dwordx4 v8, s[8:11], s61 offen offset:2048  lds
  buffer_load_dwordx4 v9, s[8:11], s61 offen offset:3072  lds
  s_add_u32 s64, s64, 1
  s_cmp_eq_u32 s64, 10
  s_cselect_b32 s64, 0, s64
  s_waitcnt vmcnt(12)
  s_barrier
  buffer_load_dword v39, v21, s[32:35], 0 offen
  s_waitcnt vmcnt(1)
  s_barrier
  s_waitcnt vmcnt(9)
  s_mov_b32 s62, 262144
Lstl_3:
  v_xor_b32 v10, v66, v70
  v_xor_b32 v11, v74, v78
  v_xor_b32 v12, s53, v66
  v_xor_b32 v13, s53, v74
  v_or3_b32 v10, v10, v11, v12
  v_or_b32 v10, v10, v13
  v_cmp_ne_u32 vcc, 0, v10
  v_add_f32 v11, v64, v68
  v_add_f32 v12, v65, v69
  s_cbranch_vccnz Lstrt_5
Lstok_4:
  v_add_f32 v13, v72, v76
  v_add_f32 v14, v73, v77
  v_add_f32 v11, v11, v13
  v_add_f32 v12, v12, v14
  s_nop 1
  v_permlane32_swap_b32 v11, v12
  s_nop 0
  v_add_f32 v11, v11, v12
  v_mul_f32 v11, 0.0015625, v11
  v_mov_b32 v12, v11
  s_nop 1
  v_permlane32_swap_b32 v11, v12
  s_nop 0
  v_fma_f32 v12, -v11, v11, v12
  v_max_f32 v12, 0, v12
  v_cvt_pk_bf16_f32 v12, v12, v12
  v_and_b32 v12, 0xffff0000, v12
  v_add_f32 v12, 0x3727c5ac, v12
  v_cvt_pk_bf16_f32 v12, v12, v12
  v_and_b32 v12, 0xffff0000, v12
  v_sqrt_f32 v12, v12
  v_xor_b32 v11, 0x80000000, v11
  s_barrier
  v_cvt_pk_bf16_f32 v12, v12, v12
  v_and_b32 v12, 0xffff0000, v12
  v_rcp_f32 v15, v12
  v_cvt_pk_bf16_f32 v14, v11, v11
  v_and_b32 v13, 31, v0
  s_lshl_b32 s62, s54, 8
  s_add_u32 s62, s62, 158208
  v_lshl_add_u32 v11, v13, 3, s62
  s_lshl_b32 s62, s54, 7
  s_add_u32 s62, s62, 131072
  v_lshl_add_u32 v12, v13, 2, s62
  v_and_b32 v14, 0xffff0000, v14
  ds_write_b64 v11, v[14:15]
  ds_write_b32 v12, v15 offset:28160
  ds_write_b32 v12, v14
  s_waitcnt lgkmcnt(0)
  s_barrier
  s_lshr_b32 s55, s46, 1
  s_and_b32 s56, s46, 1
  s_and_b32 s57, s55, 1
  s_lshr_b32 s58, s55, 1
  s_lshl_b32 s59, s48, 3
  s_add_u32 s58, s58, s59
  s_lshl_b32 s59, s48, 4
  s_add_u32 s59, s59, s55
  s_lshl_b32 s60, s47, 1
  s_add_u32 s60, s60, s56
  s_lshl_b32 s60, s60, 3
  s_mov_b32 s75, 1024
  v_lshlrev_b32 v6, 4, v0
  v_lshrrev_b32 v10, 5, v0
  v_mul_u32_u24 v10, 2048, v10
  v_add3_u32 v7, v6, v10, s75
  s_lshr_b32 s61, s55, 1
  s_mul_i32 s61, s61, 5
  s_lshl_b32 s62, s57, 1
  s_add_u32 s61, s61, s62
  s_add_u32 s62, s61, 2
  s_lshr_b32 s61, s61, 3
  s_lshr_b32 s62, s62, 3
  s_lshl_b32 s62, s62, 4
  s_or_b32 s61, s61, s62
  s_add_u32 s62, s61, 0x55
  s_lshl_b32 s71, s62, 8
  s_or_b32 s61, s71, s62
  s_mul_i32 s62, s55, 20
  s_add_u32 s71, s62, 19
  s_lshr_b32 s62, s62, 6
  s_lshr_b32 s71, s71, 6
  s_lshl_b32 s71, s71, 4
  s_or_b32 s62, s62, s71
  s_add_u32 s62, s62, 0xaa
  s_lshl_b32 s62, s62, 16
  s_or_b32 s61, s61, s62
  v_and_b32 v10, 60, v0
  v_min_u32 v10, 20, v10
  v_bfe_u32 v10, s61, v10, 4
  v_and_b32 v8, 3, v0
  v_lshlrev_b32 v8, 2, v8
  v_lshl_add_u32 v8, v10, 7, v8
  v_mov_b32 v11, 1
  v_and_b32 v12, 4, v8
  v_and_b32 v8, -128, v8
  s_cmp_lg_u32 s54, 0
  s_cbranch_scc1 Lrem_7
  v_add_u32 v8, v8, v12
  s_mul_i32 s61, s56, 24
  s_lshl_b32 s63, s45, 11
  s_add_u32 s63, s63, s61
  s_add_u32 s63, s63, 19529728
  s_mov_b32 s62, 0
  s_branch Lremj_8
Lrem_7:
  v_lshlrev_b32 v8, 3, v8
  s_lshl_b32 s61, s56, 2
  s_add_u32 s61, s61, s45
  s_sub_u32 s61, s61, 2
  s_and_b32 s61, s61, 7
  s_lshl_b32 s63, s61, 14
  s_mul_i32 s61, s56, -768
  s_add_u32 s63, s63, s61
  s_add_u32 s63, s63, 24380160
  s_mov_b32 s62, 5242880
Lremj_8:
  s_lshl_b32 s61, s54, 2
  s_sub_u32 s64, -2, s61
  s_cmp_eq_u32 s56, 0
  s_cselect_b32 s61, s64, s61
  s_mul_i32 s66, s56, 5120
  s_sub_u32 s66, s66, 2560
  s_add_u32 s61, s61, s60
  s_mul_i32 s64, s61, 2560
  s_mul_i32 s65, s61, 1280
  s_mul_i32 s61, s58, 163840
  s_add_u32 s64, s64, s61
  s_add_u32 s64, s64, s62
  s_add_u32 s64, s64, 2621440
  s_mul_i32 s61, s59, 81920
  s_add_u32 s65, s65, s61
  s_add_u32 s65, s65, s62
  s_add_u32 s65, s65, 5242880
  s_mul_i32 s70, s54, -11264
  s_add_u32 s70, s70, 27136
  s_cmp_eq_u32 s60, 0
  s_cbranch_scc1 Lg2done_6
  s_cmp_lg_u32 s54, 0
  s_cbranch_scc1 Lgate0_9
  s_branch Lgate1_10
Lgate0_9:
  v_mov_b32 v10, 159808
  s_mov_b32 s71, 1048576
Llw_11:
  ds_read_b32 v15, v10
  s_waitcnt lgkmcnt(0)
  v_cmp_gt_u32 vcc, 4, v15
  s_nop 0
  s_cbranch_vccz Llwok_12
  s_sub_u32 s71, s71, 1
  s_cbranch_scc1 Llwok_12
  s_branch Llw_11
Llwok_12:
Lgate1_10:
  s_mov_b32 s71, 262144
Lfp_13:
  buffer_load_dword v15, v8, s[32:35], s63 offen sc1
  s_waitcnt vmcnt(0)
  v_cmp_ne_u32 vcc, s53, v15
  s_nop 0
  s_cbranch_vccz Lfpok_14
  s_sub_u32 s71, s71, 1
  s_cbranch_scc1 Lfpok_14
  s_sleep 1
  s_branch Lfp_13
Lfpok_14:
  s_mul_i32 s61, s57, 1536
  s_add_u32 s61, s61, s64
  s_mov_b32 m0, s70
  s_add_u32 s62, s61, 1536
  buffer_load_dwordx4 v6, s[32:35], s61 offen sc1 lds
  buffer_load_dwordx4 v6, s[32:35], s62 offen offset:1024 sc1 lds
  s_sub_u32 s61, s64, 2048
  s_sub_u32 s62, s65, 3072
  buffer_load_dwordx4 v7, s[32:35], s61 offen offset:2048 sc1 lds
  buffer_load_dwordx4 v6, s[32:35], s62 offen offset:3072 sc1 lds
  s_add_u32 m0, s70, 4096
  s_add_u32 s62, s65, 1024
  buffer_load_dwordx4 v6, s[32:35], s62 offen sc1 lds
  s_mov_b64 exec, s[76:77]
  buffer_load_dwordx4 v6, s[32:35], s62 offen offset:1024 sc1 lds
  s_mov_b64 exec, -1
  s_add_u32 s64, s64, s66
  s_add_u32 s64, s64, s66
  s_add_u32 s65, s65, s66
  s_sub_u32 s70, s70, 5632
  s_mul_i32 s61, s57, 1536
  s_add_u32 s61, s61, s64
  s_mov_b32 m0, s70
  s_add_u32 s62, s61, 1536
  buffer_load_dwordx4 v6, s[32:35], s61 offen sc1 lds
  buffer_load_dwordx4 v6, s[32:35], s62 offen offset:1024 sc1 lds
  s_sub_u32 s61, s64, 2048
  s_sub_u32 s62, s65, 3072
  buffer_load_dwordx4 v7, s[32:35], s61 offen offset:2048 sc1 lds
  buffer_load_dwordx4 v6, s[32:35], s62 offen offset:3072 sc1 lds
  s_add_u32 m0, s70, 4096
  s_add_u32 s62, s65, 1024
  buffer_load_dwordx4 v6, s[32:35], s62 offen sc1 lds
  s_mov_b64 exec, s[76:77]
  buffer_load_dwordx4 v6, s[32:35], s62 offen offset:1024 sc1 lds
  s_mov_b64 exec, -1
  s_waitcnt vmcnt(0)
Lg2done_6:
  s_lshl_b32 s61, s54, 2
  s_add_u32 s61, s61, 159920
  v_mov_b32 v10, 159812
  v_mov_b32 v12, s61
  s_mov_b64 exec, 1
  ds_write_b32 v12, v11
  ds_add_u32 v10, v11
  s_mov_b64 exec, -1
  v_mov_b32 v10, 159816
  s_mov_b32 s71, 1048576
Llw_15:
  ds_read_b32 v15, v10
  s_waitcnt lgkmcnt(0)
  v_cmp_gt_u32 vcc, 4, v15
  s_nop 0
  s_cbranch_vccz Llwok_16
  s_sub_u32 s71, s71, 1
  s_cbranch_scc1 Llwok_16
  s_sleep 1
  s_branch Llw_15
Llwok_16:
  s_cmp_eq_u32 s54, 0
  s_cbranch_scc0 Ltu_17
  buffer_load_dword v39, v24, s[16:19], 0 offen
  s_branch Ltj_18
Ltu_17:
  buffer_load_dword v39, v24, s[20:23], 0 offen
Ltj_18:
  s_branch L_mw
L_helperB:
  s_lshr_b32 s72, s46, 3
  s_lshl_b32 s71, s45, 2
  s_add_u32 s72, s72, s71
  s_lshl_b32 s72, s72, 3
  s_and_b32 s71, s46, 7
  s_add_u32 s73, s72, s71
  s_lshr_b32 s70, s73, 1
  s_mul_i32 s70, s70, 20480
  s_and_b32 s71, s71, 1
  s_mul_i32 s71, s71, 5120
  s_add_u32 s70, s70, s71
  s_add_u32 s70, s70, 13107200
  s_mul_i32 s71, s48, 10240
  s_add_u32 s72, s70, 10240
  s_add_u32 s70, s70, s71
  s_sub_u32 s72, s72, s71
  s_lshl_b32 s73, s73, 10
  s_add_u32 s73, s73, 16384000
  s_mul_i32 s71, s54, 25
  s_sub_u32 s71, s71, 50
  v_min_u32 v10, 24, v0
  v_add_u32 v10, s71, v10
  v_min_u32 v10, 48, v10
  s_sub_u32 s73, s73, 5120
  s_and_b32 s71, s46, 15
  s_lshl_b32 s72, s45, 4
  s_add_u32 s71, s71, s72
  s_lshl_b32 s71, s71, 7
  s_add_u32 s71, s71, 19523584
  v_mov_b32 v11, s70
  v_mov_b32 v12, s73
  v_cmp_le_u32 vcc, 40, v10
  v_mov_b32 v13, s71
  s_mul_i32 s71, s46, 25600
  v_cndmask_b32 v11, v11, v12, vcc
  v_cmp_le_u32 vcc, 48, v10
  s_mul_i32 s70, s54, 12800
  s_add_u32 s71, s71, s70
  v_cndmask_b32 v11, v11, v13, vcc
  v_lshl_add_u32 v23, v10, 7, v11
  s_sub_u32 s71, s71, 25600
  s_mul_i32 s70, s45, 5
  s_lshr_b32 s70, s70, 1
  s_mul_i32 s70, s70, 640
  s_add_u32 s70, s70, s71
  s_mov_b32 s72, 20
  v_lshlrev_b32 v20, 4, v0
  v_add_u32 v20, 19398656, v20
  v_mul_u32_u24 v37, 20, v0
  s_lshl_b32 s61, s57, 7
  s_add_u32 m0, s60, 32768
  s_add_u32 s61, s61, s58
  buffer_load_dwordx4 v2, s[4:7], s61 offen offset:0  lds
  buffer_load_dwordx4 v3, s[4:7], s61 offen offset:1024  lds
  buffer_load_dwordx4 v4, s[4:7], s61 offen offset:2048  lds
  buffer_load_dwordx4 v5, s[4:7], s61 offen offset:3072  lds
  s_add_u32 s57, s57, 1
  s_cmp_eq_u32 s57, 10
  s_cselect_b32 s57, 0, s57
  s_mul_i32 s61, s64, 245760
  s_add_u32 m0, s60, 49152
  s_add_u32 s61, s61, s59
  buffer_load_dwordx4 v6, s[8:11], s61 offen offset:0  lds
  buffer_load_dwordx4 v7, s[8:11], s61 offen offset:1024  lds
  buffer_load_dwordx4 v8, s[8:11], s61 offen offset:2048  lds
  buffer_load_dwordx4 v9, s[8:11], s61 offen offset:3072  lds
  s_add_u32 s64, s64, 1
  s_cmp_eq_u32 s64, 10
  s_cselect_b32 s64, 0, s64
  s_and_b32 s74, s54, 1
  s_lshl_b32 s65, s46, 1
  s_add_u32 s74, s74, s65
  s_mul_i32 s65, s74, 30720
  s_mul_i32 s74, s45, 384
  s_add_u32 s65, s65, s74
  s_lshl_b32 s74, s2, 2
  s_add_u32 s74, s74, s54
  s_mul_i32 s66, s74, 800
  s_and_b32 s66, s66, -128
  s_waitcnt vmcnt(8)
  s_barrier
  ds_read_b128 v[64:67], v44 offset:0
  ds_read_b128 v[68:71], v45 offset:0
  ds_read_b128 v[72:75], v46 offset:0
  ds_read_b128 v[76:79], v47 offset:0
  s_lshl_b32 s61, s57, 7
  s_add_u32 m0, s60, 65536
  s_add_u32 s61, s61, s58
  buffer_load_dwordx4 v2, s[4:7], s61 offen offset:0  lds
  buffer_load_dwordx4 v3, s[4:7], s61 offen offset:1024  lds
  buffer_load_dwordx4 v4, s[4:7], s61 offen offset:2048  lds
  buffer_load_dwordx4 v5, s[4:7], s61 offen offset:3072  lds
  s_add_u32 s57, s57, 1
  s_cmp_eq_u32 s57, 10
  s_cselect_b32 s57, 0, s57
  s_mul_i32 s61, s64, 245760
  s_add_u32 m0, s60, 81920
  s_add_u32 s61, s61, s59
  buffer_load_dwordx4 v6, s[8:11], s61 offen offset:0  lds
  buffer_load_dwordx4 v7, s[8:11], s61 offen offset:1024  lds
  buffer_load_dwordx4 v8, s[8:11], s61 offen offset:2048  lds
  buffer_load_dwordx4 v9, s[8:11], s61 offen offset:3072  lds
  s_add_u32 s64, s64, 1
  s_cmp_eq_u32 s64, 10
  s_cselect_b32 s64, 0, s64
  s_waitcnt lgkmcnt(0)
  s_waitcnt vmcnt(8)
  s_barrier
  s_lshl_b32 s61, s57, 7
  s_add_u32 m0, s60, 98304
  s_add_u32 s61, s61, s58
  buffer_load_dwordx4 v2, s[4:7], s61 offen offset:0  lds
  buffer_load_dwordx4 v3, s[4:7], s61 offen offset:1024  lds
  buffer_load_dwordx4 v4, s[4:7], s61 offen offset:2048  lds
  buffer_load_dwordx4 v5, s[4:7], s61 offen offset:3072  lds
  s_add_u32 s57, s57, 1
  s_cmp_eq_u32 s57, 10
  s_cselect_b32 s57, 0, s57
  s_mul_i32 s61, s64, 245760
  s_add_u32 m0, s60, 114688
  s_add_u32 s61, s61, s59
  buffer_load_dwordx4 v6, s[8:11], s61 offen offset:0  lds
  buffer_load_dwordx4 v7, s[8:11], s61 offen offset:1024  lds
  buffer_load_dwordx4 v8, s[8:11], s61 offen offset:2048  lds
  buffer_load_dwordx4 v9, s[8:11], s61 offen offset:3072  lds
  s_add_u32 s64, s64, 1
  s_cmp_eq_u32 s64, 10
  s_cselect_b32 s64, 0, s64
  s_waitcnt lgkmcnt(3)
  v_dot2_f32_bf16 v60, v64, v43, v60
  v_dot2_f32_bf16 v62, v64, v64, v62
  v_dot2_f32_bf16 v61, v65, v43, v61
  v_dot2_f32_bf16 v63, v65, v65, v63
  v_dot2_f32_bf16 v60, v66, v43, v60
  v_dot2_f32_bf16 v62, v66, v66, v62
  v_dot2_f32_bf16 v61, v67, v43, v61
  v_dot2_f32_bf16 v63, v67, v67, v63
  s_waitcnt lgkmcnt(2)
  v_dot2_f32_bf16 v60, v68, v43, v60
  v_dot2_f32_bf16 v62, v68, v68, v62
  v_dot2_f32_bf16 v61, v69, v43, v61
  v_dot2_f32_bf16 v63, v69, v69, v63
  v_dot2_f32_bf16 v60, v70, v43, v60
  v_dot2_f32_bf16 v62, v70, v70, v62
  v_dot2_f32_bf16 v61, v71, v43, v61
  v_dot2_f32_bf16 v63, v71, v71, v63
  s_waitcnt lgkmcnt(1)
  v_dot2_f32_bf16 v60, v72, v43, v60
  v_dot2_f32_bf16 v62, v72, v72, v62
  v_dot2_f32_bf16 v61, v73, v43, v61
  v_dot2_f32_bf16 v63, v73, v73, v63
  v_dot2_f32_bf16 v60, v74, v43, v60
  v_dot2_f32_bf16 v62, v74, v74, v62
  v_dot2_f32_bf16 v61, v75, v43, v61
  v_dot2_f32_bf16 v63, v75, v75, v63
  s_waitcnt lgkmcnt(0)
  v_dot2_f32_bf16 v60, v76, v43, v60
  v_dot2_f32_bf16 v62, v76, v76, v62
  v_dot2_f32_bf16 v61, v77, v43, v61
  v_dot2_f32_bf16 v63, v77, v77, v63
  v_dot2_f32_bf16 v60, v78, v43, v60
  v_dot2_f32_bf16 v62, v78, v78, v62
  v_dot2_f32_bf16 v61, v79, v43, v61
  v_dot2_f32_bf16 v63, v79, v79, v63
  s_nop 1
  v_add_f32 v60, v60, v61
  v_add_f32 v61, v62, v63
  v_mov_b32 v62, s53
  s_nop 0
  v_permlane32_swap_b32 v60, v61
  s_nop 0
  v_add_f32 v60, v60, v61
  v_mov_b32 v61, v60
  s_nop 1
  v_permlane32_swap_b32 v60, v61
  s_mov_b64 exec, s[76:77]
  buffer_store_dwordx4 v[60:63], v49, s[32:35], s37 offen sc1
  s_mov_b64 exec, -1
  s_waitcnt vmcnt(9)
  s_barrier
  s_lshl_b32 s61, s57, 7
  s_add_u32 m0, s60, 0
  s_add_u32 s61, s61, s58
  buffer_load_dwordx4 v2, s[4:7], s61 offen offset:0  lds
  buffer_load_dwordx4 v3, s[4:7], s61 offen offset:1024  lds
  buffer_load_dwordx4 v4, s[4:7], s61 offen offset:2048  lds
  buffer_load_dwordx4 v5, s[4:7], s61 offen offset:3072  lds
  s_add_u32 s57, s57, 1
  s_cmp_eq_u32 s57, 10
  s_cselect_b32 s57, 0, s57
  s_mul_i32 s61, s64, 245760
  s_add_u32 m0, s60, 16384
  s_add_u32 s61, s61, s59
  buffer_load_dwordx4 v6, s[8:11], s61 offen offset:0  lds
  buffer_load_dwordx4 v7, s[8:11], s61 offen offset:1024  lds
  buffer_load_dwordx4 v8, s[8:11], s61 offen offset:2048  lds
  buffer_load_dwordx4 v9, s[8:11], s61 offen offset:3072  lds
  s_add_u32 s64, s64, 1
  s_cmp_eq_u32 s64, 10
  s_cselect_b32 s64, 0, s64
  s_waitcnt vmcnt(9)
  s_barrier
  s_lshl_b32 s61, s57, 7
  s_add_u32 m0, s60, 32768
  s_add_u32 s61, s61, s58
  buffer_load_dwordx4 v2, s[4:7], s61 offen offset:0  lds
  buffer_load_dwordx4 v3, s[4:7], s61 offen offset:1024  lds
  buffer_load_dwordx4 v4, s[4:7], s61 offen offset:2048  lds
  buffer_load_dwordx4 v5, s[4:7], s61 offen offset:3072  lds
  s_add_u32 s57, s57, 1
  s_cmp_eq_u32 s57, 10
  s_cselect_b32 s57, 0, s57
  s_mul_i32 s61, s64, 245760
  s_add_u32 m0, s60, 49152
  s_add_u32 s61, s61, s59
  buffer_load_dwordx4 v6, s[8:11], s61 offen offset:0  lds
  buffer_load_dwordx4 v7, s[8:11], s61 offen offset:1024  lds
  buffer_load_dwordx4 v8, s[8:11], s61 offen offset:2048  lds
  buffer_load_dwordx4 v9, s[8:11], s61 offen offset:3072  lds
  s_add_u32 s64, s64, 1
  s_cmp_eq_u32 s64, 10
  s_cselect_b32 s64, 0, s64
  s_load_dword s100, s[12:13], s66 offset:0
  s_load_dword s100, s[12:13], s66 offset:128
  s_waitcnt vmcnt(8)
  s_barrier
  s_lshl_b32 s61, s57, 7
  s_add_u32 m0, s60, 65536
  s_add_u32 s61, s61, s58
  buffer_load_dwordx4 v2, s[4:7], s61 offen offset:0  lds
  buffer_load_dwordx4 v3, s[4:7], s61 offen offset:1024  lds
  buffer_load_dwordx4 v4, s[4:7], s61 offen offset:2048  lds
  buffer_load_dwordx4 v5, s[4:7], s61 offen offset:3072  lds
  s_add_u32 s57, s57, 1
  s_cmp_eq_u32 s57, 10
  s_cselect_b32 s57, 0, s57
  s_mul_i32 s61, s64, 245760
  s_add_u32 m0, s60, 81920
  s_add_u32 s61, s61, s59
  buffer_load_dwordx4 v6, s[8:11], s61 offen offset:0  lds
  buffer_load_dwordx4 v7, s[8:11], s61 offen offset:1024  lds
  buffer_load_dwordx4 v8, s[8:11], s61 offen offset:2048  lds
  buffer_load_dwordx4 v9, s[8:11], s61 offen offset:3072  lds
  s_add_u32 s64, s64, 1
  s_cmp_eq_u32 s64, 10
  s_cselect_b32 s64, 0, s64
  s_load_dword s100, s[12:13], s66 offset:256
  s_load_dword s100, s[12:13], s66 offset:384
  s_waitcnt vmcnt(8)
  s_barrier
  s_lshl_b32 s61, s57, 7
  s_add_u32 m0, s60, 98304
  s_add_u32 s61, s61, s58
  buffer_load_dwordx4 v2, s[4:7], s61 offen offset:0  lds
  buffer_load_dwordx4 v3, s[4:7], s61 offen offset:1024  lds
  buffer_load_dwordx4 v4, s[4:7], s61 offen offset:2048  lds
  buffer_load_dwordx4 v5, s[4:7], s61 offen offset:3072  lds
  s_add_u32 s57, s57, 1
  s_cmp_eq_u32 s57, 10
  s_cselect_b32 s57, 0, s57
  s_mul_i32 s61, s64, 245760
  s_add_u32 m0, s60, 114688
  s_add_u32 s61, s61, s59
  buffer_load_dwordx4 v6, s[8:11], s61 offen offset:0  lds
  buffer_load_dwordx4 v7, s[8:11], s61 offen offset:1024  lds
  buffer_load_dwordx4 v8, s[8:11], s61 offen offset:2048  lds
  buffer_load_dwordx4 v9, s[8:11], s61 offen offset:3072  lds
  s_add_u32 s64, s64, 1
  s_cmp_eq_u32 s64, 10
  s_cselect_b32 s64, 0, s64
  s_load_dword s100, s[12:13], s66 offset:512
  s_load_dword s100, s[12:13], s66 offset:640
  s_load_dword s100, s[12:13], s66 offset:768
  s_waitcnt vmcnt(8)
  s_barrier
  s_lshl_b32 s61, s57, 7
  s_add_u32 m0, s60, 0
  s_add_u32 s61, s61, s58
  buffer_load_dwordx4 v2, s[4:7], s61 offen offset:0  lds
  buffer_load_dwordx4 v3, s[4:7], s61 offen offset:1024  lds
  buffer_load_dwordx4 v4, s[4:7], s61 offen offset:2048  lds
  buffer_load_dwordx4 v5, s[4:7], s61 offen offset:3072  lds
  s_add_u32 s57, s57, 1
  s_cmp_eq_u32 s57, 10
  s_cselect_b32 s57, 0, s57
  s_mul_i32 s61, s64, 245760
  s_add_u32 m0, s60, 16384
  s_add_u32 s61, s61, s59
  buffer_load_dwordx4 v6, s[8:11], s61 offen offset:0  lds
  buffer_load_dwordx4 v7, s[8:11], s61 offen offset:1024  lds
  buffer_load_dwordx4 v8, s[8:11], s61 offen offset:2048  lds
  buffer_load_dwordx4 v9, s[8:11], s61 offen offset:3072  lds
  s_add_u32 s64, s64, 1
  s_cmp_eq_u32 s64, 10
  s_cselect_b32 s64, 0, s64
  s_add_u32 s38, s37, 0
  buffer_load_dwordx4 v[64:67], v48, s[32:35], s38 offen sc1
  s_add_u32 s38, s37, 4096
  buffer_load_dwordx4 v[68:71], v48, s[32:35], s38 offen sc1
  s_add_u32 s38, s37, 8192
  buffer_load_dwordx4 v[72:75], v48, s[32:35], s38 offen sc1
  s_add_u32 s38, s37, 12288
  buffer_load_dwordx4 v[76:79], v48, s[32:35], s38 offen sc1
  buffer_load_dwordx4 v[16:19], v20, s[32:35], 0 offen sc1
  buffer_load_dwordx4 v[32:35], v37, s[40:43], 0 offen
  buffer_load_dword v36, v37, s[40:43], 0 offen offset:16
  s_waitcnt vmcnt(15)
  s_barrier
  s_lshl_b32 s61, s57, 7
  s_add_u32 m0, s60, 32768
  s_add_u32 s61, s61, s58
  buffer_load_dwordx4 v2, s[4:7], s61 offen offset:0  lds
  buffer_load_dwordx4 v3, s[4:7], s61 offen offset:1024  lds
  buffer_load_dwordx4 v4, s[4:7], s61 offen offset:2048  lds
  buffer_load_dwordx4 v5, s[4:7], s61 offen offset:3072  lds
  s_add_u32 s57, s57, 1
  s_cmp_eq_u32 s57, 10
  s_cselect_b32 s57, 0, s57
  s_mul_i32 s61, s64, 245760
  s_add_u32 m0, s60, 49152
  s_add_u32 s61, s61, s59
  buffer_load_dwordx4 v6, s[8:11], s61 offen offset:0  lds
  buffer_load_dwordx4 v7, s[8:11], s61 offen offset:1024  lds
  buffer_load_dwordx4 v8, s[8:11], s61 offen offset:2048  lds
  buffer_load_dwordx4 v9, s[8:11], s61 offen offset:3072  lds
  s_add_u32 s64, s64, 1
  s_cmp_eq_u32 s64, 10
  s_cselect_b32 s64, 0, s64
  s_waitcnt vmcnt(15)
  s_barrier
  s_waitcnt vmcnt(10)
  s_mov_b32 s61, 262144
Lhello_19:
  v_xor_b32 v16, s53, v16
  v_xor_b32 v17, s53, v17
  v_xor_b32 v18, s53, v18
  v_xor_b32 v19, s53, v19
  v_or3_b32 v2, v16, v17, v18
  v_or_b32 v2, v2, v19
  v_cmp_lt_u32 vcc, 15, v2
  s_nop 0
  s_cbranch_vccz Lhello_ok_20
  s_sub_u32 s61, s61, 1
  s_cbranch_scc1 Lhello_ok_20
  s_sleep 4
  buffer_load_dwordx4 v[16:19], v20, s[32:35], 0 offen sc1
  s_waitcnt vmcnt(0)
  s_branch Lhello_19
Lhello_ok_20:
  v_lshl_or_b32 v16, v17, 4, v16
  v_lshl_or_b32 v18, v19, 4, v18
  v_lshl_or_b32 v16, v18, 8, v16
  v_and_b32 v2, 1, v0
  v_readlane_b32 s61, v16, 0
  v_readlane_b32 s62, v16, 1
  v_cmp_eq_u32 vcc, 0, v2
  v_mov_b32 v3, s61
  v_mov_b32 v4, s62
  v_cndmask_b32 v3, v4, v3, vcc
  v_cmp_ne_u32 vcc, v3, v16
  v_mov_b32 v2, 159744
  s_cmp_lg_u64 vcc, 0
  s_cselect_b32 s51, 1, 0
  v_mov_b32 v3, s51
  ds_write_b32 v2, v3
  buffer_load_dword v39, v21, s[32:35], 0 offen
  buffer_load_dword v39, v23, s[32:35], 0 offen
  v_lshlrev_b32 v12, 4, v0
  s_waitcnt vmcnt(2)
  s_barrier
  s_waitcnt vmcnt(13)
  s_mov_b32 s62, 262144
Lstl_22:
  v_xor_b32 v96, v66, v70
  v_xor_b32 v97, v74, v78
  v_xor_b32 v98, s53, v66
  v_xor_b32 v99, s53, v74
  v_or3_b32 v96, v96, v97, v98
  v_or_b32 v96, v96, v99
  v_cmp_ne_u32 vcc, 0, v96
  v_add_f32 v97, v64, v68
  v_add_f32 v98, v65, v69
  s_cbranch_vccnz Lstrt_24
Lstok_23:
  v_add_f32 v99, v72, v76
  v_add_f32 v100, v73, v77
  v_add_f32 v97, v97, v99
  v_add_f32 v98, v98, v100
  s_nop 1
  v_permlane32_swap_b32 v97, v98
  s_nop 0
  v_add_f32 v97, v97, v98
  v_mul_f32 v97, 0.0015625, v97
  v_mov_b32 v98, v97
  s_nop 1
  v_permlane32_swap_b32 v97, v98
  s_nop 0
  v_fma_f32 v98, -v97, v97, v98
  v_max_f32 v98, 0, v98
  v_cvt_pk_bf16_f32 v98, v98, v98
  v_and_b32 v98, 0xffff0000, v98
  v_add_f32 v98, 0x3727c5ac, v98
  v_cvt_pk_bf16_f32 v98, v98, v98
  v_and_b32 v98, 0xffff0000, v98
  v_sqrt_f32 v98, v98
  v_xor_b32 v97, 0x80000000, v97
  s_barrier
  v_cvt_pk_bf16_f32 v98, v98, v98
  v_and_b32 v98, 0xffff0000, v98
  v_rcp_f32 v101, v98
  v_cvt_pk_bf16_f32 v100, v97, v97
  v_and_b32 v99, 31, v0
  s_lshl_b32 s62, s54, 8
  s_add_u32 s62, s62, 158208
  v_lshl_add_u32 v97, v99, 3, s62
  s_lshl_b32 s62, s54, 7
  s_add_u32 s62, s62, 131072
  v_lshl_add_u32 v98, v99, 2, s62
  v_and_b32 v100, 0xffff0000, v100
  ds_write_b64 v97, v[100:101]
  ds_write_b32 v98, v101 offset:28160
  ds_write_b32 v98, v100
  s_waitcnt lgkmcnt(0)
  s_barrier
  v_mov_b32 v2, 0x3f803f80
  v_mov_b32 v3, 0
  s_waitcnt vmcnt(10)
  v_dot2_f32_bf16 v3, v32, v2, v3
  v_dot2_f32_bf16 v3, v33, v2, v3
  v_dot2_f32_bf16 v3, v34, v2, v3
  v_dot2_f32_bf16 v3, v35, v2, v3
  v_dot2_f32_bf16 v3, v36, v2, v3
  s_nop 0
  s_nop 1
  v_add_f32_dpp v3, v3, v3 quad_perm:[1,0,3,2] row_mask:0xf bank_mask:0xf
  s_nop 1
  v_add_f32_dpp v3, v3, v3 quad_perm:[2,3,0,1] row_mask:0xf bank_mask:0xf
  s_nop 1
  v_add_f32_dpp v3, v3, v3 row_half_mirror row_mask:0xf bank_mask:0xf
  s_nop 1
  v_add_f32_dpp v3, v3, v3 row_mirror row_mask:0xf bank_mask:0xf
  v_mov_b32 v4, v3
  s_nop 1
  v_permlane16_swap_b32 v3, v4
  s_nop 0
  v_add_f32 v3, v3, v4
  v_mov_b32 v4, v3
  s_nop 1
  v_permlane32_swap_b32 v3, v4
  s_nop 0
  v_add_f32 v3, v3, v4
  v_mov_b32 v2, 159888
  ds_write_b32 v2, v3
  s_lshr_b32 s61, 0x8ccc, s3
  s_cmp_gt_u32 s50, 2
  s_cselect_b32 s61, s61, 0
  s_and_b32 s61, s61, 1
  s_cbranch_scc0 Lnohalo_25
  s_lshl_b32 s61, s50, 1
  s_add_u32 s61, s61, s54
  s_sub_u32 s61, s61, 3
  s_lshl_b32 s59, s45, 4
  s_add_u32 s61, s61, s59
  s_lshl_b32 s61, s61, 2
  s_add_u32 s61, s61, s49
  s_lshl_b32 s61, s61, 8
  s_add_u32 s61, s61, 24379392
  s_lshl_b32 s62, s54, 2
  s_add_u32 s62, s62, 159816
  v_mov_b32 v2, s62
  v_lshlrev_b32 v4, 7, v0
  v_mov_b32 v5, s53
  s_mov_b32 s59, 1048576
Llw_26:
  ds_read_b32 v3, v2
  s_waitcnt lgkmcnt(0)
  v_cmp_gt_u32 vcc, 2, v3
  s_nop 0
  s_cbranch_vccz Llwok_27
  s_sub_u32 s59, s59, 1
  s_cbranch_scc1 Llwok_27
  s_branch Llw_26
Llwok_27:
  s_mov_b64 exec, 3
  buffer_store_dword v5, v4, s[32:35], s61 offen sc1
  s_mov_b64 exec, -1
Lnohalo_25:
  s_lshr_b32 s63, s46, 3
  s_lshl_b32 s64, s45, 2
  s_add_u32 s63, s63, s64
  s_and_b32 s64, s46, 7
  v_add_u32 v96, 0, v0
  v_mul_u32_u24 v97, 6554, v96
  v_lshrrev_b32 v97, 16, v97
  v_mul_u32_u24 v98, 10, v97
  v_sub_u32 v96, v96, v98
  v_and_b32 v135, 28, v97
  v_and_b32 v98, 3, v97
  v_mul_u32_u24 v98, 1280, v98
  v_lshl_add_u32 v96, v96, 4, v98
  v_bfe_u32 v97, v97, 2, 2
  v_mul_u32_u24 v97, 10240, v97
  v_add_u32 v130, v96, v97
  v_add_u32 v96, 64, v0
  v_mul_u32_u24 v97, 6554, v96
  v_lshrrev_b32 v97, 16, v97
  v_mul_u32_u24 v98, 10, v97
  v_sub_u32 v96, v96, v98
  v_and_b32 v136, 28, v97
  v_and_b32 v98, 3, v97
  v_mul_u32_u24 v98, 1280, v98
  v_lshl_add_u32 v96, v96, 4, v98
  v_bfe_u32 v97, v97, 2, 2
  v_mul_u32_u24 v97, 10240, v97
  v_add_u32 v131, v96, v97
  v_subrev_u32 v131, 1024, v131
  v_add_u32 v96, 128, v0
  v_mul_u32_u24 v97, 6554, v96
  v_lshrrev_b32 v97, 16, v97
  v_mul_u32_u24 v98, 10, v97
  v_sub_u32 v96, v96, v98
  v_and_b32 v137, 28, v97
  v_and_b32 v98, 3, v97
  v_mul_u32_u24 v98, 1280, v98
  v_lshl_add_u32 v96, v96, 4, v98
  v_bfe_u32 v97, v97, 2, 2
  v_mul_u32_u24 v97, 10240, v97
  v_add_u32 v132, v96, v97
  v_subrev_u32 v132, 2048, v132
  v_add_u32 v96, 192, v0
  v_mul_u32_u24 v97, 6554, v96
  v_lshrrev_b32 v97, 16, v97
  v_mul_u32_u24 v98, 10, v97
  v_sub_u32 v96, v96, v98
  v_and_b32 v138, 28, v97
  v_and_b32 v98, 3, v97
  v_mul_u32_u24 v98, 1280, v98
  v_lshl_add_u32 v96, v96, 4, v98
  v_bfe_u32 v97, v97, 2, 2
  v_mul_u32_u24 v97, 10240, v97
  v_add_u32 v133, v96, v97
  v_subrev_u32 v133, 3072, v133
  v_add_u32 v96, 256, v0
  v_mul_u32_u24 v97, 6554, v96
  v_lshrrev_b32 v97, 16, v97
  v_mul_u32_u24 v98, 10, v97
  v_sub_u32 v96, v96, v98
  v_and_b32 v139, 28, v97
  v_and_b32 v98, 3, v97
  v_mul_u32_u24 v98, 1280, v98
  v_lshl_add_u32 v96, v96, 4, v98
  v_bfe_u32 v97, v97, 2, 2
  v_mul_u32_u24 v97, 10240, v97
  v_add_u32 v134, v96, v97
  s_lshr_b32 s61, s46, 3
  s_mul_i32 s61, s61, 5
  s_lshr_b32 s61, s61, 1
  s_add_u32 s61, s61, s54
  s_sub_u32 s65, s61, 2
  v_mov_b32 v96, 5120
  s_add_u32 s61, s65, 0
  s_sub_u32 s62, s61, 10
  s_cselect_b32 s61, s61, s62
  s_sub_u32 s62, s61, 5
  s_cselect_b32 s62, s61, s62
  s_mul_i32 s71, s61, 40960
  s_sub_u32 s71, s71, 10240
  s_mov_b32 s70, 0x37341212
  s_cmp_eq_u32 s62, 1
  s_cselect_b32 s70, 0x73422120, s70
  s_cmp_eq_u32 s62, 2
  s_cselect_b32 s70, 0x34231201, s70
  s_cmp_eq_u32 s62, 3
  s_cselect_b32 s70, 0x42372012, s70
  s_cmp_eq_u32 s62, 4
  s_cselect_b32 s70, 0x23730121, s70
  v_bfe_u32 v97, s70, v135, 4
  v_mad_u32_u24 v97, v97, v96, v130
  v_add_u32 v140, s71, v97
  v_bfe_u32 v97, s70, v136, 4
  v_mad_u32_u24 v97, v97, v96, v131
  v_add_u32 v141, s71, v97
  v_bfe_u32 v97, s70, v137, 4
  v_mad_u32_u24 v97, v97, v96, v132
  v_add_u32 v142, s71, v97
  v_bfe_u32 v97, s70, v138, 4
  v_mad_u32_u24 v97, v97, v96, v133
  v_add_u32 v143, s71, v97
  v_bfe_u32 v97, s70, v139, 4
  v_mad_u32_u24 v97, v97, v96, v134
  v_add_u32 v144, s71, v97
  s_add_u32 s61, s65, 2
  s_sub_u32 s62, s61, 10
  s_cselect_b32 s61, s61, s62
  s_sub_u32 s62, s61, 5
  s_cselect_b32 s62, s61, s62
  s_mul_i32 s71, s61, 40960
  s_sub_u32 s71, s71, 10240
  s_mov_b32 s70, 0x37341212
  s_cmp_eq_u32 s62, 1
  s_cselect_b32 s70, 0x73422120, s70
  s_cmp_eq_u32 s62, 2
  s_cselect_b32 s70, 0x34231201, s70
  s_cmp_eq_u32 s62, 3
  s_cselect_b32 s70, 0x42372012, s70
  s_cmp_eq_u32 s62, 4
  s_cselect_b32 s70, 0x23730121, s70
  v_bfe_u32 v97, s70, v135, 4
  v_mad_u32_u24 v97, v97, v96, v130
  v_add_u32 v145, s71, v97
  v_bfe_u32 v97, s70, v136, 4
  v_mad_u32_u24 v97, v97, v96, v131
  v_add_u32 v146, s71, v97
  v_bfe_u32 v97, s70, v137, 4
  v_mad_u32_u24 v97, v97, v96, v132
  v_add_u32 v147, s71, v97
  v_bfe_u32 v97, s70, v138, 4
  v_mad_u32_u24 v97, v97, v96, v133
  v_add_u32 v148, s71, v97
  v_bfe_u32 v97, s70, v139, 4
  v_mad_u32_u24 v97, v97, v96, v134
  v_add_u32 v149, s71, v97
  s_add_u32 s61, s65, 4
  s_sub_u32 s62, s61, 10
  s_cselect_b32 s61, s61, s62
  s_sub_u32 s62, s61, 5
  s_cselect_b32 s62, s61, s62
  s_mul_i32 s71, s61, 40960
  s_sub_u32 s71, s71, 10240
  s_mov_b32 s70, 0x37341212
  s_cmp_eq_u32 s62, 1
  s_cselect_b32 s70, 0x73422120, s70
  s_cmp_eq_u32 s62, 2
  s_cselect_b32 s70, 0x34231201, s70
  s_cmp_eq_u32 s62, 3
  s_cselect_b32 s70, 0x42372012, s70
  s_cmp_eq_u32 s62, 4
  s_cselect_b32 s70, 0x23730121, s70
  v_bfe_u32 v97, s70, v135, 4
  v_mad_u32_u24 v97, v97, v96, v130
  v_add_u32 v150, s71, v97
  v_bfe_u32 v97, s70, v136, 4
  v_mad_u32_u24 v97, v97, v96, v131
  v_add_u32 v151, s71, v97
  v_bfe_u32 v97, s70, v137, 4
  v_mad_u32_u24 v97, v97, v96, v132
  v_add_u32 v152, s71, v97
  v_bfe_u32 v97, s70, v138, 4
  v_mad_u32_u24 v97, v97, v96, v133
  v_add_u32 v153, s71, v97
  v_bfe_u32 v97, s70, v139, 4
  v_mad_u32_u24 v97, v97, v96, v134
  v_add_u32 v154, s71, v97
  s_add_u32 s61, s65, 6
  s_sub_u32 s62, s61, 10
  s_cselect_b32 s61, s61, s62
  s_sub_u32 s62, s61, 5
  s_cselect_b32 s62, s61, s62
  s_mul_i32 s71, s61, 40960
  s_sub_u32 s71, s71, 10240
  s_mov_b32 s70, 0x37341212
  s_cmp_eq_u32 s62, 1
  s_cselect_b32 s70, 0x73422120, s70
  s_cmp_eq_u32 s62, 2
  s_cselect_b32 s70, 0x34231201, s70
  s_cmp_eq_u32 s62, 3
  s_cselect_b32 s70, 0x42372012, s70
  s_cmp_eq_u32 s62, 4
  s_cselect_b32 s70, 0x23730121, s70
  v_bfe_u32 v97, s70, v135, 4
  v_mad_u32_u24 v97, v97, v96, v130
  v_add_u32 v155, s71, v97
  v_bfe_u32 v97, s70, v136, 4
  v_mad_u32_u24 v97, v97, v96, v131
  v_add_u32 v156, s71, v97
  v_bfe_u32 v97, s70, v137, 4
  v_mad_u32_u24 v97, v97, v96, v132
  v_add_u32 v157, s71, v97
  v_bfe_u32 v97, s70, v138, 4
  v_mad_u32_u24 v97, v97, v96, v133
  v_add_u32 v158, s71, v97
  v_bfe_u32 v97, s70, v139, 4
  v_mad_u32_u24 v97, v97, v96, v134
  v_add_u32 v159, s71, v97
  s_add_u32 s61, s65, 8
  s_sub_u32 s62, s61, 10
  s_cselect_b32 s61, s61, s62
  s_sub_u32 s62, s61, 5
  s_cselect_b32 s62, s61, s62
  s_mul_i32 s71, s61, 40960
  s_sub_u32 s71, s71, 10240
  s_mov_b32 s70, 0x37341212
  s_cmp_eq_u32 s62, 1
  s_cselect_b32 s70, 0x73422120, s70
  s_cmp_eq_u32 s62, 2
  s_cselect_b32 s70, 0x34231201, s70
  s_cmp_eq_u32 s62, 3
  s_cselect_b32 s70, 0x42372012, s70
  s_cmp_eq_u32 s62, 4
  s_cselect_b32 s70, 0x23730121, s70
  v_bfe_u32 v97, s70, v135, 4
  v_mad_u32_u24 v97, v97, v96, v130
  v_add_u32 v160, s71, v97
  v_bfe_u32 v97, s70, v136, 4
  v_mad_u32_u24 v97, v97, v96, v131
  v_add_u32 v161, s71, v97
  v_bfe_u32 v97, s70, v137, 4
  v_mad_u32_u24 v97, v97, v96, v132
  v_add_u32 v162, s71, v97
  v_bfe_u32 v97, s70, v138, 4
  v_mad_u32_u24 v97, v97, v96, v133
  v_add_u32 v163, s71, v97
  v_bfe_u32 v97, s70, v139, 4
  v_mad_u32_u24 v97, v97, v96, v134
  v_add_u32 v164, s71, v97
  s_add_u32 s61, s2, s54
  s_cmp_lg_u32 s61, 2
  s_cbranch_scc1 Lnoep_21
  s_add_u32 s61, s52, 1
  v_mov_b32 v2, 19406848
  v_mov_b32 v3, s61
  s_mov_b64 exec, 1
  buffer_store_dword v3, v2, s[32:35], 0 offen sc1
  s_mov_b64 exec, -1
Lnoep_21:
  v_mov_b32 v2, 159808
  s_mov_b32 s61, 1048576
Llw_28:
  ds_read_b32 v3, v2
  s_waitcnt lgkmcnt(0)
  v_cmp_gt_u32 vcc, 4, v3
  s_nop 0
  s_cbranch_vccz Llwok_29
  s_sub_u32 s61, s61, 1
  s_cbranch_scc1 Llwok_29
  s_sleep 1
  s_branch Llw_28
Llwok_29:
  s_xor_b32 s61, s48, 0
  s_mul_i32 s55, s61, 409600
  s_mul_i32 s57, s61, 51200
  s_add_u32 s57, s57, 55296
  s_mul_i32 s61, s64, 160
  s_add_u32 s55, s55, s61
  s_add_u32 s61, s65, 0
  s_sub_u32 s62, s61, 10
  s_cselect_b32 s61, s61, s62
  s_mul_i32 s56, s61, 5120
  s_add_u32 s56, s56, s57
  s_mov_b32 m0, s56
  s_nop 0
  buffer_load_dwordx4 v140, s[12:15], s55 offen offset:0  lds
  buffer_load_dwordx4 v141, s[12:15], s55 offen offset:1024  lds
  buffer_load_dwordx4 v142, s[12:15], s55 offen offset:2048  lds
  buffer_load_dwordx4 v143, s[12:15], s55 offen offset:3072  lds
  s_add_u32 m0, s56, 4096
  s_nop 0
  buffer_load_dwordx4 v144, s[12:15], s55 offen offset:0  lds
  s_add_u32 s61, s65, 2
  s_sub_u32 s62, s61, 10
  s_cselect_b32 s61, s61, s62
  s_mul_i32 s56, s61, 5120
  s_add_u32 s56, s56, s57
  s_mov_b32 m0, s56
  s_nop 0
  buffer_load_dwordx4 v145, s[12:15], s55 offen offset:0  lds
  buffer_load_dwordx4 v146, s[12:15], s55 offen offset:1024  lds
  buffer_load_dwordx4 v147, s[12:15], s55 offen offset:2048  lds
  buffer_load_dwordx4 v148, s[12:15], s55 offen offset:3072  lds
  s_add_u32 m0, s56, 4096
  s_nop 0
  buffer_load_dwordx4 v149, s[12:15], s55 offen offset:0  lds
  ds_read_b32 v3, v2 offset:112
  s_waitcnt lgkmcnt(0)
  v_cmp_gt_u32 vcc, 1, v3
  s_nop 0
  s_cbranch_vccz Lwog_30
  s_waitcnt vmcnt(1)
Lwog_30:
  s_add_u32 s61, s65, 4
  s_sub_u32 s62, s61, 10
  s_cselect_b32 s61, s61, s62
  s_mul_i32 s56, s61, 5120
  s_add_u32 s56, s56, s57
  s_mov_b32 m0, s56
  s_nop 0
  buffer_load_dwordx4 v150, s[12:15], s55 offen offset:0  lds
  buffer_load_dwordx4 v151, s[12:15], s55 offen offset:1024  lds
  buffer_load_dwordx4 v152, s[12:15], s55 offen offset:2048  lds
  buffer_load_dwordx4 v153, s[12:15], s55 offen offset:3072  lds
  s_add_u32 m0, s56, 4096
  s_nop 0
  buffer_load_dwordx4 v154, s[12:15], s55 offen offset:0  lds
  ds_read_b32 v3, v2 offset:112
  s_waitcnt lgkmcnt(0)
  v_cmp_gt_u32 vcc, 1, v3
  s_nop 0
  s_cbranch_vccz Lwog_31
  s_waitcnt vmcnt(1)
Lwog_31:
  s_waitcnt vmcnt(7)
  s_add_u32 s61, s65, 6
  s_sub_u32 s62, s61, 10
  s_cselect_b32 s61, s61, s62
  s_mul_i32 s56, s61, 5120
  s_add_u32 s56, s56, s57
  s_mov_b32 m0, s56
  s_nop 0
  buffer_load_dwordx4 v155, s[12:15], s55 offen offset:0  lds
  buffer_load_dwordx4 v156, s[12:15], s55 offen offset:1024  lds
  buffer_load_dwordx4 v157, s[12:15], s55 offen offset:2048  lds
  buffer_load_dwordx4 v158, s[12:15], s55 offen offset:3072  lds
  s_add_u32 m0, s56, 4096
  s_nop 0
  buffer_load_dwordx4 v159, s[12:15], s55 offen offset:0  lds
  ds_read_b32 v3, v2 offset:112
  s_waitcnt lgkmcnt(0)
  v_cmp_gt_u32 vcc, 1, v3
  s_nop 0
  s_cbranch_vccz Lwog_32
  s_waitcnt vmcnt(1)
Lwog_32:
  s_waitcnt vmcnt(7)
  s_add_u32 s61, s65, 8
  s_sub_u32 s62, s61, 10
  s_cselect_b32 s61, s61, s62
  s_mul_i32 s56, s61, 5120
  s_add_u32 s56, s56, s57
  s_mov_b32 m0, s56
  s_nop 0
  buffer_load_dwordx4 v160, s[12:15], s55 offen offset:0  lds
  buffer_load_dwordx4 v161, s[12:15], s55 offen offset:1024  lds
  buffer_load_dwordx4 v162, s[12:15], s55 offen offset:2048  lds
  buffer_load_dwordx4 v163, s[12:15], s55 offen offset:3072  lds
  s_add_u32 m0, s56, 4096
  s_nop 0
  buffer_load_dwordx4 v164, s[12:15], s55 offen offset:0  lds
  ds_read_b32 v3, v2 offset:112
  s_waitcnt lgkmcnt(0)
  v_cmp_gt_u32 vcc, 1, v3
  s_nop 0
  s_cbranch_vccz Lwog_33
  s_waitcnt vmcnt(1)
Lwog_33:
  s_waitcnt vmcnt(7)
  s_xor_b32 s61, s48, 1
  s_mul_i32 s55, s61, 409600
  s_mul_i32 s57, s61, 51200
  s_add_u32 s57, s57, 55296
  s_mul_i32 s61, s64, 160
  s_add_u32 s55, s55, s61
  s_add_u32 s61, s65, 0
  s_sub_u32 s62, s61, 10
  s_cselect_b32 s61, s61, s62
  s_mul_i32 s56, s61, 5120
  s_add_u32 s56, s56, s57
  s_mov_b32 m0, s56
  s_nop 0
  buffer_load_dwordx4 v140, s[12:15], s55 offen offset:0  lds
  buffer_load_dwordx4 v141, s[12:15], s55 offen offset:1024  lds
  buffer_load_dwordx4 v142, s[12:15], s55 offen offset:2048  lds
  buffer_load_dwordx4 v143, s[12:15], s55 offen offset:3072  lds
  s_add_u32 m0, s56, 4096
  s_nop 0
  buffer_load_dwordx4 v144, s[12:15], s55 offen offset:0  lds
  ds_read_b32 v3, v2 offset:112
  s_waitcnt lgkmcnt(0)
  v_cmp_gt_u32 vcc, 1, v3
  s_nop 0
  s_cbranch_vccz Lwog_34
  s_waitcnt vmcnt(1)
Lwog_34:
  s_waitcnt vmcnt(7)
  s_add_u32 s61, s65, 2
  s_sub_u32 s62, s61, 10
  s_cselect_b32 s61, s61, s62
  s_mul_i32 s56, s61, 5120
  s_add_u32 s56, s56, s57
  s_mov_b32 m0, s56
  s_nop 0
  buffer_load_dwordx4 v145, s[12:15], s55 offen offset:0  lds
  buffer_load_dwordx4 v146, s[12:15], s55 offen offset:1024  lds
  buffer_load_dwordx4 v147, s[12:15], s55 offen offset:2048  lds
  buffer_load_dwordx4 v148, s[12:15], s55 offen offset:3072  lds
  s_add_u32 m0, s56, 4096
  s_nop 0
  buffer_load_dwordx4 v149, s[12:15], s55 offen offset:0  lds
  ds_read_b32 v3, v2 offset:112
  s_waitcnt lgkmcnt(0)
  v_cmp_gt_u32 vcc, 1, v3
  s_nop 0
  s_cbranch_vccz Lwog_35
  s_waitcnt vmcnt(4)
Lwog_35:
  s_waitcnt vmcnt(10)
  s_add_u32 s61, s65, 4
  s_sub_u32 s62, s61, 10
  s_cselect_b32 s61, s61, s62
  s_mul_i32 s56, s61, 5120
  s_add_u32 s56, s56, s57
  s_mov_b32 m0, s56
  s_nop 0
  buffer_load_dwordx4 v150, s[12:15], s55 offen offset:0  lds
  buffer_load_dwordx4 v151, s[12:15], s55 offen offset:1024  lds
  s_waitcnt vmcnt(12)
  v_mov_b32 v4, 159848
  v_mov_b32 v5, 1
  s_mov_b64 exec, 1
  ds_add_u32 v4, v5
  s_mov_b64 exec, -1
  s_waitcnt vmcnt(7)
  buffer_load_dwordx4 v152, s[12:15], s55 offen offset:2048  lds
  buffer_load_dwordx4 v153, s[12:15], s55 offen offset:3072  lds
  s_add_u32 m0, s56, 4096
  s_nop 0
  buffer_load_dwordx4 v154, s[12:15], s55 offen offset:0  lds
  s_add_u32 s61, s65, 6
  s_sub_u32 s62, s61, 10
  s_cselect_b32 s61, s61, s62
  s_mul_i32 s56, s61, 5120
  s_add_u32 s56, s56, s57
  s_mov_b32 m0, s56
  s_nop 0
  buffer_load_dwordx4 v155, s[12:15], s55 offen offset:0  lds
  buffer_load_dwordx4 v156, s[12:15], s55 offen offset:1024  lds
  s_waitcnt vmcnt(7)
  buffer_load_dwordx4 v157, s[12:15], s55 offen offset:2048  lds
  buffer_load_dwordx4 v158, s[12:15], s55 offen offset:3072  lds
  s_add_u32 m0, s56, 4096
  s_nop 0
  buffer_load_dwordx4 v159, s[12:15], s55 offen offset:0  lds
  s_add_u32 s61, s65, 8
  s_sub_u32 s62, s61, 10
  s_cselect_b32 s61, s61, s62
  s_mul_i32 s56, s61, 5120
  s_add_u32 s56, s56, s57
  s_mov_b32 m0, s56
  s_nop 0
  buffer_load_dwordx4 v160, s[12:15], s55 offen offset:0  lds
  buffer_load_dwordx4 v161, s[12:15], s55 offen offset:1024  lds
  s_waitcnt vmcnt(7)
  buffer_load_dwordx4 v162, s[12:15], s55 offen offset:2048  lds
  buffer_load_dwordx4 v163, s[12:15], s55 offen offset:3072  lds
  s_add_u32 m0, s56, 4096
  s_nop 0
  buffer_load_dwordx4 v164, s[12:15], s55 offen offset:0  lds
  v_mov_b32 v4, 159872
  v_mov_b32 v5, 1
  s_mov_b64 exec, 1
  ds_add_u32 v4, v5
  s_mov_b64 exec, -1
  s_waitcnt vmcnt(0)
  v_mov_b32 v4, 159880
  v_mov_b32 v5, 1
  s_mov_b64 exec, 1
  ds_add_u32 v4, v5
  s_mov_b64 exec, -1
L_mw:
  s_cmp_ge_u32 s39, 17
  s_cbranch_scc1 Lmwpl_39
  v_bfe_u32 v2, v0, 3, 2
  v_lshrrev_b32 v3, 5, v0
  v_lshlrev_b32 v2, 1, v2
  v_add_lshl_u32 v2, v2, v3, 2
  v_bfe_u32 v3, v0, 1, 2
  v_add_u32 v2, v2, v3
  v_and_b32 v3, 1, v0
  v_lshlrev_b32 v3, 4, v3
  s_cmp_lt_u32 s39, 12
  s_cbranch_scc1 Lmwgu_36
  v_mul_u32_u24 v2, 1280, v2
  v_add_u32 v12, v2, v3
  s_mul_i32 s61, s45, 5
  s_add_u32 s61, s61, s39
  s_sub_u32 s61, s61, 12
  s_lshl_b32 s61, s61, 5
  s_mul_i32 s62, s54, 491520
  s_add_u32 s61, s61, s62
  v_mov_b32 v6, 159852
  s_mov_b32 s59, 1048576
Llw_40:
  ds_read_b32 v7, v6
  s_waitcnt lgkmcnt(0)
  v_cmp_gt_u32 vcc, 4, v7
  s_nop 0
  s_cbranch_vccz Llwok_41
  s_sub_u32 s59, s59, 1
  s_cbranch_scc1 Llwok_41
  s_sleep 2
  s_branch Llw_40
Llwok_41:
  buffer_load_dwordx4 v[40:43], v12, s[24:27], s61 offen
  s_add_u32 s61, s61, 40960
  buffer_load_dwordx4 v[44:47], v12, s[24:27], s61 offen
  s_add_u32 s61, s61, 40960
  buffer_load_dwordx4 v[48:51], v12, s[24:27], s61 offen
  s_add_u32 s61, s61, 40960
  buffer_load_dwordx4 v[52:55], v12, s[24:27], s61 offen
  s_add_u32 s61, s61, 40960
  buffer_load_dwordx4 v[56:59], v12, s[24:27], s61 offen
  s_add_u32 s61, s61, 40960
  buffer_load_dwordx4 v[60:63], v12, s[24:27], s61 offen
  s_add_u32 s61, s61, 40960
  buffer_load_dwordx4 v[64:67], v12, s[24:27], s61 offen
  s_add_u32 s61, s61, 40960
  buffer_load_dwordx4 v[68:71], v12, s[24:27], s61 offen
  s_add_u32 s61, s61, 40960
  buffer_load_dwordx4 v[72:75], v12, s[24:27], s61 offen
  s_add_u32 s61, s61, 40960
  buffer_load_dwordx4 v[76:79], v12, s[24:27], s61 offen
  s_add_u32 s61, s61, 40960
  buffer_load_dwordx4 v[80:83], v12, s[24:27], s61 offen
  s_add_u32 s61, s61, 40960
  buffer_load_dwordx4 v[84:87], v12, s[24:27], s61 offen
  s_mul_i32 s62, s54, 12288
  s_branch Lmwwr_37
Lmwpl_39:
  s_cmp_ge_u32 s39, 28
  s_cbranch_scc1 Lmwend_38
  v_mov_b32 v6, 159884
  s_mov_b32 s59, 1048576
Llw_42:
  ds_read_b32 v7, v6
  s_waitcnt lgkmcnt(0)
  v_cmp_gt_u32 vcc, 4, v7
  s_nop 0
  s_cbranch_vccz Llwok_43
  s_sub_u32 s59, s59, 1
  s_cbranch_scc1 Llwok_43
  s_sleep 2
  s_branch Llw_42
Llwok_43:
  buffer_load_dword v39, v25, s[24:27], 0 offen
  s_mov_b64 exec, 63
  buffer_load_dword v39, v27, s[24:27], 0 offen
  s_mov_b64 exec, -1
  s_branch Lmwend_38
Lmwgu_36:
  v_mul_u32_u24 v2, 3072, v2
  v_add_u32 v12, v2, v3
  s_mul_i32 s61, s45, 12
  s_add_u32 s61, s61, s39
  s_lshl_b32 s61, s61, 5
  s_mul_i32 s62, s54, 491520
  s_add_u32 s61, s61, s62
  v_mov_b32 v6, 159840
  s_mov_b32 s59, 1048576
Llw_44:
  ds_read_b32 v7, v6
  s_waitcnt lgkmcnt(0)
  v_cmp_gt_u32 vcc, 4, v7
  s_nop 0
  s_cbranch_vccz Llwok_45
  s_sub_u32 s59, s59, 1
  s_cbranch_scc1 Llwok_45
  s_sleep 2
  s_branch Llw_44
Llwok_45:
  buffer_load_dwordx4 v[40:43], v12, s[16:19], s61 offen
  buffer_load_dwordx4 v[44:47], v12, s[20:23], s61 offen
  s_add_u32 s61, s61, 98304
  buffer_load_dwordx4 v[48:51], v12, s[16:19], s61 offen
  buffer_load_dwordx4 v[52:55], v12, s[20:23], s61 offen
  s_add_u32 s61, s61, 98304
  buffer_load_dwordx4 v[56:59], v12, s[16:19], s61 offen
  buffer_load_dwordx4 v[60:63], v12, s[20:23], s61 offen
  s_add_u32 s61, s61, 98304
  buffer_load_dwordx4 v[64:67], v12, s[16:19], s61 offen
  buffer_load_dwordx4 v[68:71], v12, s[20:23], s61 offen
  s_add_u32 s61, s61, 98304
  buffer_load_dwordx4 v[72:75], v12, s[16:19], s61 offen
  buffer_load_dwordx4 v[76:79], v12, s[20:23], s61 offen
  s_mul_i32 s62, s54, 12288
Lmwwr_37:
  v_lshl_add_u32 v2, v0, 4, s62
  v_mov_b32 v6, 159844
  s_mov_b32 s59, 1048576
Llw_46:
  ds_read_b32 v7, v6
  s_waitcnt lgkmcnt(0)
  v_cmp_gt_u32 vcc, 4, v7
  s_nop 0
  s_cbranch_vccz Llwok_47
  s_sub_u32 s59, s59, 1
  s_cbranch_scc1 Llwok_47
  s_sleep 2
  s_branch Llw_46
Llwok_47:
  s_waitcnt vmcnt(0)
  ds_write_b128 v2, v[40:43] offset:0
  ds_write_b128 v2, v[44:47] offset:1024
  ds_write_b128 v2, v[48:51] offset:2048
  ds_write_b128 v2, v[52:55] offset:3072
  ds_write_b128 v2, v[56:59] offset:4096
  ds_write_b128 v2, v[60:63] offset:5120
  ds_write_b128 v2, v[64:67] offset:6144
  ds_write_b128 v2, v[68:71] offset:7168
  ds_write_b128 v2, v[72:75] offset:8192
  ds_write_b128 v2, v[76:79] offset:9216
  ds_write_b128 v2, v[80:83] offset:10240
  ds_write_b128 v2, v[84:87] offset:11264
  s_lshl_b32 s61, s54, 2
  s_add_u32 s61, s61, 159856
  v_mov_b32 v2, s61
  ds_write_b32 v2, v2
  s_waitcnt lgkmcnt(0)
Lmwend_38:
  s_endpgm
.p2alignl 12, 0xbf810000
L_comp:
  s_waitcnt lgkmcnt(0)
  s_mov_b32 s53, 19406848
  s_load_dword s52, s[32:33], s53
  s_load_dwordx2 s[40:41], s[0:1], 32
  s_load_dwordx2 s[28:29], s[0:1], 64
  s_mov_b32 s34, 268435456
  s_mov_b32 s35, 0x20000
  s_mov_b32 s42, 1280
  s_mov_b32 s43, 0x20000
  s_mov_b32 s30, 2621440
  s_mov_b32 s31, 0x20000
  s_mov_b32 s76, -1
  s_mov_b32 s77, 0
  s_mov_b32 s78, 0xfffff
  s_mov_b32 s79, 0xfffff
  s_mov_b32 s6, 2621440
  s_mov_b32 s7, 0x20000
  s_lshr_b32 s63, s46, 3
  s_lshl_b32 s64, s45, 2
  s_add_u32 s63, s63, s64
  s_and_b32 s64, s46, 7
  v_and_b32 v2, 15, v0
  v_lshrrev_b32 v3, 4, v0
  v_mul_u32_u24 v225, 40, v3
  v_mov_b32 v5, 1280
  v_mad_u32_u24 v196, v2, v5, v225
  s_lshl_b32 s61, s63, 2
  s_add_u32 s61, s61, s44
  s_mul_i32 s61, s61, 20480
  s_mul_i32 s17, s64, 160
  s_add_u32 s16, s61, s17
  v_lshlrev_b32 v197, 7, v2
  v_lshl_add_u32 v197, v3, 5, v197
  v_lshlrev_b32 v227, 7, v2
  v_mul_u32_u24 v4, 640, v3
  v_bfe_u32 v5, v0, 2, 2
  v_mul_u32_u24 v5, 160, v5
  v_and_b32 v6, 3, v0
  v_mul_u32_u24 v6, 40, v6
  v_add3_u32 v4, v4, v5, v6
  s_mul_i32 s61, s48, 51200
  s_add_u32 s62, s61, 55296
  v_add_u32 v198, s62, v4
  s_sub_u32 s62, 106496, s61
  v_add_u32 v199, s62, v4
  v_and_b32 v4, 7, v0
  v_mul_u32_u24 v4, 1280, v4
  v_bfe_u32 v5, v0, 3, 1
  v_lshl_add_u32 v222, v5, 7, v4
  v_mul_u32_u24 v4, 6554, v0
  v_lshrrev_b32 v4, 16, v4
  v_mul_u32_u24 v4, 1120, v4
  v_lshl_add_u32 v219, v0, 4, v4
  s_mul_i32 s62, s44, 2560
  s_add_u32 s62, s62, 0
  v_mul_u32_u24 v4, 160, v2
  v_add3_u32 v223, v4, v225, s62
  v_add_u32 v225, 158208, v225
  s_and_b32 s62, s44, 1
  s_mul_i32 s62, s62, 25600
  v_add_u32 v198, s62, v198
  v_add_u32 v199, s62, v199
  s_lshr_b32 s62, s44, 1
  s_mul_i32 s62, s62, 10240
  s_add_u32 s61, s61, s62
  s_and_b32 s62, s44, 1
  s_lshl_b32 s62, s62, 10
  s_add_u32 s61, s61, s62
  s_add_u32 s61, s61, 55296
  v_lshlrev_b32 v221, 4, v0
  v_add_u32 v222, s61, v221
  v_add_u32 v221, 4096, v221
  s_lshr_b32 s55, s46, 1
  s_and_b32 s56, s46, 1
  s_and_b32 s57, s55, 1
  s_lshr_b32 s58, s55, 1
  s_lshl_b32 s59, s48, 3
  s_add_u32 s58, s58, s59
  s_lshl_b32 s59, s48, 4
  s_add_u32 s59, s59, s55
  s_lshl_b32 s60, s47, 1
  s_add_u32 s60, s60, s56
  s_lshl_b32 s60, s60, 3
  s_lshr_b32 s74, s46, 3
  s_sub_u32 s39, s46, s74
  s_sub_u32 s39, s39, 1
  s_add_u32 s74, s74, 28
  s_and_b32 s75, s46, 7
  s_cselect_b32 s39, s39, s74
  v_mov_b32 v255, 0x207
  s_lshr_b32 s61, s55, 1
  s_mul_i32 s61, s61, 5
  s_lshl_b32 s62, s57, 1
  s_add_u32 s61, s61, s62
  s_add_u32 s62, s61, 2
  s_lshr_b32 s61, s61, 3
  s_lshr_b32 s62, s62, 3
  s_lshl_b32 s62, s62, 4
  s_or_b32 s61, s61, s62
  s_add_u32 s62, s61, 0x55
  s_lshl_b32 s71, s62, 8
  s_or_b32 s61, s71, s61
  s_mul_i32 s62, s55, 20
  s_add_u32 s71, s62, 19
  s_lshr_b32 s62, s62, 6
  s_lshr_b32 s71, s71, 6
  s_lshl_b32 s71, s71, 4
  s_or_b32 s62, s62, s71
  s_add_u32 s62, s62, 0xaa
  s_lshl_b32 s62, s62, 16
  s_or_b32 s61, s61, s62
  v_and_b32 v2, 60, v0
  v_min_u32 v2, 20, v2
  v_bfe_u32 v2, s61, v2, 4
  v_and_b32 v251, 3, v0
  v_lshlrev_b32 v251, 2, v251
  v_lshl_add_u32 v251, v2, 7, v251
  s_lshl_b32 s18, s45, 11
  s_lshl_b32 s61, s56, 4
  v_mov_b32 v2, s61
  v_cmp_gt_u32 vcc, 8, v0
  s_add_u32 s18, s18, 19529728
  s_mov_b32 s75, 1024
  v_cndmask_b32 v2, 8, v2, vcc
  v_add_u32 v251, v251, v2
  v_lshlrev_b32 v246, 4, v0
  v_lshrrev_b32 v2, 5, v0
  v_mul_u32_u24 v2, 2048, v2
  v_add3_u32 v247, v246, v2, s75
  s_lshl_b32 s61, s56, 10
  s_add_u32 s62, s61, 10240
  v_add_u32 v248, s62, v246
  s_sub_u32 s62, 11264, s61
  v_add_u32 v216, s62, v246
  v_and_b32 v2, 31, v0
  v_lshrrev_b32 v3, 5, v0
  v_xor_b32 v4, s57, v3
  v_lshlrev_b32 v4, 3, v4
  v_lshl_add_u32 v4, v2, 4, v4
  s_lshl_b32 s61, s56, 9
  s_add_u32 s62, s61, 12288
  v_add_u32 v249, s62, v4
  s_sub_u32 s62, 12800, s61
  v_add_u32 v217, s62, v4
  v_mul_u32_u24 v4, 320, v3
  v_lshl_add_u32 v4, v2, 4, v4
  s_mul_i32 s61, s56, 1280
  s_add_u32 s62, s61, 13312
  v_add_u32 v250, s62, v4
  s_sub_u32 s62, 14592, s61
  v_add_u32 v218, s62, v4
  v_lshlrev_b32 v4, 2, v3
  v_sub_u32 v4, v2, v4
  s_cmp_eq_u32 s56, 0
  s_cselect_b32 s61, 0xff800000, 0
  s_cselect_b32 s62, 0, 0xff800000
  v_mov_b32 v5, s61
  v_mov_b32 v6, s62
  v_cmp_le_i32 s[72:73], 0, v4
  v_cmp_le_i32 s[74:75], 1, v4
  s_nop 0
  v_cndmask_b32 v200, v5, v6, s[72:73]
  v_cndmask_b32 v230, v6, v5, s[72:73]
  v_cmp_le_i32 s[72:73], 2, v4
  v_cndmask_b32 v201, v5, v6, s[74:75]
  v_cndmask_b32 v231, v6, v5, s[74:75]
  v_cmp_le_i32 s[74:75], 3, v4
  v_cndmask_b32 v202, v5, v6, s[72:73]
  v_cndmask_b32 v232, v6, v5, s[72:73]
  v_cmp_le_i32 s[72:73], 8, v4
  v_cndmask_b32 v203, v5, v6, s[74:75]
  v_cndmask_b32 v233, v6, v5, s[74:75]
  v_cmp_le_i32 s[74:75], 9, v4
  v_cndmask_b32 v204, v5, v6, s[72:73]
  v_cndmask_b32 v234, v6, v5, s[72:73]
  v_cmp_le_i32 s[72:73], 10, v4
  v_cndmask_b32 v205, v5, v6, s[74:75]
  v_cndmask_b32 v235, v6, v5, s[74:75]
  v_cmp_le_i32 s[74:75], 11, v4
  v_cndmask_b32 v206, v5, v6, s[72:73]
  v_cndmask_b32 v236, v6, v5, s[72:73]
  v_cmp_le_i32 s[72:73], 16, v4
  v_cndmask_b32 v207, v5, v6, s[74:75]
  v_cndmask_b32 v237, v6, v5, s[74:75]
  v_cmp_le_i32 s[74:75], 17, v4
  v_cndmask_b32 v208, v5, v6, s[72:73]
  v_cndmask_b32 v238, v6, v5, s[72:73]
  v_cmp_le_i32 s[72:73], 18, v4
  v_cndmask_b32 v209, v5, v6, s[74:75]
  v_cndmask_b32 v239, v6, v5, s[74:75]
  v_cmp_le_i32 s[74:75], 19, v4
  v_cndmask_b32 v210, v5, v6, s[72:73]
  v_cndmask_b32 v240, v6, v5, s[72:73]
  v_cmp_le_i32 s[72:73], 24, v4
  v_cndmask_b32 v211, v5, v6, s[74:75]
  v_cndmask_b32 v241, v6, v5, s[74:75]
  v_cmp_le_i32 s[74:75], 25, v4
  v_cndmask_b32 v212, v5, v6, s[72:73]
  v_cndmask_b32 v242, v6, v5, s[72:73]
  v_cmp_le_i32 s[72:73], 26, v4
  v_cndmask_b32 v213, v5, v6, s[74:75]
  v_cndmask_b32 v243, v6, v5, s[74:75]
  v_cmp_le_i32 s[74:75], 27, v4
  v_cndmask_b32 v214, v5, v6, s[72:73]
  v_cndmask_b32 v244, v6, v5, s[72:73]
  s_nop 0
  v_cndmask_b32 v215, v5, v6, s[74:75]
  v_cndmask_b32 v245, v6, v5, s[74:75]
  v_cmp_eq_u32 s[74:75], 20, v2
  v_cmp_eq_u32 vcc, 24, v2
  s_mov_b32 s22, s57
  s_or_b64 s[8:9], vcc, s[74:75]
  v_bfe_u32 v4, v0, 4, 1
  v_mul_u32_u24 v4, 20480, v4
  v_lshl_add_u32 v4, v3, 8, v4
  v_and_b32 v5, 15, v0
  v_lshl_add_u32 v252, v5, 4, v4
  s_xor_b32 s24, s56, s48
  s_mov_b32 s23, s60
  s_lshl_b32 s61, s44, 1
  s_sub_u32 s61, 7, s61
  v_mul_u32_u24 v4, s61, v0
  s_add_u32 s61, s60, s44
  v_add_lshl_u32 v226, v4, s61, 12
  s_lshl_b32 s61, s59, 7
  s_add_u32 s61, s61, 24117248
  v_add_u32 v226, s61, v226
  s_sub_u32 s61, 7, s44
  s_cmp_eq_u32 s56, 0
  s_cselect_b32 s61, s61, s44
  s_add_u32 s61, s61, s60
  s_mul_i32 s10, s61, 2560
  s_mul_i32 s62, s58, 163840
  s_add_u32 s10, s10, s62
  s_mul_i32 s61, s61, 40960
  s_mul_i32 s62, s58, 1280
  s_add_u32 s61, s61, s62
  s_add_u32 s61, s61, 13107200
  s_mul_i32 s62, s57, 768
  s_add_u32 s12, s61, s62
  s_lshl_b32 s62, s57, 3
  s_add_u32 s14, s61, s62
  s_sub_u32 s61, 7, s44
  s_cmp_eq_u32 s56, 1
  s_cselect_b32 s61, s61, s44
  s_add_u32 s61, s61, s60
  s_mul_i32 s11, s61, 2560
  s_mul_i32 s62, s58, 163840
  s_add_u32 s11, s11, s62
  s_mul_i32 s61, s61, 40960
  s_mul_i32 s62, s58, 1280
  s_add_u32 s61, s61, s62
  s_add_u32 s61, s61, 13107200
  s_mul_i32 s62, s57, 768
  s_add_u32 s13, s61, s62
  s_lshl_b32 s62, s57, 3
  s_add_u32 s15, s61, s62
  s_lshl_b32 s61, s44, 1
  s_sub_u32 s62, -2, s61
  s_cmp_eq_u32 s56, 0
  s_cselect_b32 s61, s61, s62
  s_add_u32 s61, s61, s60
  s_mul_i32 s19, s61, 2560
  s_mul_i32 s20, s61, 1280
  s_mul_i32 s61, s58, 163840
  s_add_u32 s19, s19, s61
  s_add_u32 s19, s19, 2621440
  s_mul_i32 s61, s59, 81920
  s_add_u32 s20, s20, s61
  s_add_u32 s20, s20, 5242880
  s_mul_i32 s21, s44, 5632
  s_add_u32 s21, s21, 32768
  s_mul_i32 s61, s57, 1536
  v_add_u32 v253, s61, v246
  s_lshl_b32 s61, s57, 3
  v_add_u32 v254, s61, v246
  s_lshr_b32 s69, s46, 3
  s_lshl_b32 s68, s45, 2
  s_add_u32 s69, s69, s68
  s_lshl_b32 s69, s69, 3
  s_and_b32 s68, s46, 7
  s_add_u32 s70, s69, s68
  s_lshr_b32 s67, s70, 1
  s_mul_i32 s67, s67, 20480
  s_and_b32 s68, s68, 1
  s_mul_i32 s68, s68, 5120
  s_add_u32 s67, s67, s68
  s_add_u32 s67, s67, 13107200
  s_mul_i32 s68, s48, 10240
  s_add_u32 s69, s67, 10240
  s_add_u32 s67, s67, s68
  s_sub_u32 s69, s69, s68
  s_lshl_b32 s70, s70, 10
  s_add_u32 s70, s70, 16384000
  v_lshlrev_b32 v16, 4, v0
  v_mov_b32 v12, -1
  v_mov_b32 v13, -1
  v_mov_b32 v14, -1
  v_mov_b32 v15, -1
  s_cmp_ge_u32 s44, 2
  s_cbranch_scc1 Lclw2_48
  s_mul_i32 s68, s44, 2560
  s_add_u32 s67, s67, s68
  buffer_store_dwordx4 v[12:15], v16, s[32:35], s67 offen offset:0
  buffer_store_dwordx4 v[12:15], v16, s[32:35], s67 offen offset:1024
  buffer_store_dwordx4 v[12:15], v16, s[32:35], s67 offen offset:1536
  s_branch Lcldn_50
Lclw2_48:
  s_cmp_eq_u32 s44, 3
  s_cbranch_scc1 Lclw3_49
  s_mul_i32 s69, s2, 2560
  s_add_u32 s69, s69, 15728640
  buffer_store_dwordx4 v[12:15], v16, s[32:35], s69 offen offset:0 sc1
  buffer_store_dwordx4 v[12:15], v16, s[32:35], s69 offen offset:1024 sc1
  buffer_store_dwordx4 v[12:15], v16, s[32:35], s69 offen offset:1536 sc1
  s_branch Lcldn_50
Lclw3_49:
  buffer_store_dwordx4 v[12:15], v16, s[32:35], s69 offen offset:0 sc1
  buffer_store_dwordx4 v[12:15], v16, s[32:35], s69 offen offset:1024 sc1
  buffer_store_dwordx4 v[12:15], v16, s[32:35], s69 offen offset:2048 sc1
  buffer_store_dwordx4 v[12:15], v16, s[32:35], s69 offen offset:3072 sc1
  s_add_u32 s69, s69, 4096
  buffer_store_dwordx4 v[12:15], v16, s[32:35], s69 offen offset:0 sc1
  s_cmp_ge_u32 s2, 24
  s_cbranch_scc1 Lcldn_50
  s_lshl_b32 s69, s2, 10
  s_add_u32 s69, s69, 16650240
  buffer_store_dwordx4 v[12:15], v16, s[32:35], s69 offen offset:0 sc1
Lcldn_50:
  s_and_b32 s54, s44, 1
  s_lshr_b32 s55, s44, 1
  s_lshl_b32 s56, s50, 1
  s_add_u32 s56, s56, s55
  s_cmp_eq_u32 s56, 5
  s_cselect_b32 s56, 15, s56
  s_cmp_gt_u32 s50, 2
  s_subb_u32 s56, s56, 0
  s_mul_i32 s57, s56, 52
  s_lshr_b32 s57, s57, 8
  v_and_b32 v2, 15, v0
  v_and_b32 v3, 8, v0
  s_cmp_eq_u32 s57, 2
  s_cselect_b32 s64, 1, 0
  v_mul_u32_u24 v3, s64, v3
  s_lshl_b32 s64, s54, 6
  v_add3_u32 v3, v3, v2, s64
  v_lshlrev_b32 v3, 7, v3
  v_lshrrev_b32 v4, 4, v0
  v_lshrrev_b32 v5, 1, v2
  v_xor_b32 v5, v5, v4
  v_lshl_add_u32 v168, v5, 4, v3
  v_xor_b32 v169, 64, v168
  v_bfe_u32 v5, v0, 2, 2
  v_lshl_add_u32 v6, v4, 3, v5
  v_lshlrev_b32 v6, 8, v6
  v_xor_b32 v5, s44, v5
  v_lshl_add_u32 v6, v5, 6, v6
  v_bfe_u32 v5, v0, 4, 1
  v_lshl_add_u32 v6, v5, 5, v6
  v_and_b32 v7, 3, v0
  v_lshl_add_u32 v6, v7, 3, v6
  v_add_u32 v170, 16384, v6
  v_xor_b32 v171, 32, v170
  v_xor_b32 v172, 64, v170
  v_xor_b32 v173, 96, v170
  v_mov_b32 v164, 0x3f803f80
  v_mov_b32 v44, 0
  v_mov_b32 v165, 0x3f803f80
  v_mov_b32 v45, 0
  v_mov_b32 v166, 0x3f803f80
  v_mov_b32 v46, 0
  v_mov_b32 v167, 0x3f803f80
  v_mov_b32 v47, 0
  v_mov_b32 v64, 0
  v_mov_b32 v65, 0
  v_mov_b32 v66, 0
  v_mov_b32 v67, 0
  v_mov_b32 v68, 0
  v_mov_b32 v69, 0
  v_mov_b32 v70, 0
  v_mov_b32 v71, 0
  v_mov_b32 v72, 0
  v_mov_b32 v73, 0
  v_mov_b32 v74, 0
  v_mov_b32 v75, 0
  v_mov_b32 v76, 0
  v_mov_b32 v77, 0
  v_mov_b32 v78, 0
  v_mov_b32 v79, 0
  v_mov_b32 v80, 0
  v_mov_b32 v81, 0
  v_mov_b32 v82, 0
  v_mov_b32 v83, 0
  v_mov_b32 v84, 0
  v_mov_b32 v85, 0
  v_mov_b32 v86, 0
  v_mov_b32 v87, 0
  v_mov_b32 v88, 0
  v_mov_b32 v89, 0
  v_mov_b32 v90, 0
  v_mov_b32 v91, 0
  v_mov_b32 v92, 0
  v_mov_b32 v93, 0
  v_mov_b32 v94, 0
  v_mov_b32 v95, 0
  v_mov_b32 v96, 0
  v_mov_b32 v97, 0
  v_mov_b32 v98, 0
  v_mov_b32 v99, 0
  v_mov_b32 v100, 0
  v_mov_b32 v101, 0
  v_mov_b32 v102, 0
  v_mov_b32 v103, 0
  v_mov_b32 v104, 0
  v_mov_b32 v105, 0
  v_mov_b32 v106, 0
  v_mov_b32 v107, 0
  v_mov_b32 v108, 0
  v_mov_b32 v109, 0
  v_mov_b32 v110, 0
  v_mov_b32 v111, 0
  v_mov_b32 v112, 0
  v_mov_b32 v113, 0
  v_mov_b32 v114, 0
  v_mov_b32 v115, 0
  v_mov_b32 v116, 0
  v_mov_b32 v117, 0
  v_mov_b32 v118, 0
  v_mov_b32 v119, 0
  v_mov_b32 v120, 0
  v_mov_b32 v121, 0
  v_mov_b32 v122, 0
  v_mov_b32 v123, 0
  v_mov_b32 v124, 0
  v_mov_b32 v125, 0
  v_mov_b32 v126, 0
  v_mov_b32 v127, 0
  v_mov_b32 v128, 0
  v_mov_b32 v129, 0
  v_mov_b32 v130, 0
  v_mov_b32 v131, 0
  v_and_b32 v2, 31, v0
  v_lshrrev_b32 v4, 5, v0
  s_mul_i32 s64, s57, 5
  s_sub_u32 s64, s56, s64
  s_mul_i32 s65, s48, 5
  s_add_u32 s64, s64, s65
  s_lshl_b32 s65, s3, 1
  s_add_u32 s65, s65, s54
  s_lshl_b32 s65, s65, 1
  s_cmp_ge_u32 s57, 2
  s_cbranch_scc1 Lisv_51
  s_mul_i32 s58, s65, 2560
  s_mul_i32 s65, s57, 2621440
  s_add_u32 s58, s58, s65
  s_add_u32 s61, s58, 2560
  s_lshl_b32 s64, s64, 3
  s_xor_b32 s65, s54, 0
  s_lshl_b32 s65, s65, 2
  s_add_u32 s65, s65, s64
  s_add_u32 s65, s65, 0
  v_add_u32 v5, s65, v4
  v_mul_u32_u24 v6, 205, v5
  v_lshrrev_b32 v6, 10, v6
  v_mul_u32_u24 v7, 5, v6
  v_sub_u32 v7, v5, v7
  v_mul_u32_u24 v6, 163840, v6
  v_lshl_add_u32 v6, v7, 9, v6
  v_lshl_add_u32 v174, v2, 4, v6
  s_xor_b32 s65, s54, 0
  s_lshl_b32 s65, s65, 2
  s_add_u32 s65, s65, s64
  s_add_u32 s65, s65, 2
  v_add_u32 v5, s65, v4
  v_mul_u32_u24 v6, 205, v5
  v_lshrrev_b32 v6, 10, v6
  v_mul_u32_u24 v7, 5, v6
  v_sub_u32 v7, v5, v7
  v_mul_u32_u24 v6, 163840, v6
  v_lshl_add_u32 v6, v7, 9, v6
  v_lshl_add_u32 v175, v2, 4, v6
  s_xor_b32 s65, s54, 1
  s_lshl_b32 s65, s65, 2
  s_add_u32 s65, s65, s64
  s_add_u32 s65, s65, 0
  v_add_u32 v5, s65, v4
  v_mul_u32_u24 v6, 205, v5
  v_lshrrev_b32 v6, 10, v6
  v_mul_u32_u24 v7, 5, v6
  v_sub_u32 v7, v5, v7
  v_mul_u32_u24 v6, 163840, v6
  v_lshl_add_u32 v6, v7, 9, v6
  v_lshl_add_u32 v176, v2, 4, v6
  s_xor_b32 s65, s54, 1
  s_lshl_b32 s65, s65, 2
  s_add_u32 s65, s65, s64
  s_add_u32 s65, s65, 2
  v_add_u32 v5, s65, v4
  v_mul_u32_u24 v6, 205, v5
  v_lshrrev_b32 v6, 10, v6
  v_mul_u32_u24 v7, 5, v6
  v_sub_u32 v7, v5, v7
  v_mul_u32_u24 v6, 163840, v6
  v_lshl_add_u32 v6, v7, 9, v6
  v_lshl_add_u32 v177, v2, 4, v6
  s_branch Lstj_52
Lisv_51:
  s_mul_i32 s58, s65, 1280
  s_add_u32 s58, s58, 5242880
  s_add_u32 s61, s58, 1280
  s_lshl_b32 s64, s64, 6
  v_and_b32 v2, 15, v0
  v_bfe_u32 v3, v0, 4, 1
  v_lshl_add_u32 v4, v4, 1, v3
  v_mul_u32_u24 v4, 320, v4
  s_xor_b32 s65, s54, 0
  s_lshl_b32 s65, s65, 5
  s_add_u32 s65, s65, s64
  s_add_u32 s65, s65, 0
  v_add_u32 v5, s65, v2
  v_mul_u32_u24 v6, 3277, v5
  v_lshrrev_b32 v6, 16, v6
  v_mul_u32_u24 v7, 20, v6
  v_sub_u32 v7, v5, v7
  v_mul_u32_u24 v6, 81920, v6
  v_lshl_add_u32 v6, v7, 4, v6
  v_add_u32 v174, v6, v4
  s_xor_b32 s65, s54, 0
  s_lshl_b32 s65, s65, 5
  s_add_u32 s65, s65, s64
  s_add_u32 s65, s65, 16
  v_add_u32 v5, s65, v2
  v_mul_u32_u24 v6, 3277, v5
  v_lshrrev_b32 v6, 16, v6
  v_mul_u32_u24 v7, 20, v6
  v_sub_u32 v7, v5, v7
  v_mul_u32_u24 v6, 81920, v6
  v_lshl_add_u32 v6, v7, 4, v6
  v_add_u32 v175, v6, v4
  s_xor_b32 s65, s54, 1
  s_lshl_b32 s65, s65, 5
  s_add_u32 s65, s65, s64
  s_add_u32 s65, s65, 0
  v_add_u32 v5, s65, v2
  v_mul_u32_u24 v6, 3277, v5
  v_lshrrev_b32 v6, 16, v6
  v_mul_u32_u24 v7, 20, v6
  v_sub_u32 v7, v5, v7
  v_mul_u32_u24 v6, 81920, v6
  v_lshl_add_u32 v6, v7, 4, v6
  v_add_u32 v176, v6, v4
  s_xor_b32 s65, s54, 1
  s_lshl_b32 s65, s65, 5
  s_add_u32 s65, s65, s64
  s_add_u32 s65, s65, 16
  v_add_u32 v5, s65, v2
  v_mul_u32_u24 v6, 3277, v5
  v_lshrrev_b32 v6, 16, v6
  v_mul_u32_u24 v7, 20, v6
  v_sub_u32 v7, v5, v7
  v_mul_u32_u24 v6, 81920, v6
  v_lshl_add_u32 v6, v7, 4, v6
  v_add_u32 v177, v6, v4
Lstj_52:
  s_lshr_b32 s59, 0x8ccc, s3
  s_cmp_gt_u32 s50, 2
  s_cselect_b32 s59, s59, 0
  s_and_b32 s59, s59, 1
  s_lshl_b32 s60, s45, 4
  s_add_u32 s60, s60, s56
  s_lshl_b32 s60, s60, 5
  s_lshl_b32 s64, s49, 1
  s_add_u32 s64, s64, s54
  s_add_u32 s60, s60, s64
  s_lshl_b32 s60, s60, 2
  s_add_u32 s60, s60, 19529728
  s_mov_b32 s36, s59
  s_waitcnt lgkmcnt(0)
  s_mul_i32 s53, s52, 0x9e3779b1
  s_add_u32 s53, s53, 0x7f4a7c15
  s_and_b32 s53, s53, -16
  s_cmp_eq_u32 s56, 15
  s_cbranch_scc1 L_gS
  s_cmp_eq_u32 s57, 2
  s_cbranch_scc1 L_gV
  s_branch L_gT
L_att:
  buffer_load_dword v12, v251, s[32:35], s18 offen sc1
  v_mov_b32 v6, 0x3f803f80
  s_or_b32 s69, s24, s51
  s_mov_b32 s70, 0
  s_mul_i32 s61, s51, 7864320
  v_add_u32 v252, s61, v252
  v_cndmask_b32 v54, 0, v6, s[8:9]
  v_cndmask_b32 v55, 0, v6, s[8:9]
  v_cndmask_b32 v56, 0, v6, s[8:9]
  v_cndmask_b32 v57, 0, v6, s[8:9]
  v_cndmask_b32 v58, 0, v6, s[8:9]
  v_cndmask_b32 v59, 0, v6, s[8:9]
  v_cndmask_b32 v60, 0, v6, s[8:9]
  v_cndmask_b32 v61, 0, v6, s[8:9]
  v_cndmask_b32 v68, 0, v6, s[8:9]
  v_cndmask_b32 v69, 0, v6, s[8:9]
  v_cndmask_b32 v70, 0, v6, s[8:9]
  v_cndmask_b32 v71, 0, v6, s[8:9]
  v_cndmask_b32 v72, 0, v6, s[8:9]
  v_cndmask_b32 v73, 0, v6, s[8:9]
  v_cndmask_b32 v74, 0, v6, s[8:9]
  v_cndmask_b32 v75, 0, v6, s[8:9]
  v_mov_b32 v32, 0
  v_mov_b32 v33, 0
  v_mov_b32 v38, 0
  v_mov_b32 v39, 0
  s_lshr_b32 s63, s46, 3
  s_lshl_b32 s64, s45, 2
  s_add_u32 s63, s63, s64
  s_and_b32 s64, s46, 7
  s_lshl_b32 s55, s63, 2
  s_add_u32 s55, s55, s44
  s_mul_i32 s61, s55, 20480
  s_mul_i32 s62, s51, 7864320
  s_add_u32 s61, s61, s62
  s_add_u32 s61, s61, 13107200
  s_mul_i32 s62, s48, 10240
  s_add_u32 s56, s61, s62
  s_add_u32 s57, s56, 4096
  s_add_u32 s58, s56, 8192
  s_add_u32 s61, s61, 10240
  s_sub_u32 s59, s61, s62
  s_lshl_b32 s66, s55, 11
  s_add_u32 s66, s66, 16384000
  s_mov_b32 s67, 65536
  s_add_u32 s60, s59, 4096
  s_add_u32 s68, s59, 8192
  s_and_b32 s61, s44, 1
  s_mul_i32 s62, s61, 5120
  s_add_u32 s56, s56, s62
  s_add_u32 s59, s59, s62
  s_mul_i32 s62, s61, -40960
  s_add_u32 s62, s62, 20480
  s_add_u32 s57, s56, s62
  s_add_u32 s60, s59, s62
  s_lshr_b32 s61, s44, 1
  s_lshl_b32 s61, s61, 2
  s_add_u32 s61, s61, 159824
  v_mov_b32 v6, s61
  v_mov_b32 v7, 1
  s_mov_b32 s71, 262144
  s_cmp_eq_u32 s36, 0
  s_waitcnt vmcnt(0)
  s_cbranch_scc1 Lnohs_79
  s_mov_b64 exec, 1
  ds_add_u32 v6, v7
  s_mov_b64 exec, -1
Lnohs_79:
  s_branch Lfpm_82
Lfp_80:
  buffer_load_dword v12, v251, s[32:35], s18 offen sc1
  s_waitcnt vmcnt(0)
Lfpm_82:
  v_cmp_ne_u32 vcc, s53, v12
  s_nop 0
  s_cbranch_vccz Lfpok_81
  s_sub_u32 s71, s71, 1
  s_cbranch_scc1 Lfpok_81
  s_branch Lfp_80
Lfpok_81:
  s_mul_i32 s61, s22, 1536
  s_add_u32 s61, s61, s19
  s_mov_b32 m0, s21
  s_add_u32 s62, s61, 1536
  buffer_load_dwordx4 v246, s[32:35], s61 offen sc1 lds
  buffer_load_dwordx4 v246, s[32:35], s62 offen offset:1024 sc1 lds
  s_sub_u32 s61, s19, 2048
  s_sub_u32 s62, s20, 3072
  buffer_load_dwordx4 v247, s[32:35], s61 offen offset:2048 sc1 lds
  buffer_load_dwordx4 v246, s[32:35], s62 offen offset:3072 sc1 lds
  s_add_u32 m0, s21, 4096
  s_add_u32 s62, s20, 1024
  buffer_load_dwordx4 v246, s[32:35], s62 offen sc1 lds
  s_mov_b64 exec, s[76:77]
  buffer_load_dwordx4 v246, s[32:35], s62 offen offset:1024 sc1 lds
  s_mov_b64 exec, -1
  buffer_load_dwordx4 v[28:31], v253, s[32:35], s10 offen sc1
  buffer_load_dwordx4 v[34:37], v253, s[32:35], s11 offen sc1
  s_mov_b64 exec, s[76:77]
  buffer_load_dwordx2 v[32:33], v254, s[32:35], s10 offen offset:1024 sc1
  buffer_load_dwordx2 v[38:39], v254, s[32:35], s11 offen offset:1024 sc1
  s_mov_b64 exec, 1
  v_mov_b32 v2, 159808
  v_mov_b32 v3, 1
  s_waitcnt vmcnt(4)
  ds_add_u32 v2, v3
  s_mov_b64 exec, -1
  v_mov_b32 v251, 159808
  s_mov_b32 s71, 1048576
Llw_83:
  ds_read_b32 v7, v251
  s_waitcnt lgkmcnt(0)
  v_cmp_gt_u32 vcc, 4, v7
  s_nop 0
  s_cbranch_vccz Llwok_84
  s_sub_u32 s71, s71, 1
  s_cbranch_scc1 Llwok_84
  s_branch Llw_83
Llwok_84:
  s_waitcnt vmcnt(0)
  s_cmp_eq_u32 s44, 1
  s_cbranch_scc1 L_av1
  s_cmp_eq_u32 s44, 2
  s_cbranch_scc1 L_av2
  s_cmp_eq_u32 s44, 3
  s_cbranch_scc1 L_av3
  s_branch L_av0
.p2alignl 12, 0xbf810000
L_gT:
  s_barrier
  ds_read_b64_tr_b16 v[148:149], v170 offset:0
  ds_read_b64_tr_b16 v[150:151], v170 offset:1024
  ds_read_b128 v[132:135], v168 offset:0
  ds_read_b128 v[136:139], v169 offset:2048
  ds_read_b64_tr_b16 v[152:153], v171 offset:0
  ds_read_b64_tr_b16 v[154:155], v171 offset:1024
  ds_read_b128 v[140:143], v168 offset:4096
  ds_read_b128 v[144:147], v169 offset:6144
  ds_read_b64_tr_b16 v[156:157], v172 offset:0
  ds_read_b64_tr_b16 v[158:159], v172 offset:1024
  ds_read_b64_tr_b16 v[160:161], v173 offset:0
  ds_read_b64_tr_b16 v[162:163], v173 offset:1024
  s_lshl_b32 s66, s44, 3
  s_add_u32 s66, s66, 5
  s_mov_b32 s64, 5
LgT_53:
  s_waitcnt lgkmcnt(0)
  ds_read_b64_tr_b16 v[28:29], v170 offset:8192
  v_mfma_f32_16x16x32_bf16 v[64:67], v[148:151], v[132:135], v[64:67]
  ds_read_b64_tr_b16 v[30:31], v170 offset:9216
  v_mfma_f32_16x16x32_bf16 v[68:71], v[148:151], v[136:139], v[68:71]
  ds_read_b128 v[12:15], v169 offset:0
  v_mfma_f32_16x16x32_bf16 v[96:99], v[148:151], v[140:143], v[96:99]
  ds_read_b128 v[16:19], v168 offset:2048
  v_mfma_f32_16x16x32_bf16 v[100:103], v[148:151], v[144:147], v[100:103]
  ds_read_b64_tr_b16 v[32:33], v171 offset:8192
  v_mfma_f32_16x16x32_bf16 v[72:75], v[152:155], v[132:135], v[72:75]
  ds_read_b64_tr_b16 v[34:35], v171 offset:9216
  v_mfma_f32_16x16x32_bf16 v[76:79], v[152:155], v[136:139], v[76:79]
  ds_read_b128 v[20:23], v169 offset:4096
  v_mfma_f32_16x16x32_bf16 v[104:107], v[152:155], v[140:143], v[104:107]
  ds_read_b128 v[24:27], v168 offset:6144
  v_mfma_f32_16x16x32_bf16 v[108:111], v[152:155], v[144:147], v[108:111]
  ds_read_b64_tr_b16 v[36:37], v172 offset:8192
  v_mfma_f32_16x16x32_bf16 v[80:83], v[156:159], v[132:135], v[80:83]
  ds_read_b64_tr_b16 v[38:39], v172 offset:9216
  v_mfma_f32_16x16x32_bf16 v[84:87], v[156:159], v[136:139], v[84:87]
  ds_read_b64_tr_b16 v[40:41], v173 offset:8192
  v_mfma_f32_16x16x32_bf16 v[112:115], v[156:159], v[140:143], v[112:115]
  ds_read_b64_tr_b16 v[42:43], v173 offset:9216
  v_mfma_f32_16x16x32_bf16 v[116:119], v[156:159], v[144:147], v[116:119]
  v_mfma_f32_16x16x32_bf16 v[88:91], v[160:163], v[132:135], v[88:91]
  v_mfma_f32_16x16x32_bf16 v[128:131], v[164:167], v[148:151], v[128:131]
  v_mfma_f32_16x16x32_bf16 v[92:95], v[160:163], v[136:139], v[92:95]
  v_mfma_f32_16x16x32_bf16 v[44:47], v[164:167], v[152:155], v[44:47]
  v_mfma_f32_16x16x32_bf16 v[120:123], v[160:163], v[140:143], v[120:123]
  v_mfma_f32_16x16x32_bf16 v[124:127], v[160:163], v[144:147], v[124:127]
  s_waitcnt lgkmcnt(0)
  v_mfma_f32_16x16x32_bf16 v[64:67], v[28:31], v[12:15], v[64:67]
  v_mfma_f32_16x16x32_bf16 v[68:71], v[28:31], v[16:19], v[68:71]
  v_mfma_f32_16x16x32_bf16 v[96:99], v[28:31], v[20:23], v[96:99]
  s_cmp_eq_u32 s64, 5
  s_cbranch_scc1 Lcw_58
Lcwr_59:
  s_barrier
  s_cmp_eq_u32 s64, s66
  s_cbranch_scc1 Lhello_56
Lhellor_57:
  ds_read_b64_tr_b16 v[148:149], v170 offset:32768
  v_mfma_f32_16x16x32_bf16 v[100:103], v[28:31], v[24:27], v[100:103]
  ds_read_b64_tr_b16 v[150:151], v170 offset:33792
  v_mfma_f32_16x16x32_bf16 v[72:75], v[32:35], v[12:15], v[72:75]
  ds_read_b128 v[132:135], v168 offset:32768
  v_mfma_f32_16x16x32_bf16 v[76:79], v[32:35], v[16:19], v[76:79]
  ds_read_b128 v[136:139], v169 offset:34816
  v_mfma_f32_16x16x32_bf16 v[104:107], v[32:35], v[20:23], v[104:107]
  ds_read_b64_tr_b16 v[152:153], v171 offset:32768
  v_mfma_f32_16x16x32_bf16 v[108:111], v[32:35], v[24:27], v[108:111]
  ds_read_b64_tr_b16 v[154:155], v171 offset:33792
  v_mfma_f32_16x16x32_bf16 v[80:83], v[36:39], v[12:15], v[80:83]
  ds_read_b128 v[140:143], v168 offset:36864
  v_mfma_f32_16x16x32_bf16 v[84:87], v[36:39], v[16:19], v[84:87]
  ds_read_b128 v[144:147], v169 offset:38912
  v_mfma_f32_16x16x32_bf16 v[112:115], v[36:39], v[20:23], v[112:115]
  ds_read_b64_tr_b16 v[156:157], v172 offset:32768
  v_mfma_f32_16x16x32_bf16 v[116:119], v[36:39], v[24:27], v[116:119]
  ds_read_b64_tr_b16 v[158:159], v172 offset:33792
  v_mfma_f32_16x16x32_bf16 v[88:91], v[40:43], v[12:15], v[88:91]
  ds_read_b64_tr_b16 v[160:161], v173 offset:32768
  v_mfma_f32_16x16x32_bf16 v[128:131], v[164:167], v[28:31], v[128:131]
  ds_read_b64_tr_b16 v[162:163], v173 offset:33792
  v_mfma_f32_16x16x32_bf16 v[92:95], v[40:43], v[16:19], v[92:95]
  v_mfma_f32_16x16x32_bf16 v[44:47], v[164:167], v[32:35], v[44:47]
  v_mfma_f32_16x16x32_bf16 v[120:123], v[40:43], v[20:23], v[120:123]
  v_mfma_f32_16x16x32_bf16 v[124:127], v[40:43], v[24:27], v[124:127]
  s_waitcnt lgkmcnt(0)
  ds_read_b64_tr_b16 v[28:29], v170 offset:40960
  v_mfma_f32_16x16x32_bf16 v[64:67], v[148:151], v[132:135], v[64:67]
  ds_read_b64_tr_b16 v[30:31], v170 offset:41984
  v_mfma_f32_16x16x32_bf16 v[68:71], v[148:151], v[136:139], v[68:71]
  ds_read_b128 v[12:15], v169 offset:32768
  v_mfma_f32_16x16x32_bf16 v[96:99], v[148:151], v[140:143], v[96:99]
  ds_read_b128 v[16:19], v168 offset:34816
  v_mfma_f32_16x16x32_bf16 v[100:103], v[148:151], v[144:147], v[100:103]
  ds_read_b64_tr_b16 v[32:33], v171 offset:40960
  v_mfma_f32_16x16x32_bf16 v[72:75], v[152:155], v[132:135], v[72:75]
  ds_read_b64_tr_b16 v[34:35], v171 offset:41984
  v_mfma_f32_16x16x32_bf16 v[76:79], v[152:155], v[136:139], v[76:79]
  ds_read_b128 v[20:23], v169 offset:36864
  v_mfma_f32_16x16x32_bf16 v[104:107], v[152:155], v[140:143], v[104:107]
  ds_read_b128 v[24:27], v168 offset:38912
  v_mfma_f32_16x16x32_bf16 v[108:111], v[152:155], v[144:147], v[108:111]
  ds_read_b64_tr_b16 v[36:37], v172 offset:40960
  v_mfma_f32_16x16x32_bf16 v[80:83], v[156:159], v[132:135], v[80:83]
  ds_read_b64_tr_b16 v[38:39], v172 offset:41984
  v_mfma_f32_16x16x32_bf16 v[84:87], v[156:159], v[136:139], v[84:87]
  ds_read_b64_tr_b16 v[40:41], v173 offset:40960
  v_mfma_f32_16x16x32_bf16 v[112:115], v[156:159], v[140:143], v[112:115]
  ds_read_b64_tr_b16 v[42:43], v173 offset:41984
  v_mfma_f32_16x16x32_bf16 v[116:119], v[156:159], v[144:147], v[116:119]
  v_mfma_f32_16x16x32_bf16 v[88:91], v[160:163], v[132:135], v[88:91]
  v_mfma_f32_16x16x32_bf16 v[128:131], v[164:167], v[148:151], v[128:131]
  v_mfma_f32_16x16x32_bf16 v[92:95], v[160:163], v[136:139], v[92:95]
  v_mfma_f32_16x16x32_bf16 v[44:47], v[164:167], v[152:155], v[44:47]
  v_mfma_f32_16x16x32_bf16 v[120:123], v[160:163], v[140:143], v[120:123]
  v_mfma_f32_16x16x32_bf16 v[124:127], v[160:163], v[144:147], v[124:127]
  s_waitcnt lgkmcnt(0)
  v_mfma_f32_16x16x32_bf16 v[64:67], v[28:31], v[12:15], v[64:67]
  v_xor_b32 v168, 0x10000, v168
  v_xor_b32 v169, 0x10000, v169
  v_mfma_f32_16x16x32_bf16 v[68:71], v[28:31], v[16:19], v[68:71]
  v_xor_b32 v170, 0x10000, v170
  v_xor_b32 v171, 0x10000, v171
  v_mfma_f32_16x16x32_bf16 v[96:99], v[28:31], v[20:23], v[96:99]
  v_xor_b32 v172, 0x10000, v172
  v_xor_b32 v173, 0x10000, v173
  s_barrier
  ds_read_b64_tr_b16 v[148:149], v170 offset:0
  v_mfma_f32_16x16x32_bf16 v[100:103], v[28:31], v[24:27], v[100:103]
  ds_read_b64_tr_b16 v[150:151], v170 offset:1024
  v_mfma_f32_16x16x32_bf16 v[72:75], v[32:35], v[12:15], v[72:75]
  ds_read_b128 v[132:135], v168 offset:0
  v_mfma_f32_16x16x32_bf16 v[76:79], v[32:35], v[16:19], v[76:79]
  ds_read_b128 v[136:139], v169 offset:2048
  v_mfma_f32_16x16x32_bf16 v[104:107], v[32:35], v[20:23], v[104:107]
  ds_read_b64_tr_b16 v[152:153], v171 offset:0
  v_mfma_f32_16x16x32_bf16 v[108:111], v[32:35], v[24:27], v[108:111]
  ds_read_b64_tr_b16 v[154:155], v171 offset:1024
  v_mfma_f32_16x16x32_bf16 v[80:83], v[36:39], v[12:15], v[80:83]
  ds_read_b128 v[140:143], v168 offset:4096
  v_mfma_f32_16x16x32_bf16 v[84:87], v[36:39], v[16:19], v[84:87]
  ds_read_b128 v[144:147], v169 offset:6144
  v_mfma_f32_16x16x32_bf16 v[112:115], v[36:39], v[20:23], v[112:115]
  ds_read_b64_tr_b16 v[156:157], v172 offset:0
  v_mfma_f32_16x16x32_bf16 v[116:119], v[36:39], v[24:27], v[116:119]
  ds_read_b64_tr_b16 v[158:159], v172 offset:1024
  v_mfma_f32_16x16x32_bf16 v[88:91], v[40:43], v[12:15], v[88:91]
  ds_read_b64_tr_b16 v[160:161], v173 offset:0
  v_mfma_f32_16x16x32_bf16 v[128:131], v[164:167], v[28:31], v[128:131]
  ds_read_b64_tr_b16 v[162:163], v173 offset:1024
  v_mfma_f32_16x16x32_bf16 v[92:95], v[40:43], v[16:19], v[92:95]
  v_mfma_f32_16x16x32_bf16 v[44:47], v[164:167], v[32:35], v[44:47]
  v_mfma_f32_16x16x32_bf16 v[120:123], v[40:43], v[20:23], v[120:123]
  v_mfma_f32_16x16x32_bf16 v[124:127], v[40:43], v[24:27], v[124:127]
  s_sub_u32 s64, s64, 1
  s_cmp_lg_u32 s64, 0
  s_cbranch_scc1 LgT_53
  v_and_b32 v2, 15, v0
  v_lshrrev_b32 v6, 4, v0
  s_lshl_b32 s64, s44, 7
  s_add_u32 s64, s64, 157696
  s_lshl_b32 s65, s54, 9
  s_add_u32 s65, s65, 158208
  v_lshl_add_u32 v5, v2, 3, s65
  v_lshl_add_u32 v3, v6, 4, s64
  v_and_b32 v7, 31, v0
  v_lshl_add_u32 v7, v7, 2, s64
  s_mov_b32 vcc_lo, 0xffff0000
  s_mov_b32 vcc_hi, 0xffff0000
  v_cndmask_b32 v128, v128, v44, vcc
  ds_write_b32 v7, v128
  v_xor_b32 v4, 128, v3
  s_waitcnt lgkmcnt(0)
  s_barrier
  ds_read_b64 v[20:21], v5 offset:0
  ds_read_b64 v[22:23], v5 offset:128
  ds_read_b64 v[24:25], v5 offset:256
  ds_read_b64 v[26:27], v5 offset:384
  v_mov_b32 v10, 159744
  ds_read_b32 v11, v10
  ds_read_b128 v[28:31], v3 offset:0
  ds_read_b128 v[32:35], v3 offset:64
  ds_read_b128 v[36:39], v4 offset:0
  ds_read_b128 v[40:43], v4 offset:64
  s_waitcnt lgkmcnt(2)
  v_readfirstlane_b32 s51, v11
  s_cmp_eq_u32 s57, 0
  s_cselect_b32 s64, 0x3ea52b5c, 1.0
  v_mul_f32 v21, s64, v21
  v_mul_f32 v23, s64, v23
  v_mul_f32 v25, s64, v25
  v_mul_f32 v27, s64, v27
  v_pk_fma_f32 v[64:65], v[28:29], v[20:21], v[64:65] op_sel:[0,0,0] op_sel_hi:[1,0,1]
  v_pk_fma_f32 v[66:67], v[30:31], v[20:21], v[66:67] op_sel:[0,0,0] op_sel_hi:[1,0,1]
  v_pk_fma_f32 v[68:69], v[28:29], v[22:23], v[68:69] op_sel:[0,0,0] op_sel_hi:[1,0,1]
  v_pk_fma_f32 v[70:71], v[30:31], v[22:23], v[70:71] op_sel:[0,0,0] op_sel_hi:[1,0,1]
  v_pk_mul_f32 v[64:65], v[64:65], v[20:21] op_sel:[0,1] op_sel_hi:[1,1]
  v_pk_mul_f32 v[66:67], v[66:67], v[20:21] op_sel:[0,1] op_sel_hi:[1,1]
  v_pk_mul_f32 v[68:69], v[68:69], v[22:23] op_sel:[0,1] op_sel_hi:[1,1]
  v_pk_mul_f32 v[70:71], v[70:71], v[22:23] op_sel:[0,1] op_sel_hi:[1,1]
  v_cvt_pk_bf16_f32 v64, v64, v65
  v_cvt_pk_bf16_f32 v65, v66, v67
  v_cvt_pk_bf16_f32 v66, v68, v69
  v_cvt_pk_bf16_f32 v67, v70, v71
  s_nop 0
  v_permlane16_swap_b32 v64, v66
  v_permlane16_swap_b32 v65, v67
  buffer_store_dwordx4 v[64:67], v174, s[32:35], s58 offen
  v_pk_fma_f32 v[72:73], v[32:33], v[20:21], v[72:73] op_sel:[0,0,0] op_sel_hi:[1,0,1]
  v_pk_fma_f32 v[74:75], v[34:35], v[20:21], v[74:75] op_sel:[0,0,0] op_sel_hi:[1,0,1]
  v_pk_fma_f32 v[76:77], v[32:33], v[22:23], v[76:77] op_sel:[0,0,0] op_sel_hi:[1,0,1]
  v_pk_fma_f32 v[78:79], v[34:35], v[22:23], v[78:79] op_sel:[0,0,0] op_sel_hi:[1,0,1]
  v_pk_mul_f32 v[72:73], v[72:73], v[20:21] op_sel:[0,1] op_sel_hi:[1,1]
  v_pk_mul_f32 v[74:75], v[74:75], v[20:21] op_sel:[0,1] op_sel_hi:[1,1]
  v_pk_mul_f32 v[76:77], v[76:77], v[22:23] op_sel:[0,1] op_sel_hi:[1,1]
  v_pk_mul_f32 v[78:79], v[78:79], v[22:23] op_sel:[0,1] op_sel_hi:[1,1]
  v_cvt_pk_bf16_f32 v68, v72, v73
  v_cvt_pk_bf16_f32 v69, v74, v75
  v_cvt_pk_bf16_f32 v70, v76, v77
  v_cvt_pk_bf16_f32 v71, v78, v79
  s_nop 0
  v_permlane16_swap_b32 v68, v70
  v_permlane16_swap_b32 v69, v71
  buffer_store_dwordx4 v[68:71], v175, s[32:35], s58 offen
  v_pk_fma_f32 v[96:97], v[28:29], v[24:25], v[96:97] op_sel:[0,0,0] op_sel_hi:[1,0,1]
  v_pk_fma_f32 v[98:99], v[30:31], v[24:25], v[98:99] op_sel:[0,0,0] op_sel_hi:[1,0,1]
  v_pk_fma_f32 v[100:101], v[28:29], v[26:27], v[100:101] op_sel:[0,0,0] op_sel_hi:[1,0,1]
  v_pk_fma_f32 v[102:103], v[30:31], v[26:27], v[102:103] op_sel:[0,0,0] op_sel_hi:[1,0,1]
  v_pk_mul_f32 v[96:97], v[96:97], v[24:25] op_sel:[0,1] op_sel_hi:[1,1]
  v_pk_mul_f32 v[98:99], v[98:99], v[24:25] op_sel:[0,1] op_sel_hi:[1,1]
  v_pk_mul_f32 v[100:101], v[100:101], v[26:27] op_sel:[0,1] op_sel_hi:[1,1]
  v_pk_mul_f32 v[102:103], v[102:103], v[26:27] op_sel:[0,1] op_sel_hi:[1,1]
  v_cvt_pk_bf16_f32 v96, v96, v97
  v_cvt_pk_bf16_f32 v97, v98, v99
  v_cvt_pk_bf16_f32 v98, v100, v101
  v_cvt_pk_bf16_f32 v99, v102, v103
  s_nop 0
  v_permlane16_swap_b32 v96, v98
  v_permlane16_swap_b32 v97, v99
  buffer_store_dwordx4 v[96:99], v174, s[32:35], s61 offen
  v_pk_fma_f32 v[104:105], v[32:33], v[24:25], v[104:105] op_sel:[0,0,0] op_sel_hi:[1,0,1]
  v_pk_fma_f32 v[106:107], v[34:35], v[24:25], v[106:107] op_sel:[0,0,0] op_sel_hi:[1,0,1]
  v_pk_fma_f32 v[108:109], v[32:33], v[26:27], v[108:109] op_sel:[0,0,0] op_sel_hi:[1,0,1]
  v_pk_fma_f32 v[110:111], v[34:35], v[26:27], v[110:111] op_sel:[0,0,0] op_sel_hi:[1,0,1]
  v_pk_mul_f32 v[104:105], v[104:105], v[24:25] op_sel:[0,1] op_sel_hi:[1,1]
  v_pk_mul_f32 v[106:107], v[106:107], v[24:25] op_sel:[0,1] op_sel_hi:[1,1]
  v_pk_mul_f32 v[108:109], v[108:109], v[26:27] op_sel:[0,1] op_sel_hi:[1,1]
  v_pk_mul_f32 v[110:111], v[110:111], v[26:27] op_sel:[0,1] op_sel_hi:[1,1]
  v_cvt_pk_bf16_f32 v100, v104, v105
  v_cvt_pk_bf16_f32 v101, v106, v107
  v_cvt_pk_bf16_f32 v102, v108, v109
  v_cvt_pk_bf16_f32 v103, v110, v111
  s_nop 0
  v_permlane16_swap_b32 v100, v102
  v_permlane16_swap_b32 v101, v103
  buffer_store_dwordx4 v[100:103], v175, s[32:35], s61 offen
  s_waitcnt lgkmcnt(0)
  v_pk_fma_f32 v[80:81], v[36:37], v[20:21], v[80:81] op_sel:[0,0,0] op_sel_hi:[1,0,1]
  v_pk_fma_f32 v[82:83], v[38:39], v[20:21], v[82:83] op_sel:[0,0,0] op_sel_hi:[1,0,1]
  v_pk_fma_f32 v[84:85], v[36:37], v[22:23], v[84:85] op_sel:[0,0,0] op_sel_hi:[1,0,1]
  v_pk_fma_f32 v[86:87], v[38:39], v[22:23], v[86:87] op_sel:[0,0,0] op_sel_hi:[1,0,1]
  v_pk_mul_f32 v[80:81], v[80:81], v[20:21] op_sel:[0,1] op_sel_hi:[1,1]
  v_pk_mul_f32 v[82:83], v[82:83], v[20:21] op_sel:[0,1] op_sel_hi:[1,1]
  v_pk_mul_f32 v[84:85], v[84:85], v[22:23] op_sel:[0,1] op_sel_hi:[1,1]
  v_pk_mul_f32 v[86:87], v[86:87], v[22:23] op_sel:[0,1] op_sel_hi:[1,1]
  v_cvt_pk_bf16_f32 v80, v80, v81
  v_cvt_pk_bf16_f32 v81, v82, v83
  v_cvt_pk_bf16_f32 v82, v84, v85
  v_cvt_pk_bf16_f32 v83, v86, v87
  s_nop 0
  v_permlane16_swap_b32 v80, v82
  v_permlane16_swap_b32 v81, v83
  buffer_store_dwordx4 v[80:83], v176, s[32:35], s58 offen
  v_pk_fma_f32 v[88:89], v[40:41], v[20:21], v[88:89] op_sel:[0,0,0] op_sel_hi:[1,0,1]
  v_pk_fma_f32 v[90:91], v[42:43], v[20:21], v[90:91] op_sel:[0,0,0] op_sel_hi:[1,0,1]
  v_pk_fma_f32 v[92:93], v[40:41], v[22:23], v[92:93] op_sel:[0,0,0] op_sel_hi:[1,0,1]
  v_pk_fma_f32 v[94:95], v[42:43], v[22:23], v[94:95] op_sel:[0,0,0] op_sel_hi:[1,0,1]
  v_pk_mul_f32 v[88:89], v[88:89], v[20:21] op_sel:[0,1] op_sel_hi:[1,1]
  v_pk_mul_f32 v[90:91], v[90:91], v[20:21] op_sel:[0,1] op_sel_hi:[1,1]
  v_pk_mul_f32 v[92:93], v[92:93], v[22:23] op_sel:[0,1] op_sel_hi:[1,1]
  v_pk_mul_f32 v[94:95], v[94:95], v[22:23] op_sel:[0,1] op_sel_hi:[1,1]
  v_cvt_pk_bf16_f32 v84, v88, v89
  v_cvt_pk_bf16_f32 v85, v90, v91
  v_cvt_pk_bf16_f32 v86, v92, v93
  v_cvt_pk_bf16_f32 v87, v94, v95
  s_nop 0
  v_permlane16_swap_b32 v84, v86
  v_permlane16_swap_b32 v85, v87
  buffer_store_dwordx4 v[84:87], v177, s[32:35], s58 offen
  v_pk_fma_f32 v[112:113], v[36:37], v[24:25], v[112:113] op_sel:[0,0,0] op_sel_hi:[1,0,1]
  v_pk_fma_f32 v[114:115], v[38:39], v[24:25], v[114:115] op_sel:[0,0,0] op_sel_hi:[1,0,1]
  v_pk_fma_f32 v[116:117], v[36:37], v[26:27], v[116:117] op_sel:[0,0,0] op_sel_hi:[1,0,1]
  v_pk_fma_f32 v[118:119], v[38:39], v[26:27], v[118:119] op_sel:[0,0,0] op_sel_hi:[1,0,1]
  v_pk_mul_f32 v[112:113], v[112:113], v[24:25] op_sel:[0,1] op_sel_hi:[1,1]
  v_pk_mul_f32 v[114:115], v[114:115], v[24:25] op_sel:[0,1] op_sel_hi:[1,1]
  v_pk_mul_f32 v[116:117], v[116:117], v[26:27] op_sel:[0,1] op_sel_hi:[1,1]
  v_pk_mul_f32 v[118:119], v[118:119], v[26:27] op_sel:[0,1] op_sel_hi:[1,1]
  v_cvt_pk_bf16_f32 v112, v112, v113
  v_cvt_pk_bf16_f32 v113, v114, v115
  v_cvt_pk_bf16_f32 v114, v116, v117
  v_cvt_pk_bf16_f32 v115, v118, v119
  s_nop 0
  v_permlane16_swap_b32 v112, v114
  v_permlane16_swap_b32 v113, v115
  buffer_store_dwordx4 v[112:115], v176, s[32:35], s61 offen
  v_pk_fma_f32 v[120:121], v[40:41], v[24:25], v[120:121] op_sel:[0,0,0] op_sel_hi:[1,0,1]
  v_pk_fma_f32 v[122:123], v[42:43], v[24:25], v[122:123] op_sel:[0,0,0] op_sel_hi:[1,0,1]
  v_pk_fma_f32 v[124:125], v[40:41], v[26:27], v[124:125] op_sel:[0,0,0] op_sel_hi:[1,0,1]
  v_pk_fma_f32 v[126:127], v[42:43], v[26:27], v[126:127] op_sel:[0,0,0] op_sel_hi:[1,0,1]
  v_pk_mul_f32 v[120:121], v[120:121], v[24:25] op_sel:[0,1] op_sel_hi:[1,1]
  v_pk_mul_f32 v[122:123], v[122:123], v[24:25] op_sel:[0,1] op_sel_hi:[1,1]
  v_pk_mul_f32 v[124:125], v[124:125], v[26:27] op_sel:[0,1] op_sel_hi:[1,1]
  v_pk_mul_f32 v[126:127], v[126:127], v[26:27] op_sel:[0,1] op_sel_hi:[1,1]
  v_cvt_pk_bf16_f32 v116, v120, v121
  v_cvt_pk_bf16_f32 v117, v122, v123
  v_cvt_pk_bf16_f32 v118, v124, v125
  v_cvt_pk_bf16_f32 v119, v126, v127
  s_nop 0
  v_permlane16_swap_b32 v116, v118
  v_permlane16_swap_b32 v117, v119
  buffer_store_dwordx4 v[116:119], v177, s[32:35], s61 offen
  s_cmp_lg_u32 s51, 0
  s_cbranch_scc1 Lqslow_60
Lqjn_61:
  v_mov_b32 v2, 0
  v_mov_b32 v3, s53
  s_add_u32 s64, s58, 5242880
  s_add_u32 s65, s61, 5242880
  s_waitcnt vmcnt(0)
  s_mov_b64 exec, 1
  s_cmp_lg_u32 s51, 0
  s_cbranch_scc1 Lslow_64
  buffer_store_dword v3, v2, s[32:35], s60 offen
  s_branch Ljn_65
Lslow_64:
  buffer_store_dword v3, v2, s[32:35], s60 offen sc1
Ljn_65:
  s_mov_b64 exec, -1
  s_cmp_eq_u32 s59, 0
  s_cbranch_scc1 Lnohalo_62
  buffer_store_dwordx4 v[64:67], v174, s[32:35], s64 offen sc1
  buffer_store_dwordx4 v[68:71], v175, s[32:35], s64 offen sc1
  buffer_store_dwordx4 v[80:83], v176, s[32:35], s64 offen sc1
  buffer_store_dwordx4 v[84:87], v177, s[32:35], s64 offen sc1
  buffer_store_dwordx4 v[96:99], v174, s[32:35], s65 offen sc1
  buffer_store_dwordx4 v[100:103], v175, s[32:35], s65 offen sc1
  buffer_store_dwordx4 v[112:115], v176, s[32:35], s65 offen sc1
  buffer_store_dwordx4 v[116:119], v177, s[32:35], s65 offen sc1
Lnohalo_62:
  s_branch L_att
.p2alignl 12, 0xbf810000
L_gV:
  s_barrier
  ds_read_b64_tr_b16 v[148:149], v170 offset:0
  ds_read_b64_tr_b16 v[150:151], v170 offset:1024
  ds_read_b128 v[132:135], v168 offset:0
  ds_read_b128 v[136:139], v169 offset:1024
  ds_read_b64_tr_b16 v[152:153], v171 offset:0
  ds_read_b64_tr_b16 v[154:155], v171 offset:1024
  ds_read_b128 v[140:143], v168 offset:4096
  ds_read_b128 v[144:147], v169 offset:5120
  ds_read_b64_tr_b16 v[156:157], v172 offset:0
  ds_read_b64_tr_b16 v[158:159], v172 offset:1024
  ds_read_b64_tr_b16 v[160:161], v173 offset:0
  ds_read_b64_tr_b16 v[162:163], v173 offset:1024
  s_lshl_b32 s66, s44, 3
  s_add_u32 s66, s66, 5
  s_mov_b32 s64, 5
LgV_66:
  s_waitcnt lgkmcnt(0)
  ds_read_b64_tr_b16 v[28:29], v170 offset:8192
  v_mfma_f32_16x16x32_bf16 v[64:67], v[132:135], v[148:151], v[64:67]
  ds_read_b64_tr_b16 v[30:31], v170 offset:9216
  v_mfma_f32_16x16x32_bf16 v[68:71], v[136:139], v[148:151], v[68:71]
  ds_read_b128 v[12:15], v169 offset:0
  v_mfma_f32_16x16x32_bf16 v[96:99], v[140:143], v[148:151], v[96:99]
  ds_read_b128 v[16:19], v168 offset:1024
  v_mfma_f32_16x16x32_bf16 v[100:103], v[144:147], v[148:151], v[100:103]
  ds_read_b64_tr_b16 v[32:33], v171 offset:8192
  v_mfma_f32_16x16x32_bf16 v[72:75], v[132:135], v[152:155], v[72:75]
  ds_read_b64_tr_b16 v[34:35], v171 offset:9216
  v_mfma_f32_16x16x32_bf16 v[76:79], v[136:139], v[152:155], v[76:79]
  ds_read_b128 v[20:23], v169 offset:4096
  v_mfma_f32_16x16x32_bf16 v[104:107], v[140:143], v[152:155], v[104:107]
  ds_read_b128 v[24:27], v168 offset:5120
  v_mfma_f32_16x16x32_bf16 v[108:111], v[144:147], v[152:155], v[108:111]
  ds_read_b64_tr_b16 v[36:37], v172 offset:8192
  v_mfma_f32_16x16x32_bf16 v[80:83], v[132:135], v[156:159], v[80:83]
  ds_read_b64_tr_b16 v[38:39], v172 offset:9216
  v_mfma_f32_16x16x32_bf16 v[84:87], v[136:139], v[156:159], v[84:87]
  ds_read_b64_tr_b16 v[40:41], v173 offset:8192
  v_mfma_f32_16x16x32_bf16 v[112:115], v[140:143], v[156:159], v[112:115]
  ds_read_b64_tr_b16 v[42:43], v173 offset:9216
  v_mfma_f32_16x16x32_bf16 v[116:119], v[144:147], v[156:159], v[116:119]
  v_mfma_f32_16x16x32_bf16 v[88:91], v[132:135], v[160:163], v[88:91]
  v_mfma_f32_16x16x32_bf16 v[128:131], v[164:167], v[148:151], v[128:131]
  v_mfma_f32_16x16x32_bf16 v[92:95], v[136:139], v[160:163], v[92:95]
  v_mfma_f32_16x16x32_bf16 v[44:47], v[164:167], v[152:155], v[44:47]
  v_mfma_f32_16x16x32_bf16 v[120:123], v[140:143], v[160:163], v[120:123]
  v_mfma_f32_16x16x32_bf16 v[124:127], v[144:147], v[160:163], v[124:127]
  s_waitcnt lgkmcnt(0)
  v_mfma_f32_16x16x32_bf16 v[64:67], v[12:15], v[28:31], v[64:67]
  v_mfma_f32_16x16x32_bf16 v[68:71], v[16:19], v[28:31], v[68:71]
  v_mfma_f32_16x16x32_bf16 v[96:99], v[20:23], v[28:31], v[96:99]
  s_cmp_eq_u32 s64, 5
  s_cbranch_scc1 Lcw_71
Lcwr_72:
  s_barrier
  s_cmp_eq_u32 s64, s66
  s_cbranch_scc1 Lhello_69
Lhellor_70:
  ds_read_b64_tr_b16 v[148:149], v170 offset:32768
  v_mfma_f32_16x16x32_bf16 v[100:103], v[24:27], v[28:31], v[100:103]
  ds_read_b64_tr_b16 v[150:151], v170 offset:33792
  v_mfma_f32_16x16x32_bf16 v[72:75], v[12:15], v[32:35], v[72:75]
  ds_read_b128 v[132:135], v168 offset:32768
  v_mfma_f32_16x16x32_bf16 v[76:79], v[16:19], v[32:35], v[76:79]
  ds_read_b128 v[136:139], v169 offset:33792
  v_mfma_f32_16x16x32_bf16 v[104:107], v[20:23], v[32:35], v[104:107]
  ds_read_b64_tr_b16 v[152:153], v171 offset:32768
  v_mfma_f32_16x16x32_bf16 v[108:111], v[24:27], v[32:35], v[108:111]
  ds_read_b64_tr_b16 v[154:155], v171 offset:33792
  v_mfma_f32_16x16x32_bf16 v[80:83], v[12:15], v[36:39], v[80:83]
  ds_read_b128 v[140:143], v168 offset:36864
  v_mfma_f32_16x16x32_bf16 v[84:87], v[16:19], v[36:39], v[84:87]
  ds_read_b128 v[144:147], v169 offset:37888
  v_mfma_f32_16x16x32_bf16 v[112:115], v[20:23], v[36:39], v[112:115]
  ds_read_b64_tr_b16 v[156:157], v172 offset:32768
  v_mfma_f32_16x16x32_bf16 v[116:119], v[24:27], v[36:39], v[116:119]
  ds_read_b64_tr_b16 v[158:159], v172 offset:33792
  v_mfma_f32_16x16x32_bf16 v[88:91], v[12:15], v[40:43], v[88:91]
  ds_read_b64_tr_b16 v[160:161], v173 offset:32768
  v_mfma_f32_16x16x32_bf16 v[128:131], v[164:167], v[28:31], v[128:131]
  ds_read_b64_tr_b16 v[162:163], v173 offset:33792
  v_mfma_f32_16x16x32_bf16 v[92:95], v[16:19], v[40:43], v[92:95]
  v_mfma_f32_16x16x32_bf16 v[44:47], v[164:167], v[32:35], v[44:47]
  v_mfma_f32_16x16x32_bf16 v[120:123], v[20:23], v[40:43], v[120:123]
  v_mfma_f32_16x16x32_bf16 v[124:127], v[24:27], v[40:43], v[124:127]
  s_waitcnt lgkmcnt(0)
  ds_read_b64_tr_b16 v[28:29], v170 offset:40960
  v_mfma_f32_16x16x32_bf16 v[64:67], v[132:135], v[148:151], v[64:67]
  ds_read_b64_tr_b16 v[30:31], v170 offset:41984
  v_mfma_f32_16x16x32_bf16 v[68:71], v[136:139], v[148:151], v[68:71]
  ds_read_b128 v[12:15], v169 offset:32768
  v_mfma_f32_16x16x32_bf16 v[96:99], v[140:143], v[148:151], v[96:99]
  ds_read_b128 v[16:19], v168 offset:33792
  v_mfma_f32_16x16x32_bf16 v[100:103], v[144:147], v[148:151], v[100:103]
  ds_read_b64_tr_b16 v[32:33], v171 offset:40960
  v_mfma_f32_16x16x32_bf16 v[72:75], v[132:135], v[152:155], v[72:75]
  ds_read_b64_tr_b16 v[34:35], v171 offset:41984
  v_mfma_f32_16x16x32_bf16 v[76:79], v[136:139], v[152:155], v[76:79]
  ds_read_b128 v[20:23], v169 offset:36864
  v_mfma_f32_16x16x32_bf16 v[104:107], v[140:143], v[152:155], v[104:107]
  ds_read_b128 v[24:27], v168 offset:37888
  v_mfma_f32_16x16x32_bf16 v[108:111], v[144:147], v[152:155], v[108:111]
  ds_read_b64_tr_b16 v[36:37], v172 offset:40960
  v_mfma_f32_16x16x32_bf16 v[80:83], v[132:135], v[156:159], v[80:83]
  ds_read_b64_tr_b16 v[38:39], v172 offset:41984
  v_mfma_f32_16x16x32_bf16 v[84:87], v[136:139], v[156:159], v[84:87]
  ds_read_b64_tr_b16 v[40:41], v173 offset:40960
  v_mfma_f32_16x16x32_bf16 v[112:115], v[140:143], v[156:159], v[112:115]
  ds_read_b64_tr_b16 v[42:43], v173 offset:41984
  v_mfma_f32_16x16x32_bf16 v[116:119], v[144:147], v[156:159], v[116:119]
  v_mfma_f32_16x16x32_bf16 v[88:91], v[132:135], v[160:163], v[88:91]
  v_mfma_f32_16x16x32_bf16 v[128:131], v[164:167], v[148:151], v[128:131]
  v_mfma_f32_16x16x32_bf16 v[92:95], v[136:139], v[160:163], v[92:95]
  v_mfma_f32_16x16x32_bf16 v[44:47], v[164:167], v[152:155], v[44:47]
  v_mfma_f32_16x16x32_bf16 v[120:123], v[140:143], v[160:163], v[120:123]
  v_mfma_f32_16x16x32_bf16 v[124:127], v[144:147], v[160:163], v[124:127]
  s_waitcnt lgkmcnt(0)
  v_mfma_f32_16x16x32_bf16 v[64:67], v[12:15], v[28:31], v[64:67]
  v_xor_b32 v168, 0x10000, v168
  v_xor_b32 v169, 0x10000, v169
  v_mfma_f32_16x16x32_bf16 v[68:71], v[16:19], v[28:31], v[68:71]
  v_xor_b32 v170, 0x10000, v170
  v_xor_b32 v171, 0x10000, v171
  v_mfma_f32_16x16x32_bf16 v[96:99], v[20:23], v[28:31], v[96:99]
  v_xor_b32 v172, 0x10000, v172
  v_xor_b32 v173, 0x10000, v173
  s_barrier
  ds_read_b64_tr_b16 v[148:149], v170 offset:0
  v_mfma_f32_16x16x32_bf16 v[100:103], v[24:27], v[28:31], v[100:103]
  ds_read_b64_tr_b16 v[150:151], v170 offset:1024
  v_mfma_f32_16x16x32_bf16 v[72:75], v[12:15], v[32:35], v[72:75]
  ds_read_b128 v[132:135], v168 offset:0
  v_mfma_f32_16x16x32_bf16 v[76:79], v[16:19], v[32:35], v[76:79]
  ds_read_b128 v[136:139], v169 offset:1024
  v_mfma_f32_16x16x32_bf16 v[104:107], v[20:23], v[32:35], v[104:107]
  ds_read_b64_tr_b16 v[152:153], v171 offset:0
  v_mfma_f32_16x16x32_bf16 v[108:111], v[24:27], v[32:35], v[108:111]
  ds_read_b64_tr_b16 v[154:155], v171 offset:1024
  v_mfma_f32_16x16x32_bf16 v[80:83], v[12:15], v[36:39], v[80:83]
  ds_read_b128 v[140:143], v168 offset:4096
  v_mfma_f32_16x16x32_bf16 v[84:87], v[16:19], v[36:39], v[84:87]
  ds_read_b128 v[144:147], v169 offset:5120
  v_mfma_f32_16x16x32_bf16 v[112:115], v[20:23], v[36:39], v[112:115]
  ds_read_b64_tr_b16 v[156:157], v172 offset:0
  v_mfma_f32_16x16x32_bf16 v[116:119], v[24:27], v[36:39], v[116:119]
  ds_read_b64_tr_b16 v[158:159], v172 offset:1024
  v_mfma_f32_16x16x32_bf16 v[88:91], v[12:15], v[40:43], v[88:91]
  ds_read_b64_tr_b16 v[160:161], v173 offset:0
  v_mfma_f32_16x16x32_bf16 v[128:131], v[164:167], v[28:31], v[128:131]
  ds_read_b64_tr_b16 v[162:163], v173 offset:1024
  v_mfma_f32_16x16x32_bf16 v[92:95], v[16:19], v[40:43], v[92:95]
  v_mfma_f32_16x16x32_bf16 v[44:47], v[164:167], v[32:35], v[44:47]
  v_mfma_f32_16x16x32_bf16 v[120:123], v[20:23], v[40:43], v[120:123]
  v_mfma_f32_16x16x32_bf16 v[124:127], v[24:27], v[40:43], v[124:127]
  s_sub_u32 s64, s64, 1
  s_cmp_lg_u32 s64, 0
  s_cbranch_scc1 LgV_66
  v_and_b32 v2, 15, v0
  v_lshrrev_b32 v6, 4, v0
  s_lshl_b32 s64, s44, 7
  s_add_u32 s64, s64, 157696
  v_lshrrev_b32 v5, 5, v0
  v_lshlrev_b32 v5, 6, v5
  v_and_b32 v6, 1, v6
  s_lshl_b32 s65, s54, 8
  s_add_u32 s65, s65, 131072
  v_lshl_add_u32 v5, v6, 4, v5
  v_add_u32 v5, s65, v5
  v_lshl_add_u32 v3, v2, 2, s64
  v_and_b32 v7, 31, v0
  v_lshl_add_u32 v7, v7, 2, s64
  s_mov_b32 vcc_lo, 0xffff0000
  s_mov_b32 vcc_hi, 0xffff0000
  v_cndmask_b32 v128, v128, v44, vcc
  ds_write_b32 v7, v128
  v_xor_b32 v4, 128, v3
  s_waitcnt lgkmcnt(0)
  s_barrier
  ds_read_b128 v[48:51], v5 offset:0
  ds_read_b128 v[32:35], v5 offset:28160
  ds_read_b128 v[52:55], v5 offset:32
  ds_read_b128 v[36:39], v5 offset:28192
  ds_read_b128 v[56:59], v5 offset:128
  ds_read_b128 v[40:43], v5 offset:28288
  ds_read_b128 v[60:63], v5 offset:160
  ds_read_b128 v[44:47], v5 offset:28320
  v_mov_b32 v10, 159744
  ds_read_b32 v11, v10
  ds_read_b32 v20, v3 offset:0
  ds_read_b32 v21, v3 offset:64
  ds_read_b32 v22, v4 offset:0
  ds_read_b32 v23, v4 offset:64
  s_waitcnt lgkmcnt(2)
  v_readfirstlane_b32 s51, v11
  v_pk_fma_f32 v[64:65], v[48:49], v[20:21], v[64:65] op_sel:[0,0,0] op_sel_hi:[1,0,1]
  v_pk_fma_f32 v[66:67], v[50:51], v[20:21], v[66:67] op_sel:[0,0,0] op_sel_hi:[1,0,1]
  v_pk_fma_f32 v[68:69], v[52:53], v[20:21], v[68:69] op_sel:[0,0,0] op_sel_hi:[1,0,1]
  v_pk_fma_f32 v[70:71], v[54:55], v[20:21], v[70:71] op_sel:[0,0,0] op_sel_hi:[1,0,1]
  v_pk_mul_f32 v[64:65], v[64:65], v[32:33]
  v_pk_mul_f32 v[66:67], v[66:67], v[34:35]
  v_pk_mul_f32 v[68:69], v[68:69], v[36:37]
  v_pk_mul_f32 v[70:71], v[70:71], v[38:39]
  v_cvt_pk_bf16_f32 v64, v64, v65
  v_cvt_pk_bf16_f32 v65, v66, v67
  v_cvt_pk_bf16_f32 v66, v68, v69
  v_cvt_pk_bf16_f32 v67, v70, v71
  buffer_store_dwordx4 v[64:67], v174, s[32:35], s58 offen
  v_pk_fma_f32 v[72:73], v[48:49], v[20:21], v[72:73] op_sel:[0,1,0] op_sel_hi:[1,1,1]
  v_pk_fma_f32 v[74:75], v[50:51], v[20:21], v[74:75] op_sel:[0,1,0] op_sel_hi:[1,1,1]
  v_pk_fma_f32 v[76:77], v[52:53], v[20:21], v[76:77] op_sel:[0,1,0] op_sel_hi:[1,1,1]
  v_pk_fma_f32 v[78:79], v[54:55], v[20:21], v[78:79] op_sel:[0,1,0] op_sel_hi:[1,1,1]
  v_pk_mul_f32 v[72:73], v[72:73], v[32:33]
  v_pk_mul_f32 v[74:75], v[74:75], v[34:35]
  v_pk_mul_f32 v[76:77], v[76:77], v[36:37]
  v_pk_mul_f32 v[78:79], v[78:79], v[38:39]
  v_cvt_pk_bf16_f32 v68, v72, v73
  v_cvt_pk_bf16_f32 v69, v74, v75
  v_cvt_pk_bf16_f32 v70, v76, v77
  v_cvt_pk_bf16_f32 v71, v78, v79
  buffer_store_dwordx4 v[68:71], v175, s[32:35], s58 offen
  v_pk_fma_f32 v[96:97], v[56:57], v[20:21], v[96:97] op_sel:[0,0,0] op_sel_hi:[1,0,1]
  v_pk_fma_f32 v[98:99], v[58:59], v[20:21], v[98:99] op_sel:[0,0,0] op_sel_hi:[1,0,1]
  v_pk_fma_f32 v[100:101], v[60:61], v[20:21], v[100:101] op_sel:[0,0,0] op_sel_hi:[1,0,1]
  v_pk_fma_f32 v[102:103], v[62:63], v[20:21], v[102:103] op_sel:[0,0,0] op_sel_hi:[1,0,1]
  v_pk_mul_f32 v[96:97], v[96:97], v[40:41]
  v_pk_mul_f32 v[98:99], v[98:99], v[42:43]
  v_pk_mul_f32 v[100:101], v[100:101], v[44:45]
  v_pk_mul_f32 v[102:103], v[102:103], v[46:47]
  v_cvt_pk_bf16_f32 v96, v96, v97
  v_cvt_pk_bf16_f32 v97, v98, v99
  v_cvt_pk_bf16_f32 v98, v100, v101
  v_cvt_pk_bf16_f32 v99, v102, v103
  buffer_store_dwordx4 v[96:99], v174, s[32:35], s61 offen
  v_pk_fma_f32 v[104:105], v[56:57], v[20:21], v[104:105] op_sel:[0,1,0] op_sel_hi:[1,1,1]
  v_pk_fma_f32 v[106:107], v[58:59], v[20:21], v[106:107] op_sel:[0,1,0] op_sel_hi:[1,1,1]
  v_pk_fma_f32 v[108:109], v[60:61], v[20:21], v[108:109] op_sel:[0,1,0] op_sel_hi:[1,1,1]
  v_pk_fma_f32 v[110:111], v[62:63], v[20:21], v[110:111] op_sel:[0,1,0] op_sel_hi:[1,1,1]
  v_pk_mul_f32 v[104:105], v[104:105], v[40:41]
  v_pk_mul_f32 v[106:107], v[106:107], v[42:43]
  v_pk_mul_f32 v[108:109], v[108:109], v[44:45]
  v_pk_mul_f32 v[110:111], v[110:111], v[46:47]
  v_cvt_pk_bf16_f32 v100, v104, v105
  v_cvt_pk_bf16_f32 v101, v106, v107
  v_cvt_pk_bf16_f32 v102, v108, v109
  v_cvt_pk_bf16_f32 v103, v110, v111
  buffer_store_dwordx4 v[100:103], v175, s[32:35], s61 offen
  s_waitcnt lgkmcnt(0)
  v_pk_fma_f32 v[80:81], v[48:49], v[22:23], v[80:81] op_sel:[0,0,0] op_sel_hi:[1,0,1]
  v_pk_fma_f32 v[82:83], v[50:51], v[22:23], v[82:83] op_sel:[0,0,0] op_sel_hi:[1,0,1]
  v_pk_fma_f32 v[84:85], v[52:53], v[22:23], v[84:85] op_sel:[0,0,0] op_sel_hi:[1,0,1]
  v_pk_fma_f32 v[86:87], v[54:55], v[22:23], v[86:87] op_sel:[0,0,0] op_sel_hi:[1,0,1]
  v_pk_mul_f32 v[80:81], v[80:81], v[32:33]
  v_pk_mul_f32 v[82:83], v[82:83], v[34:35]
  v_pk_mul_f32 v[84:85], v[84:85], v[36:37]
  v_pk_mul_f32 v[86:87], v[86:87], v[38:39]
  v_cvt_pk_bf16_f32 v80, v80, v81
  v_cvt_pk_bf16_f32 v81, v82, v83
  v_cvt_pk_bf16_f32 v82, v84, v85
  v_cvt_pk_bf16_f32 v83, v86, v87
  buffer_store_dwordx4 v[80:83], v176, s[32:35], s58 offen
  v_pk_fma_f32 v[88:89], v[48:49], v[22:23], v[88:89] op_sel:[0,1,0] op_sel_hi:[1,1,1]
  v_pk_fma_f32 v[90:91], v[50:51], v[22:23], v[90:91] op_sel:[0,1,0] op_sel_hi:[1,1,1]
  v_pk_fma_f32 v[92:93], v[52:53], v[22:23], v[92:93] op_sel:[0,1,0] op_sel_hi:[1,1,1]
  v_pk_fma_f32 v[94:95], v[54:55], v[22:23], v[94:95] op_sel:[0,1,0] op_sel_hi:[1,1,1]
  v_pk_mul_f32 v[88:89], v[88:89], v[32:33]
  v_pk_mul_f32 v[90:91], v[90:91], v[34:35]
  v_pk_mul_f32 v[92:93], v[92:93], v[36:37]
  v_pk_mul_f32 v[94:95], v[94:95], v[38:39]
  v_cvt_pk_bf16_f32 v84, v88, v89
  v_cvt_pk_bf16_f32 v85, v90, v91
  v_cvt_pk_bf16_f32 v86, v92, v93
  v_cvt_pk_bf16_f32 v87, v94, v95
  buffer_store_dwordx4 v[84:87], v177, s[32:35], s58 offen
  v_pk_fma_f32 v[112:113], v[56:57], v[22:23], v[112:113] op_sel:[0,0,0] op_sel_hi:[1,0,1]
  v_pk_fma_f32 v[114:115], v[58:59], v[22:23], v[114:115] op_sel:[0,0,0] op_sel_hi:[1,0,1]
  v_pk_fma_f32 v[116:117], v[60:61], v[22:23], v[116:117] op_sel:[0,0,0] op_sel_hi:[1,0,1]
  v_pk_fma_f32 v[118:119], v[62:63], v[22:23], v[118:119] op_sel:[0,0,0] op_sel_hi:[1,0,1]
  v_pk_mul_f32 v[112:113], v[112:113], v[40:41]
  v_pk_mul_f32 v[114:115], v[114:115], v[42:43]
  v_pk_mul_f32 v[116:117], v[116:117], v[44:45]
  v_pk_mul_f32 v[118:119], v[118:119], v[46:47]
  v_cvt_pk_bf16_f32 v112, v112, v113
  v_cvt_pk_bf16_f32 v113, v114, v115
  v_cvt_pk_bf16_f32 v114, v116, v117
  v_cvt_pk_bf16_f32 v115, v118, v119
  buffer_store_dwordx4 v[112:115], v176, s[32:35], s61 offen
  v_pk_fma_f32 v[120:121], v[56:57], v[22:23], v[120:121] op_sel:[0,1,0] op_sel_hi:[1,1,1]
  v_pk_fma_f32 v[122:123], v[58:59], v[22:23], v[122:123] op_sel:[0,1,0] op_sel_hi:[1,1,1]
  v_pk_fma_f32 v[124:125], v[60:61], v[22:23], v[124:125] op_sel:[0,1,0] op_sel_hi:[1,1,1]
  v_pk_fma_f32 v[126:127], v[62:63], v[22:23], v[126:127] op_sel:[0,1,0] op_sel_hi:[1,1,1]
  v_pk_mul_f32 v[120:121], v[120:121], v[40:41]
  v_pk_mul_f32 v[122:123], v[122:123], v[42:43]
  v_pk_mul_f32 v[124:125], v[124:125], v[44:45]
  v_pk_mul_f32 v[126:127], v[126:127], v[46:47]
  v_cvt_pk_bf16_f32 v116, v120, v121
  v_cvt_pk_bf16_f32 v117, v122, v123
  v_cvt_pk_bf16_f32 v118, v124, v125
  v_cvt_pk_bf16_f32 v119, v126, v127
  buffer_store_dwordx4 v[116:119], v177, s[32:35], s61 offen
  s_cmp_lg_u32 s51, 0
  s_cbranch_scc1 Lqslow_73
Lqjn_74:
  v_mov_b32 v2, 0
  v_mov_b32 v3, s53
  s_add_u32 s64, s58, 5242880
  s_add_u32 s65, s61, 5242880
  s_waitcnt vmcnt(0)
  s_mov_b64 exec, 1
  s_cmp_lg_u32 s51, 0
  s_cbranch_scc1 Lslow_77
  buffer_store_dword v3, v2, s[32:35], s60 offen
  s_branch Ljn_78
Lslow_77:
  buffer_store_dword v3, v2, s[32:35], s60 offen sc1
Ljn_78:
  s_mov_b64 exec, -1
  s_cmp_eq_u32 s59, 0
  s_cbranch_scc1 Lnohalo_75
  buffer_store_dwordx4 v[64:67], v174, s[32:35], s64 offen sc1
  buffer_store_dwordx4 v[68:71], v175, s[32:35], s64 offen sc1
  buffer_store_dwordx4 v[80:83], v176, s[32:35], s64 offen sc1
  buffer_store_dwordx4 v[84:87], v177, s[32:35], s64 offen sc1
  buffer_store_dwordx4 v[96:99], v174, s[32:35], s65 offen sc1
  buffer_store_dwordx4 v[100:103], v175, s[32:35], s65 offen sc1
  buffer_store_dwordx4 v[112:115], v176, s[32:35], s65 offen sc1
  buffer_store_dwordx4 v[116:119], v177, s[32:35], s65 offen sc1
Lnohalo_75:
  s_branch L_att
.p2alignl 12, 0xbf810000
L_av0:
  ds_read_b128 v[48:51], v216 offset:39424
  ds_read_b64 v[52:53], v217 offset:39424
  ds_read_b128 v[62:65], v248 offset:39424
  ds_read_b64 v[66:67], v249 offset:39424
  s_mov_b64 exec, s[78:79]
  ds_read_b128 v[54:57], v218 offset:39424
  ds_read_b128 v[58:61], v218 offset:40064
  s_mov_b64 exec, -1
  s_waitcnt lgkmcnt(0)
  v_mfma_f32_32x32x16_bf16 v[80:95], v[48:51], v[28:31], v[200:215]
  v_mfma_f32_32x32x8_bf16 v[80:95], v[52:53], v[32:33], v[80:95]
  s_nop 7
  s_nop 3
  v_exp_f32 v80, v80
  v_exp_f32 v81, v81
  v_exp_f32 v82, v82
  ds_read_b128 v[48:51], v216 offset:33792
  ds_read_b64 v[52:53], v217 offset:33792
  v_exp_f32 v83, v83
  v_cvt_pk_bf16_f32 v40, v80, v81
  v_cvt_pk_bf16_f32 v41, v82, v83
  v_mfma_f32_32x32x16_bf16 v[96:111], v[62:65], v[28:31], 0
  v_exp_f32 v84, v84
  v_exp_f32 v85, v85
  s_mov_b64 exec, s[78:79]
  ds_read_b128 v[68:71], v250 offset:39424
  ds_read_b128 v[72:75], v250 offset:40064
  s_mov_b64 exec, -1
  v_exp_f32 v86, v86
  v_exp_f32 v87, v87
  v_cvt_pk_bf16_f32 v42, v84, v85
  v_cvt_pk_bf16_f32 v43, v86, v87
  v_mfma_f32_32x32x8_bf16 v[96:111], v[66:67], v[32:33], v[96:111]
  v_exp_f32 v88, v88
  v_exp_f32 v89, v89
  v_exp_f32 v90, v90
  v_exp_f32 v91, v91
  v_mfma_f32_32x32x16_bf16 v[112:127], v[54:57], v[40:43], 0
  v_cvt_pk_bf16_f32 v44, v88, v89
  v_cvt_pk_bf16_f32 v45, v90, v91
  v_exp_f32 v92, v92
  v_exp_f32 v93, v93
  v_exp_f32 v94, v94
  v_exp_f32 v95, v95
  v_cvt_pk_bf16_f32 v46, v92, v93
  v_cvt_pk_bf16_f32 v47, v94, v95
  v_exp_f32 v96, v96
  v_exp_f32 v97, v97
  v_mfma_f32_32x32x16_bf16 v[112:127], v[58:61], v[44:47], v[112:127]
  v_exp_f32 v98, v98
  ds_read_b128 v[62:65], v248 offset:33792
  ds_read_b64 v[66:67], v249 offset:33792
  v_exp_f32 v99, v99
  v_cvt_pk_bf16_f32 v40, v96, v97
  v_cvt_pk_bf16_f32 v41, v98, v99
  s_waitcnt lgkmcnt(2)
  v_mfma_f32_32x32x16_bf16 v[80:95], v[48:51], v[28:31], 0
  v_exp_f32 v100, v100
  v_exp_f32 v101, v101
  s_mov_b64 exec, s[78:79]
  ds_read_b128 v[54:57], v218 offset:33792
  ds_read_b128 v[58:61], v218 offset:34432
  s_mov_b64 exec, -1
  v_exp_f32 v102, v102
  v_exp_f32 v103, v103
  v_cvt_pk_bf16_f32 v42, v100, v101
  v_cvt_pk_bf16_f32 v43, v102, v103
  v_mfma_f32_32x32x8_bf16 v[80:95], v[52:53], v[32:33], v[80:95]
  v_exp_f32 v104, v104
  v_exp_f32 v105, v105
  v_exp_f32 v106, v106
  v_exp_f32 v107, v107
  v_mfma_f32_32x32x16_bf16 v[112:127], v[68:71], v[40:43], v[112:127]
  v_cvt_pk_bf16_f32 v44, v104, v105
  v_cvt_pk_bf16_f32 v45, v106, v107
  v_exp_f32 v108, v108
  v_exp_f32 v109, v109
  v_exp_f32 v110, v110
  v_exp_f32 v111, v111
  v_cvt_pk_bf16_f32 v46, v108, v109
  v_cvt_pk_bf16_f32 v47, v110, v111
  v_exp_f32 v80, v80
  v_exp_f32 v81, v81
  v_mfma_f32_32x32x16_bf16 v[112:127], v[72:75], v[44:47], v[112:127]
  v_exp_f32 v82, v82
  ds_read_b128 v[48:51], v216 offset:28160
  ds_read_b64 v[52:53], v217 offset:28160
  v_exp_f32 v83, v83
  v_cvt_pk_bf16_f32 v40, v80, v81
  v_cvt_pk_bf16_f32 v41, v82, v83
  s_waitcnt lgkmcnt(2)
  v_mfma_f32_32x32x16_bf16 v[96:111], v[62:65], v[28:31], 0
  v_exp_f32 v84, v84
  v_exp_f32 v85, v85
  s_mov_b64 exec, s[78:79]
  ds_read_b128 v[68:71], v250 offset:33792
  ds_read_b128 v[72:75], v250 offset:34432
  s_mov_b64 exec, -1
  v_exp_f32 v86, v86
  v_exp_f32 v87, v87
  v_cvt_pk_bf16_f32 v42, v84, v85
  v_cvt_pk_bf16_f32 v43, v86, v87
  v_mfma_f32_32x32x8_bf16 v[96:111], v[66:67], v[32:33], v[96:111]
  v_exp_f32 v88, v88
  v_exp_f32 v89, v89
  v_exp_f32 v90, v90
  v_exp_f32 v91, v91
  v_mfma_f32_32x32x16_bf16 v[112:127], v[54:57], v[40:43], v[112:127]
  v_cvt_pk_bf16_f32 v44, v88, v89
  v_cvt_pk_bf16_f32 v45, v90, v91
  v_exp_f32 v92, v92
  v_exp_f32 v93, v93
  v_exp_f32 v94, v94
  v_exp_f32 v95, v95
  v_cvt_pk_bf16_f32 v46, v92, v93
  v_cvt_pk_bf16_f32 v47, v94, v95
  v_exp_f32 v96, v96
  v_exp_f32 v97, v97
  v_mfma_f32_32x32x16_bf16 v[112:127], v[58:61], v[44:47], v[112:127]
  v_exp_f32 v98, v98
  ds_read_b128 v[62:65], v248 offset:28160
  ds_read_b64 v[66:67], v249 offset:28160
  v_exp_f32 v99, v99
  v_cvt_pk_bf16_f32 v40, v96, v97
  v_cvt_pk_bf16_f32 v41, v98, v99
  s_waitcnt lgkmcnt(2)
  v_mfma_f32_32x32x16_bf16 v[80:95], v[48:51], v[28:31], 0
  v_exp_f32 v100, v100
  v_exp_f32 v101, v101
  s_mov_b64 exec, s[78:79]
  ds_read_b128 v[54:57], v218 offset:28160
  ds_read_b128 v[58:61], v218 offset:28800
  s_mov_b64 exec, -1
  v_exp_f32 v102, v102
  v_exp_f32 v103, v103
  v_cvt_pk_bf16_f32 v42, v100, v101
  v_cvt_pk_bf16_f32 v43, v102, v103
  v_mfma_f32_32x32x8_bf16 v[80:95], v[52:53], v[32:33], v[80:95]
  v_exp_f32 v104, v104
  v_exp_f32 v105, v105
  v_exp_f32 v106, v106
  v_exp_f32 v107, v107
  v_mfma_f32_32x32x16_bf16 v[112:127], v[68:71], v[40:43], v[112:127]
  v_cvt_pk_bf16_f32 v44, v104, v105
  v_cvt_pk_bf16_f32 v45, v106, v107
  v_exp_f32 v108, v108
  v_exp_f32 v109, v109
  v_exp_f32 v110, v110
  v_exp_f32 v111, v111
  v_cvt_pk_bf16_f32 v46, v108, v109
  v_cvt_pk_bf16_f32 v47, v110, v111
  v_exp_f32 v80, v80
  v_exp_f32 v81, v81
  v_mfma_f32_32x32x16_bf16 v[112:127], v[72:75], v[44:47], v[112:127]
  v_exp_f32 v82, v82
  ds_read_b128 v[48:51], v216 offset:22528
  ds_read_b64 v[52:53], v217 offset:22528
  v_exp_f32 v83, v83
  v_cvt_pk_bf16_f32 v40, v80, v81
  v_cvt_pk_bf16_f32 v41, v82, v83
  s_waitcnt lgkmcnt(2)
  v_mfma_f32_32x32x16_bf16 v[96:111], v[62:65], v[28:31], 0
  v_exp_f32 v84, v84
  v_exp_f32 v85, v85
  s_mov_b64 exec, s[78:79]
  ds_read_b128 v[68:71], v250 offset:28160
  ds_read_b128 v[72:75], v250 offset:28800
  s_mov_b64 exec, -1
  v_exp_f32 v86, v86
  v_exp_f32 v87, v87
  v_cvt_pk_bf16_f32 v42, v84, v85
  v_cvt_pk_bf16_f32 v43, v86, v87
  v_mfma_f32_32x32x8_bf16 v[96:111], v[66:67], v[32:33], v[96:111]
  v_exp_f32 v88, v88
  v_exp_f32 v89, v89
  v_exp_f32 v90, v90
  v_exp_f32 v91, v91
  v_mfma_f32_32x32x16_bf16 v[112:127], v[54:57], v[40:43], v[112:127]
  v_cvt_pk_bf16_f32 v44, v88, v89
  v_cvt_pk_bf16_f32 v45, v90, v91
  v_exp_f32 v92, v92
  v_exp_f32 v93, v93
  v_exp_f32 v94, v94
  v_exp_f32 v95, v95
  v_cvt_pk_bf16_f32 v46, v92, v93
  v_cvt_pk_bf16_f32 v47, v94, v95
  v_exp_f32 v96, v96
  v_exp_f32 v97, v97
  v_mfma_f32_32x32x16_bf16 v[112:127], v[58:61], v[44:47], v[112:127]
  v_exp_f32 v98, v98
  ds_read_b128 v[62:65], v248 offset:22528
  ds_read_b64 v[66:67], v249 offset:22528
  v_exp_f32 v99, v99
  v_cvt_pk_bf16_f32 v40, v96, v97
  v_cvt_pk_bf16_f32 v41, v98, v99
  s_waitcnt lgkmcnt(2)
  v_mfma_f32_32x32x16_bf16 v[80:95], v[48:51], v[28:31], 0
  v_exp_f32 v100, v100
  v_exp_f32 v101, v101
  s_mov_b64 exec, s[78:79]
  ds_read_b128 v[54:57], v218 offset:22528
  ds_read_b128 v[58:61], v218 offset:23168
  s_mov_b64 exec, -1
  v_exp_f32 v102, v102
  v_exp_f32 v103, v103
  v_cvt_pk_bf16_f32 v42, v100, v101
  v_cvt_pk_bf16_f32 v43, v102, v103
  v_mfma_f32_32x32x8_bf16 v[80:95], v[52:53], v[32:33], v[80:95]
  v_exp_f32 v104, v104
  v_exp_f32 v105, v105
  v_exp_f32 v106, v106
  v_exp_f32 v107, v107
  v_mfma_f32_32x32x16_bf16 v[112:127], v[68:71], v[40:43], v[112:127]
  v_cvt_pk_bf16_f32 v44, v104, v105
  v_cvt_pk_bf16_f32 v45, v106, v107
  v_exp_f32 v108, v108
  v_exp_f32 v109, v109
  v_exp_f32 v110, v110
  v_exp_f32 v111, v111
  v_cvt_pk_bf16_f32 v46, v108, v109
  v_cvt_pk_bf16_f32 v47, v110, v111
  v_exp_f32 v80, v80
  v_exp_f32 v81, v81
  v_mfma_f32_32x32x16_bf16 v[112:127], v[72:75], v[44:47], v[112:127]
  v_exp_f32 v82, v82
  ds_read_b32 v2, v251 offset:112
  v_exp_f32 v83, v83
  v_cvt_pk_bf16_f32 v40, v80, v81
  v_cvt_pk_bf16_f32 v41, v82, v83
  s_waitcnt lgkmcnt(1)
  v_mfma_f32_32x32x16_bf16 v[96:111], v[62:65], v[28:31], 0
  v_exp_f32 v84, v84
  v_exp_f32 v85, v85
  s_mov_b64 exec, s[78:79]
  ds_read_b128 v[68:71], v250 offset:22528
  ds_read_b128 v[72:75], v250 offset:23168
  s_mov_b64 exec, -1
  v_exp_f32 v86, v86
  v_exp_f32 v87, v87
  v_cvt_pk_bf16_f32 v42, v84, v85
  v_cvt_pk_bf16_f32 v43, v86, v87
  v_mfma_f32_32x32x8_bf16 v[96:111], v[66:67], v[32:33], v[96:111]
  v_exp_f32 v88, v88
  v_exp_f32 v89, v89
  v_exp_f32 v90, v90
  v_exp_f32 v91, v91
  v_mfma_f32_32x32x16_bf16 v[112:127], v[54:57], v[40:43], v[112:127]
  v_cvt_pk_bf16_f32 v44, v88, v89
  v_cvt_pk_bf16_f32 v45, v90, v91
  v_exp_f32 v92, v92
  v_exp_f32 v93, v93
  v_exp_f32 v94, v94
  v_exp_f32 v95, v95
  v_cvt_pk_bf16_f32 v46, v92, v93
  v_cvt_pk_bf16_f32 v47, v94, v95
  v_exp_f32 v96, v96
  v_exp_f32 v97, v97
  v_mfma_f32_32x32x16_bf16 v[112:127], v[58:61], v[44:47], v[112:127]
  v_exp_f32 v98, v98
  v_exp_f32 v99, v99
  v_cvt_pk_bf16_f32 v40, v96, v97
  v_cvt_pk_bf16_f32 v41, v98, v99
  s_waitcnt lgkmcnt(0)
  v_mfma_f32_32x32x16_bf16 v[80:95], v[62:65], v[34:37], v[200:215]
  v_exp_f32 v100, v100
  v_cmp_gt_u32 vcc, 1, v2
  v_exp_f32 v101, v101
  s_cbranch_vccnz L_g2w00
L_g2r00:
  ds_read_b128 v[48:51], v216 offset:16896
  ds_read_b64 v[52:53], v217 offset:16896
  v_exp_f32 v102, v102
  v_exp_f32 v103, v103
  v_cvt_pk_bf16_f32 v42, v100, v101
  v_cvt_pk_bf16_f32 v43, v102, v103
  v_mfma_f32_32x32x8_bf16 v[80:95], v[66:67], v[38:39], v[80:95]
  v_exp_f32 v104, v104
  v_exp_f32 v105, v105
  v_exp_f32 v106, v106
  v_exp_f32 v107, v107
  v_mfma_f32_32x32x16_bf16 v[112:127], v[68:71], v[40:43], v[112:127]
  v_cvt_pk_bf16_f32 v44, v104, v105
  v_cvt_pk_bf16_f32 v45, v106, v107
  v_exp_f32 v108, v108
  v_exp_f32 v109, v109
  v_exp_f32 v110, v110
  v_exp_f32 v111, v111
  v_cvt_pk_bf16_f32 v46, v108, v109
  v_cvt_pk_bf16_f32 v47, v110, v111
  v_exp_f32 v80, v80
  v_exp_f32 v81, v81
  v_mfma_f32_32x32x16_bf16 v[112:127], v[72:75], v[44:47], v[112:127]
  v_exp_f32 v82, v82
  v_exp_f32 v83, v83
  v_cvt_pk_bf16_f32 v40, v80, v81
  v_cvt_pk_bf16_f32 v41, v82, v83
  s_waitcnt lgkmcnt(0)
  v_mfma_f32_32x32x16_bf16 v[96:111], v[48:51], v[28:31], v[230:245]
  v_exp_f32 v84, v84
  v_exp_f32 v85, v85
  s_mov_b64 exec, s[78:79]
  ds_read_b128 v[54:57], v218 offset:16896
  ds_read_b128 v[58:61], v218 offset:17536
  s_mov_b64 exec, -1
  v_exp_f32 v86, v86
  v_exp_f32 v87, v87
  v_cvt_pk_bf16_f32 v42, v84, v85
  v_cvt_pk_bf16_f32 v43, v86, v87
  v_mfma_f32_32x32x8_bf16 v[96:111], v[52:53], v[32:33], v[96:111]
  v_exp_f32 v88, v88
  v_exp_f32 v89, v89
  v_exp_f32 v90, v90
  v_exp_f32 v91, v91
  v_mfma_f32_32x32x16_bf16 v[128:143], v[68:71], v[40:43], 0
  v_cvt_pk_bf16_f32 v44, v88, v89
  v_cvt_pk_bf16_f32 v45, v90, v91
  v_exp_f32 v92, v92
  v_exp_f32 v93, v93
  v_exp_f32 v94, v94
  v_exp_f32 v95, v95
  v_cvt_pk_bf16_f32 v46, v92, v93
  v_cvt_pk_bf16_f32 v47, v94, v95
  s_cmp_eq_u32 s23, 0
  s_cbranch_scc1 L_ex0
  v_exp_f32 v96, v96
  v_exp_f32 v97, v97
  v_mfma_f32_32x32x16_bf16 v[128:143], v[72:75], v[44:47], v[128:143]
  v_exp_f32 v98, v98
  ds_read_b128 v[62:65], v248 offset:16896
  ds_read_b64 v[66:67], v249 offset:16896
  v_exp_f32 v99, v99
  v_cvt_pk_bf16_f32 v40, v96, v97
  v_cvt_pk_bf16_f32 v41, v98, v99
  s_waitcnt lgkmcnt(2)
  v_mfma_f32_32x32x16_bf16 v[80:95], v[48:51], v[34:37], 0
  v_exp_f32 v100, v100
  v_exp_f32 v101, v101
  v_exp_f32 v102, v102
  v_exp_f32 v103, v103
  v_cvt_pk_bf16_f32 v42, v100, v101
  v_cvt_pk_bf16_f32 v43, v102, v103
  v_mfma_f32_32x32x8_bf16 v[80:95], v[52:53], v[38:39], v[80:95]
  v_exp_f32 v104, v104
  v_exp_f32 v105, v105
  v_exp_f32 v106, v106
  v_exp_f32 v107, v107
  v_mfma_f32_32x32x16_bf16 v[112:127], v[54:57], v[40:43], v[112:127]
  v_cvt_pk_bf16_f32 v44, v104, v105
  v_cvt_pk_bf16_f32 v45, v106, v107
  v_exp_f32 v108, v108
  v_exp_f32 v109, v109
  v_exp_f32 v110, v110
  v_exp_f32 v111, v111
  v_cvt_pk_bf16_f32 v46, v108, v109
  v_cvt_pk_bf16_f32 v47, v110, v111
  v_exp_f32 v80, v80
  v_exp_f32 v81, v81
  v_mfma_f32_32x32x16_bf16 v[112:127], v[58:61], v[44:47], v[112:127]
  v_exp_f32 v82, v82
  ds_read_b128 v[48:51], v216 offset:11264
  ds_read_b64 v[52:53], v217 offset:11264
  v_exp_f32 v83, v83
  v_cvt_pk_bf16_f32 v40, v80, v81
  v_cvt_pk_bf16_f32 v41, v82, v83
  s_waitcnt lgkmcnt(2)
  v_mfma_f32_32x32x16_bf16 v[96:111], v[62:65], v[34:37], 0
  v_exp_f32 v84, v84
  v_exp_f32 v85, v85
  s_mov_b64 exec, s[78:79]
  ds_read_b128 v[68:71], v250 offset:16896
  ds_read_b128 v[72:75], v250 offset:17536
  s_mov_b64 exec, -1
  v_exp_f32 v86, v86
  v_exp_f32 v87, v87
  v_cvt_pk_bf16_f32 v42, v84, v85
  v_cvt_pk_bf16_f32 v43, v86, v87
  v_mfma_f32_32x32x8_bf16 v[96:111], v[66:67], v[38:39], v[96:111]
  v_exp_f32 v88, v88
  v_exp_f32 v89, v89
  v_exp_f32 v90, v90
  v_exp_f32 v91, v91
  v_mfma_f32_32x32x16_bf16 v[128:143], v[54:57], v[40:43], v[128:143]
  v_cvt_pk_bf16_f32 v44, v88, v89
  v_cvt_pk_bf16_f32 v45, v90, v91
  v_exp_f32 v92, v92
  v_exp_f32 v93, v93
  v_exp_f32 v94, v94
  v_exp_f32 v95, v95
  v_cvt_pk_bf16_f32 v46, v92, v93
  v_cvt_pk_bf16_f32 v47, v94, v95
  v_exp_f32 v96, v96
  v_exp_f32 v97, v97
  v_mfma_f32_32x32x16_bf16 v[128:143], v[58:61], v[44:47], v[128:143]
  v_exp_f32 v98, v98
  ds_read_b128 v[62:65], v248 offset:11264
  ds_read_b64 v[66:67], v249 offset:11264
  ds_read_b32 v2, v251 offset:116
  v_exp_f32 v99, v99
  v_cvt_pk_bf16_f32 v40, v96, v97
  v_cvt_pk_bf16_f32 v41, v98, v99
  s_waitcnt lgkmcnt(3)
  v_mfma_f32_32x32x16_bf16 v[80:95], v[48:51], v[34:37], 0
  v_exp_f32 v100, v100
  v_exp_f32 v101, v101
  s_mov_b64 exec, s[78:79]
  ds_read_b128 v[54:57], v218 offset:11264
  ds_read_b128 v[58:61], v218 offset:11904
  s_mov_b64 exec, -1
  v_exp_f32 v102, v102
  v_exp_f32 v103, v103
  v_cvt_pk_bf16_f32 v42, v100, v101
  v_cvt_pk_bf16_f32 v43, v102, v103
  v_mfma_f32_32x32x8_bf16 v[80:95], v[52:53], v[38:39], v[80:95]
  v_exp_f32 v104, v104
  v_exp_f32 v105, v105
  v_exp_f32 v106, v106
  v_exp_f32 v107, v107
  v_mfma_f32_32x32x16_bf16 v[128:143], v[68:71], v[40:43], v[128:143]
  v_cvt_pk_bf16_f32 v44, v104, v105
  v_cvt_pk_bf16_f32 v45, v106, v107
  v_exp_f32 v108, v108
  v_exp_f32 v109, v109
  v_exp_f32 v110, v110
  v_exp_f32 v111, v111
  v_cvt_pk_bf16_f32 v46, v108, v109
  v_cvt_pk_bf16_f32 v47, v110, v111
  v_exp_f32 v80, v80
  v_exp_f32 v81, v81
  v_mfma_f32_32x32x16_bf16 v[128:143], v[72:75], v[44:47], v[128:143]
  v_exp_f32 v82, v82
  v_exp_f32 v83, v83
  v_cvt_pk_bf16_f32 v40, v80, v81
  v_cvt_pk_bf16_f32 v41, v82, v83
  s_waitcnt lgkmcnt(0)
  v_mfma_f32_32x32x16_bf16 v[96:111], v[62:65], v[34:37], 0
  v_exp_f32 v84, v84
  v_cmp_gt_u32 vcc, 1, v2
  v_exp_f32 v85, v85
  s_cbranch_vccnz L_g2w01
L_g2r01:
  ds_read_b128 v[48:51], v216 offset:5632
  ds_read_b64 v[52:53], v217 offset:5632
  s_mov_b64 exec, s[78:79]
  ds_read_b128 v[68:71], v250 offset:11264
  ds_read_b128 v[72:75], v250 offset:11904
  s_mov_b64 exec, -1
  v_exp_f32 v86, v86
  v_exp_f32 v87, v87
  v_cvt_pk_bf16_f32 v42, v84, v85
  v_cvt_pk_bf16_f32 v43, v86, v87
  v_mfma_f32_32x32x8_bf16 v[96:111], v[66:67], v[38:39], v[96:111]
  v_exp_f32 v88, v88
  v_exp_f32 v89, v89
  v_exp_f32 v90, v90
  v_exp_f32 v91, v91
  v_mfma_f32_32x32x16_bf16 v[128:143], v[54:57], v[40:43], v[128:143]
  v_cvt_pk_bf16_f32 v44, v88, v89
  v_cvt_pk_bf16_f32 v45, v90, v91
  v_exp_f32 v92, v92
  v_exp_f32 v93, v93
  v_exp_f32 v94, v94
  v_exp_f32 v95, v95
  v_cvt_pk_bf16_f32 v46, v92, v93
  v_cvt_pk_bf16_f32 v47, v94, v95
  v_exp_f32 v96, v96
  v_exp_f32 v97, v97
  v_mfma_f32_32x32x16_bf16 v[128:143], v[58:61], v[44:47], v[128:143]
  v_exp_f32 v98, v98
  ds_read_b128 v[62:65], v248 offset:5632
  ds_read_b64 v[66:67], v249 offset:5632
  v_exp_f32 v99, v99
  v_cvt_pk_bf16_f32 v40, v96, v97
  v_cvt_pk_bf16_f32 v41, v98, v99
  s_waitcnt lgkmcnt(2)
  v_mfma_f32_32x32x16_bf16 v[80:95], v[48:51], v[34:37], 0
  v_exp_f32 v100, v100
  v_exp_f32 v101, v101
  s_mov_b64 exec, s[78:79]
  ds_read_b128 v[54:57], v218 offset:5632
  ds_read_b128 v[58:61], v218 offset:6272
  s_mov_b64 exec, -1
  v_exp_f32 v102, v102
  v_exp_f32 v103, v103
  v_cvt_pk_bf16_f32 v42, v100, v101
  v_cvt_pk_bf16_f32 v43, v102, v103
  v_mfma_f32_32x32x8_bf16 v[80:95], v[52:53], v[38:39], v[80:95]
  v_exp_f32 v104, v104
  v_exp_f32 v105, v105
  v_exp_f32 v106, v106
  v_exp_f32 v107, v107
  v_mfma_f32_32x32x16_bf16 v[128:143], v[68:71], v[40:43], v[128:143]
  v_cvt_pk_bf16_f32 v44, v104, v105
  v_cvt_pk_bf16_f32 v45, v106, v107
  v_exp_f32 v108, v108
  v_exp_f32 v109, v109
  v_exp_f32 v110, v110
  v_exp_f32 v111, v111
  v_cvt_pk_bf16_f32 v46, v108, v109
  v_cvt_pk_bf16_f32 v47, v110, v111
  v_exp_f32 v80, v80
  v_exp_f32 v81, v81
  v_mfma_f32_32x32x16_bf16 v[128:143], v[72:75], v[44:47], v[128:143]
  v_exp_f32 v82, v82
  ds_read_b128 v[48:51], v216 offset:0
  ds_read_b64 v[52:53], v217 offset:0
  v_exp_f32 v83, v83
  v_cvt_pk_bf16_f32 v40, v80, v81
  v_cvt_pk_bf16_f32 v41, v82, v83
  s_waitcnt lgkmcnt(2)
  v_mfma_f32_32x32x16_bf16 v[96:111], v[62:65], v[34:37], 0
  v_exp_f32 v84, v84
  v_exp_f32 v85, v85
  s_mov_b64 exec, s[78:79]
  ds_read_b128 v[68:71], v250 offset:5632
  ds_read_b128 v[72:75], v250 offset:6272
  s_mov_b64 exec, -1
  v_exp_f32 v86, v86
  v_exp_f32 v87, v87
  v_cvt_pk_bf16_f32 v42, v84, v85
  v_cvt_pk_bf16_f32 v43, v86, v87
  v_mfma_f32_32x32x8_bf16 v[96:111], v[66:67], v[38:39], v[96:111]
  v_exp_f32 v88, v88
  v_exp_f32 v89, v89
  v_exp_f32 v90, v90
  v_exp_f32 v91, v91
  v_mfma_f32_32x32x16_bf16 v[128:143], v[54:57], v[40:43], v[128:143]
  v_cvt_pk_bf16_f32 v44, v88, v89
  v_cvt_pk_bf16_f32 v45, v90, v91
  v_exp_f32 v92, v92
  v_exp_f32 v93, v93
  v_exp_f32 v94, v94
  v_exp_f32 v95, v95
  v_cvt_pk_bf16_f32 v46, v92, v93
  v_cvt_pk_bf16_f32 v47, v94, v95
  v_exp_f32 v96, v96
  v_exp_f32 v97, v97
  v_mfma_f32_32x32x16_bf16 v[128:143], v[58:61], v[44:47], v[128:143]
  v_exp_f32 v98, v98
  ds_read_b128 v[62:65], v248 offset:0
  ds_read_b64 v[66:67], v249 offset:0
  v_exp_f32 v99, v99
  v_cvt_pk_bf16_f32 v40, v96, v97
  v_cvt_pk_bf16_f32 v41, v98, v99
  s_waitcnt lgkmcnt(2)
  v_mfma_f32_32x32x16_bf16 v[80:95], v[48:51], v[34:37], 0
  v_exp_f32 v100, v100
  v_exp_f32 v101, v101
  s_mov_b64 exec, s[78:79]
  ds_read_b128 v[54:57], v218 offset:0
  ds_read_b128 v[58:61], v218 offset:640
  s_mov_b64 exec, -1
  v_exp_f32 v102, v102
  v_exp_f32 v103, v103
  v_cvt_pk_bf16_f32 v42, v100, v101
  v_cvt_pk_bf16_f32 v43, v102, v103
  v_mfma_f32_32x32x8_bf16 v[80:95], v[52:53], v[38:39], v[80:95]
  v_exp_f32 v104, v104
  v_exp_f32 v105, v105
  v_exp_f32 v106, v106
  v_exp_f32 v107, v107
  v_mfma_f32_32x32x16_bf16 v[128:143], v[68:71], v[40:43], v[128:143]
  v_cvt_pk_bf16_f32 v44, v104, v105
  v_cvt_pk_bf16_f32 v45, v106, v107
  v_exp_f32 v108, v108
  v_exp_f32 v109, v109
  v_exp_f32 v110, v110
  v_exp_f32 v111, v111
  v_cvt_pk_bf16_f32 v46, v108, v109
  v_cvt_pk_bf16_f32 v47, v110, v111
  v_exp_f32 v80, v80
  v_exp_f32 v81, v81
  v_mfma_f32_32x32x16_bf16 v[128:143], v[72:75], v[44:47], v[128:143]
  v_exp_f32 v82, v82
  v_exp_f32 v83, v83
  v_cvt_pk_bf16_f32 v40, v80, v81
  v_cvt_pk_bf16_f32 v41, v82, v83
  s_waitcnt lgkmcnt(0)
  v_mfma_f32_32x32x16_bf16 v[96:111], v[62:65], v[34:37], v[230:245]
  v_exp_f32 v84, v84
  v_exp_f32 v85, v85
  s_mov_b64 exec, s[78:79]
  ds_read_b128 v[68:71], v250 offset:0
  ds_read_b128 v[72:75], v250 offset:640
  s_mov_b64 exec, -1
  v_exp_f32 v86, v86
  v_exp_f32 v87, v87
  v_cvt_pk_bf16_f32 v42, v84, v85
  v_cvt_pk_bf16_f32 v43, v86, v87
  v_mfma_f32_32x32x8_bf16 v[96:111], v[66:67], v[38:39], v[96:111]
  v_exp_f32 v88, v88
  v_exp_f32 v89, v89
  v_exp_f32 v90, v90
  v_exp_f32 v91, v91
  v_mfma_f32_32x32x16_bf16 v[128:143], v[54:57], v[40:43], v[128:143]
  v_cvt_pk_bf16_f32 v44, v88, v89
  v_cvt_pk_bf16_f32 v45, v90, v91
  v_exp_f32 v92, v92
  v_exp_f32 v93, v93
  v_exp_f32 v94, v94
  v_exp_f32 v95, v95
  v_cvt_pk_bf16_f32 v46, v92, v93
  v_cvt_pk_bf16_f32 v47, v94, v95
  v_exp_f32 v96, v96
  v_exp_f32 v97, v97
  v_mfma_f32_32x32x16_bf16 v[128:143], v[58:61], v[44:47], v[128:143]
  s_mul_i32 s61, s44, 2560
  s_add_u32 m0, s61, 0
  s_add_u32 s61, s16, 6720
  s_add_u32 s62, s16, 13440
  s_mov_b32 exec_hi, 0x0fffffff
  buffer_load_dwordx4 v219, s[4:7], s16 offen lds
  buffer_load_dwordx4 v219, s[4:7], s61 offen offset:960 lds
  s_mov_b32 exec_hi, 0xff
  buffer_load_dwordx4 v219, s[4:7], s62 offen offset:1920 lds
  s_mov_b32 m0, 158208
  s_mov_b64 exec, 0x3ff
  buffer_load_dwordx4 v246, s[40:43], s17 offen lds
  s_mov_b64 exec, -1
  v_exp_f32 v98, v98
  v_exp_f32 v99, v99
  v_cvt_pk_bf16_f32 v40, v96, v97
  v_cvt_pk_bf16_f32 v41, v98, v99
  s_waitcnt lgkmcnt(0)
  v_exp_f32 v100, v100
  v_exp_f32 v101, v101
  v_exp_f32 v102, v102
  v_exp_f32 v103, v103
  v_cvt_pk_bf16_f32 v42, v100, v101
  v_cvt_pk_bf16_f32 v43, v102, v103
  v_exp_f32 v104, v104
  v_exp_f32 v105, v105
  v_exp_f32 v106, v106
  v_exp_f32 v107, v107
  v_mfma_f32_32x32x16_bf16 v[128:143], v[68:71], v[40:43], v[128:143]
  v_cvt_pk_bf16_f32 v44, v104, v105
  v_cvt_pk_bf16_f32 v45, v106, v107
  v_exp_f32 v108, v108
  v_exp_f32 v109, v109
  v_exp_f32 v110, v110
  v_exp_f32 v111, v111
  v_cvt_pk_bf16_f32 v46, v108, v109
  v_cvt_pk_bf16_f32 v47, v110, v111
  s_nop 1
  v_mfma_f32_32x32x16_bf16 v[128:143], v[72:75], v[44:47], v[128:143]
  s_branch L_afin
L_g2w00:
  v_mov_b32 v3, 159920
  s_mov_b32 s71, 1048576
Llw_85:
  ds_read_b32 v2, v3
  s_waitcnt lgkmcnt(0)
  v_cmp_gt_u32 vcc, 1, v2
  s_nop 0
  s_cbranch_vccz Llwok_86
  s_sub_u32 s71, s71, 1
  s_cbranch_scc1 Llwok_86
  s_branch Llw_85
Llwok_86:
  s_branch L_g2r00
L_g2w01:
  v_mov_b32 v3, 159924
  s_mov_b32 s71, 1048576
Llw_87:
  ds_read_b32 v2, v3
  s_waitcnt lgkmcnt(0)
  v_cmp_gt_u32 vcc, 1, v2
  s_nop 0
  s_cbranch_vccz Llwok_88
  s_sub_u32 s71, s71, 1
  s_cbranch_scc1 Llwok_88
  s_branch Llw_87
Llwok_88:
  s_branch L_g2r01
L_ex0:
  v_mfma_f32_32x32x16_bf16 v[128:143], v[72:75], v[44:47], v[128:143]
  s_mul_i32 s61, s44, 2560
  s_add_u32 m0, s61, 0
  s_add_u32 s61, s16, 6720
  s_add_u32 s62, s16, 13440
  s_mov_b32 exec_hi, 0x0fffffff
  buffer_load_dwordx4 v219, s[4:7], s16 offen lds
  buffer_load_dwordx4 v219, s[4:7], s61 offen offset:960 lds
  s_mov_b32 exec_hi, 0xff
  buffer_load_dwordx4 v219, s[4:7], s62 offen offset:1920 lds
  s_mov_b32 m0, 158208
  s_mov_b64 exec, 0x3ff
  buffer_load_dwordx4 v246, s[40:43], s17 offen lds
  s_mov_b64 exec, -1
  s_waitcnt lgkmcnt(0)
  s_branch L_afin
.p2alignl 12, 0xbf810000
L_av1:
  ds_read_b128 v[48:51], v248 offset:39424
  ds_read_b64 v[52:53], v249 offset:39424
  ds_read_b128 v[62:65], v216 offset:33792
  ds_read_b64 v[66:67], v217 offset:33792
  s_mov_b64 exec, s[78:79]
  ds_read_b128 v[54:57], v250 offset:39424
  ds_read_b128 v[58:61], v250 offset:40064
  s_mov_b64 exec, -1
  s_waitcnt lgkmcnt(0)
  v_mfma_f32_32x32x16_bf16 v[80:95], v[48:51], v[28:31], v[200:215]
  v_mfma_f32_32x32x8_bf16 v[80:95], v[52:53], v[32:33], v[80:95]
  s_nop 7
  s_nop 3
  v_exp_f32 v80, v80
  v_exp_f32 v81, v81
  v_exp_f32 v82, v82
  ds_read_b128 v[48:51], v248 offset:33792
  ds_read_b64 v[52:53], v249 offset:33792
  v_exp_f32 v83, v83
  v_cvt_pk_bf16_f32 v40, v80, v81
  v_cvt_pk_bf16_f32 v41, v82, v83
  v_mfma_f32_32x32x16_bf16 v[96:111], v[62:65], v[28:31], 0
  v_exp_f32 v84, v84
  v_exp_f32 v85, v85
  s_mov_b64 exec, s[78:79]
  ds_read_b128 v[68:71], v218 offset:33792
  ds_read_b128 v[72:75], v218 offset:34432
  s_mov_b64 exec, -1
  v_exp_f32 v86, v86
  v_exp_f32 v87, v87
  v_cvt_pk_bf16_f32 v42, v84, v85
  v_cvt_pk_bf16_f32 v43, v86, v87
  v_mfma_f32_32x32x8_bf16 v[96:111], v[66:67], v[32:33], v[96:111]
  v_exp_f32 v88, v88
  v_exp_f32 v89, v89
  v_exp_f32 v90, v90
  v_exp_f32 v91, v91
  v_mfma_f32_32x32x16_bf16 v[112:127], v[54:57], v[40:43], 0
  v_cvt_pk_bf16_f32 v44, v88, v89
  v_cvt_pk_bf16_f32 v45, v90, v91
  v_exp_f32 v92, v92
  v_exp_f32 v93, v93
  v_exp_f32 v94, v94
  v_exp_f32 v95, v95
  v_cvt_pk_bf16_f32 v46, v92, v93
  v_cvt_pk_bf16_f32 v47, v94, v95
  v_exp_f32 v96, v96
  v_exp_f32 v97, v97
  v_mfma_f32_32x32x16_bf16 v[112:127], v[58:61], v[44:47], v[112:127]
  v_exp_f32 v98, v98
  ds_read_b128 v[62:65], v216 offset:28160
  ds_read_b64 v[66:67], v217 offset:28160
  v_exp_f32 v99, v99
  v_cvt_pk_bf16_f32 v40, v96, v97
  v_cvt_pk_bf16_f32 v41, v98, v99
  s_waitcnt lgkmcnt(2)
  v_mfma_f32_32x32x16_bf16 v[80:95], v[48:51], v[28:31], 0
  v_exp_f32 v100, v100
  v_exp_f32 v101, v101
  s_mov_b64 exec, s[78:79]
  ds_read_b128 v[54:57], v250 offset:33792
  ds_read_b128 v[58:61], v250 offset:34432
  s_mov_b64 exec, -1
  v_exp_f32 v102, v102
  v_exp_f32 v103, v103
  v_cvt_pk_bf16_f32 v42, v100, v101
  v_cvt_pk_bf16_f32 v43, v102, v103
  v_mfma_f32_32x32x8_bf16 v[80:95], v[52:53], v[32:33], v[80:95]
  v_exp_f32 v104, v104
  v_exp_f32 v105, v105
  v_exp_f32 v106, v106
  v_exp_f32 v107, v107
  v_mfma_f32_32x32x16_bf16 v[112:127], v[68:71], v[40:43], v[112:127]
  v_cvt_pk_bf16_f32 v44, v104, v105
  v_cvt_pk_bf16_f32 v45, v106, v107
  v_exp_f32 v108, v108
  v_exp_f32 v109, v109
  v_exp_f32 v110, v110
  v_exp_f32 v111, v111
  v_cvt_pk_bf16_f32 v46, v108, v109
  v_cvt_pk_bf16_f32 v47, v110, v111
  v_exp_f32 v80, v80
  v_exp_f32 v81, v81
  v_mfma_f32_32x32x16_bf16 v[112:127], v[72:75], v[44:47], v[112:127]
  v_exp_f32 v82, v82
  ds_read_b128 v[48:51], v248 offset:28160
  ds_read_b64 v[52:53], v249 offset:28160
  v_exp_f32 v83, v83
  v_cvt_pk_bf16_f32 v40, v80, v81
  v_cvt_pk_bf16_f32 v41, v82, v83
  s_waitcnt lgkmcnt(2)
  v_mfma_f32_32x32x16_bf16 v[96:111], v[62:65], v[28:31], 0
  v_exp_f32 v84, v84
  v_exp_f32 v85, v85
  s_mov_b64 exec, s[78:79]
  ds_read_b128 v[68:71], v218 offset:28160
  ds_read_b128 v[72:75], v218 offset:28800
  s_mov_b64 exec, -1
  v_exp_f32 v86, v86
  v_exp_f32 v87, v87
  v_cvt_pk_bf16_f32 v42, v84, v85
  v_cvt_pk_bf16_f32 v43, v86, v87
  v_mfma_f32_32x32x8_bf16 v[96:111], v[66:67], v[32:33], v[96:111]
  v_exp_f32 v88, v88
  v_exp_f32 v89, v89
  v_exp_f32 v90, v90
  v_exp_f32 v91, v91
  v_mfma_f32_32x32x16_bf16 v[112:127], v[54:57], v[40:43], v[112:127]
  v_cvt_pk_bf16_f32 v44, v88, v89
  v_cvt_pk_bf16_f32 v45, v90, v91
  v_exp_f32 v92, v92
  v_exp_f32 v93, v93
  v_exp_f32 v94, v94
  v_exp_f32 v95, v95
  v_cvt_pk_bf16_f32 v46, v92, v93
  v_cvt_pk_bf16_f32 v47, v94, v95
  v_exp_f32 v96, v96
  v_exp_f32 v97, v97
  v_mfma_f32_32x32x16_bf16 v[112:127], v[58:61], v[44:47], v[112:127]
  v_exp_f32 v98, v98
  ds_read_b128 v[62:65], v216 offset:22528
  ds_read_b64 v[66:67], v217 offset:22528
  v_exp_f32 v99, v99
  v_cvt_pk_bf16_f32 v40, v96, v97
  v_cvt_pk_bf16_f32 v41, v98, v99
  s_waitcnt lgkmcnt(2)
  v_mfma_f32_32x32x16_bf16 v[80:95], v[48:51], v[28:31], 0
  v_exp_f32 v100, v100
  v_exp_f32 v101, v101
  s_mov_b64 exec, s[78:79]
  ds_read_b128 v[54:57], v250 offset:28160
  ds_read_b128 v[58:61], v250 offset:28800
  s_mov_b64 exec, -1
  v_exp_f32 v102, v102
  v_exp_f32 v103, v103
  v_cvt_pk_bf16_f32 v42, v100, v101
  v_cvt_pk_bf16_f32 v43, v102, v103
  v_mfma_f32_32x32x8_bf16 v[80:95], v[52:53], v[32:33], v[80:95]
  v_exp_f32 v104, v104
  v_exp_f32 v105, v105
  v_exp_f32 v106, v106
  v_exp_f32 v107, v107
  v_mfma_f32_32x32x16_bf16 v[112:127], v[68:71], v[40:43], v[112:127]
  v_cvt_pk_bf16_f32 v44, v104, v105
  v_cvt_pk_bf16_f32 v45, v106, v107
  v_exp_f32 v108, v108
  v_exp_f32 v109, v109
  v_exp_f32 v110, v110
  v_exp_f32 v111, v111
  v_cvt_pk_bf16_f32 v46, v108, v109
  v_cvt_pk_bf16_f32 v47, v110, v111
  v_exp_f32 v80, v80
  v_exp_f32 v81, v81
  v_mfma_f32_32x32x16_bf16 v[112:127], v[72:75], v[44:47], v[112:127]
  v_exp_f32 v82, v82
  v_exp_f32 v83, v83
  v_cvt_pk_bf16_f32 v40, v80, v81
  v_cvt_pk_bf16_f32 v41, v82, v83
  s_waitcnt lgkmcnt(0)
  v_mfma_f32_32x32x16_bf16 v[96:111], v[62:65], v[28:31], 0
  v_exp_f32 v84, v84
  v_exp_f32 v85, v85
  s_mov_b64 exec, s[78:79]
  ds_read_b128 v[68:71], v218 offset:22528
  ds_read_b128 v[72:75], v218 offset:23168
  s_mov_b64 exec, -1
  v_exp_f32 v86, v86
  v_exp_f32 v87, v87
  v_cvt_pk_bf16_f32 v42, v84, v85
  v_cvt_pk_bf16_f32 v43, v86, v87
  v_mfma_f32_32x32x8_bf16 v[96:111], v[66:67], v[32:33], v[96:111]
  v_exp_f32 v88, v88
  v_exp_f32 v89, v89
  v_exp_f32 v90, v90
  v_exp_f32 v91, v91
  v_mfma_f32_32x32x16_bf16 v[112:127], v[54:57], v[40:43], v[112:127]
  v_cvt_pk_bf16_f32 v44, v88, v89
  v_cvt_pk_bf16_f32 v45, v90, v91
  v_exp_f32 v92, v92
  v_exp_f32 v93, v93
  v_exp_f32 v94, v94
  v_exp_f32 v95, v95
  v_cvt_pk_bf16_f32 v46, v92, v93
  v_cvt_pk_bf16_f32 v47, v94, v95
  v_exp_f32 v96, v96
  v_exp_f32 v97, v97
  v_mfma_f32_32x32x16_bf16 v[112:127], v[58:61], v[44:47], v[112:127]
  v_exp_f32 v98, v98
  ds_read_b128 v[48:51], v248 offset:22528
  ds_read_b64 v[52:53], v249 offset:22528
  v_exp_f32 v99, v99
  v_cvt_pk_bf16_f32 v40, v96, v97
  v_cvt_pk_bf16_f32 v41, v98, v99
  s_waitcnt lgkmcnt(2)
  v_mfma_f32_32x32x16_bf16 v[80:95], v[62:65], v[34:37], v[200:215]
  v_exp_f32 v100, v100
  v_exp_f32 v101, v101
  v_exp_f32 v102, v102
  v_exp_f32 v103, v103
  v_cvt_pk_bf16_f32 v42, v100, v101
  v_cvt_pk_bf16_f32 v43, v102, v103
  v_mfma_f32_32x32x8_bf16 v[80:95], v[66:67], v[38:39], v[80:95]
  v_exp_f32 v104, v104
  v_exp_f32 v105, v105
  v_exp_f32 v106, v106
  v_exp_f32 v107, v107
  v_mfma_f32_32x32x16_bf16 v[112:127], v[68:71], v[40:43], v[112:127]
  v_cvt_pk_bf16_f32 v44, v104, v105
  v_cvt_pk_bf16_f32 v45, v106, v107
  v_exp_f32 v108, v108
  v_exp_f32 v109, v109
  v_exp_f32 v110, v110
  v_exp_f32 v111, v111
  v_cvt_pk_bf16_f32 v46, v108, v109
  v_cvt_pk_bf16_f32 v47, v110, v111
  v_exp_f32 v80, v80
  v_exp_f32 v81, v81
  v_mfma_f32_32x32x16_bf16 v[112:127], v[72:75], v[44:47], v[112:127]
  v_exp_f32 v82, v82
  ds_read_b32 v2, v251 offset:112
  v_exp_f32 v83, v83
  v_cvt_pk_bf16_f32 v40, v80, v81
  v_cvt_pk_bf16_f32 v41, v82, v83
  s_waitcnt lgkmcnt(1)
  v_mfma_f32_32x32x16_bf16 v[96:111], v[48:51], v[28:31], 0
  v_exp_f32 v84, v84
  v_exp_f32 v85, v85
  s_mov_b64 exec, s[78:79]
  ds_read_b128 v[54:57], v250 offset:22528
  ds_read_b128 v[58:61], v250 offset:23168
  s_mov_b64 exec, -1
  v_exp_f32 v86, v86
  v_exp_f32 v87, v87
  v_cvt_pk_bf16_f32 v42, v84, v85
  v_cvt_pk_bf16_f32 v43, v86, v87
  v_mfma_f32_32x32x8_bf16 v[96:111], v[52:53], v[32:33], v[96:111]
  v_exp_f32 v88, v88
  v_exp_f32 v89, v89
  v_exp_f32 v90, v90
  v_exp_f32 v91, v91
  v_mfma_f32_32x32x16_bf16 v[128:143], v[68:71], v[40:43], 0
  v_cvt_pk_bf16_f32 v44, v88, v89
  v_cvt_pk_bf16_f32 v45, v90, v91
  v_exp_f32 v92, v92
  v_exp_f32 v93, v93
  v_exp_f32 v94, v94
  v_exp_f32 v95, v95
  v_cvt_pk_bf16_f32 v46, v92, v93
  v_cvt_pk_bf16_f32 v47, v94, v95
  v_exp_f32 v96, v96
  v_exp_f32 v97, v97
  v_mfma_f32_32x32x16_bf16 v[128:143], v[72:75], v[44:47], v[128:143]
  v_exp_f32 v98, v98
  v_exp_f32 v99, v99
  v_cvt_pk_bf16_f32 v40, v96, v97
  v_cvt_pk_bf16_f32 v41, v98, v99
  s_waitcnt lgkmcnt(0)
  v_mfma_f32_32x32x16_bf16 v[80:95], v[48:51], v[34:37], 0
  v_exp_f32 v100, v100
  v_cmp_gt_u32 vcc, 1, v2
  v_exp_f32 v101, v101
  s_cbranch_vccnz L_g2w10
L_g2r10:
  ds_read_b128 v[62:65], v216 offset:16896
  ds_read_b64 v[66:67], v217 offset:16896
  v_exp_f32 v102, v102
  v_exp_f32 v103, v103
  v_cvt_pk_bf16_f32 v42, v100, v101
  v_cvt_pk_bf16_f32 v43, v102, v103
  v_mfma_f32_32x32x8_bf16 v[80:95], v[52:53], v[38:39], v[80:95]
  v_exp_f32 v104, v104
  v_exp_f32 v105, v105
  v_exp_f32 v106, v106
  v_exp_f32 v107, v107
  v_mfma_f32_32x32x16_bf16 v[112:127], v[54:57], v[40:43], v[112:127]
  v_cvt_pk_bf16_f32 v44, v104, v105
  v_cvt_pk_bf16_f32 v45, v106, v107
  v_exp_f32 v108, v108
  v_exp_f32 v109, v109
  v_exp_f32 v110, v110
  v_exp_f32 v111, v111
  v_cvt_pk_bf16_f32 v46, v108, v109
  v_cvt_pk_bf16_f32 v47, v110, v111
  v_exp_f32 v80, v80
  v_exp_f32 v81, v81
  v_mfma_f32_32x32x16_bf16 v[112:127], v[58:61], v[44:47], v[112:127]
  v_exp_f32 v82, v82
  v_exp_f32 v83, v83
  v_cvt_pk_bf16_f32 v40, v80, v81
  v_cvt_pk_bf16_f32 v41, v82, v83
  s_waitcnt lgkmcnt(0)
  v_mfma_f32_32x32x16_bf16 v[96:111], v[62:65], v[28:31], 0
  v_exp_f32 v84, v84
  v_exp_f32 v85, v85
  s_mov_b64 exec, s[78:79]
  ds_read_b128 v[68:71], v218 offset:16896
  ds_read_b128 v[72:75], v218 offset:17536
  s_mov_b64 exec, -1
  v_exp_f32 v86, v86
  v_exp_f32 v87, v87
  v_cvt_pk_bf16_f32 v42, v84, v85
  v_cvt_pk_bf16_f32 v43, v86, v87
  v_mfma_f32_32x32x8_bf16 v[96:111], v[66:67], v[32:33], v[96:111]
  v_exp_f32 v88, v88
  v_exp_f32 v89, v89
  v_exp_f32 v90, v90
  v_exp_f32 v91, v91
  v_mfma_f32_32x32x16_bf16 v[128:143], v[54:57], v[40:43], v[128:143]
  v_cvt_pk_bf16_f32 v44, v88, v89
  v_cvt_pk_bf16_f32 v45, v90, v91
  v_exp_f32 v92, v92
  v_exp_f32 v93, v93
  v_exp_f32 v94, v94
  v_exp_f32 v95, v95
  v_cvt_pk_bf16_f32 v46, v92, v93
  v_cvt_pk_bf16_f32 v47, v94, v95
  s_cmp_eq_u32 s23, 0
  s_cbranch_scc1 L_ex1
  v_exp_f32 v96, v96
  v_exp_f32 v97, v97
  v_mfma_f32_32x32x16_bf16 v[128:143], v[58:61], v[44:47], v[128:143]
  v_exp_f32 v98, v98
  ds_read_b128 v[48:51], v248 offset:16896
  ds_read_b64 v[52:53], v249 offset:16896
  v_exp_f32 v99, v99
  v_cvt_pk_bf16_f32 v40, v96, v97
  v_cvt_pk_bf16_f32 v41, v98, v99
  s_waitcnt lgkmcnt(2)
  v_mfma_f32_32x32x16_bf16 v[80:95], v[62:65], v[34:37], 0
  v_exp_f32 v100, v100
  v_exp_f32 v101, v101
  v_exp_f32 v102, v102
  v_exp_f32 v103, v103
  v_cvt_pk_bf16_f32 v42, v100, v101
  v_cvt_pk_bf16_f32 v43, v102, v103
  v_mfma_f32_32x32x8_bf16 v[80:95], v[66:67], v[38:39], v[80:95]
  v_exp_f32 v104, v104
  v_exp_f32 v105, v105
  v_exp_f32 v106, v106
  v_exp_f32 v107, v107
  v_mfma_f32_32x32x16_bf16 v[112:127], v[68:71], v[40:43], v[112:127]
  v_cvt_pk_bf16_f32 v44, v104, v105
  v_cvt_pk_bf16_f32 v45, v106, v107
  v_exp_f32 v108, v108
  v_exp_f32 v109, v109
  v_exp_f32 v110, v110
  v_exp_f32 v111, v111
  v_cvt_pk_bf16_f32 v46, v108, v109
  v_cvt_pk_bf16_f32 v47, v110, v111
  v_exp_f32 v80, v80
  v_exp_f32 v81, v81
  v_mfma_f32_32x32x16_bf16 v[112:127], v[72:75], v[44:47], v[112:127]
  v_exp_f32 v82, v82
  v_exp_f32 v83, v83
  v_cvt_pk_bf16_f32 v40, v80, v81
  v_cvt_pk_bf16_f32 v41, v82, v83
  s_waitcnt lgkmcnt(0)
  v_mfma_f32_32x32x16_bf16 v[96:111], v[48:51], v[28:31], v[230:245]
  v_exp_f32 v84, v84
  v_exp_f32 v85, v85
  s_mov_b64 exec, s[78:79]
  ds_read_b128 v[54:57], v250 offset:16896
  ds_read_b128 v[58:61], v250 offset:17536
  s_mov_b64 exec, -1
  v_exp_f32 v86, v86
  v_exp_f32 v87, v87
  v_cvt_pk_bf16_f32 v42, v84, v85
  v_cvt_pk_bf16_f32 v43, v86, v87
  v_mfma_f32_32x32x8_bf16 v[96:111], v[52:53], v[32:33], v[96:111]
  v_exp_f32 v88, v88
  v_exp_f32 v89, v89
  v_exp_f32 v90, v90
  v_exp_f32 v91, v91
  v_mfma_f32_32x32x16_bf16 v[128:143], v[68:71], v[40:43], v[128:143]
  v_cvt_pk_bf16_f32 v44, v88, v89
  v_cvt_pk_bf16_f32 v45, v90, v91
  v_exp_f32 v92, v92
  v_exp_f32 v93, v93
  v_exp_f32 v94, v94
  v_exp_f32 v95, v95
  v_cvt_pk_bf16_f32 v46, v92, v93
  v_cvt_pk_bf16_f32 v47, v94, v95
  v_exp_f32 v96, v96
  v_exp_f32 v97, v97
  v_mfma_f32_32x32x16_bf16 v[128:143], v[72:75], v[44:47], v[128:143]
  v_exp_f32 v98, v98
  ds_read_b128 v[62:65], v216 offset:11264
  ds_read_b64 v[66:67], v217 offset:11264
  v_exp_f32 v99, v99
  v_cvt_pk_bf16_f32 v40, v96, v97
  v_cvt_pk_bf16_f32 v41, v98, v99
  s_waitcnt lgkmcnt(2)
  v_mfma_f32_32x32x16_bf16 v[80:95], v[48:51], v[34:37], 0
  v_exp_f32 v100, v100
  v_exp_f32 v101, v101
  v_exp_f32 v102, v102
  v_exp_f32 v103, v103
  v_cvt_pk_bf16_f32 v42, v100, v101
  v_cvt_pk_bf16_f32 v43, v102, v103
  v_mfma_f32_32x32x8_bf16 v[80:95], v[52:53], v[38:39], v[80:95]
  v_exp_f32 v104, v104
  v_exp_f32 v105, v105
  v_exp_f32 v106, v106
  v_exp_f32 v107, v107
  v_mfma_f32_32x32x16_bf16 v[112:127], v[54:57], v[40:43], v[112:127]
  v_cvt_pk_bf16_f32 v44, v104, v105
  v_cvt_pk_bf16_f32 v45, v106, v107
  v_exp_f32 v108, v108
  v_exp_f32 v109, v109
  v_exp_f32 v110, v110
  v_exp_f32 v111, v111
  v_cvt_pk_bf16_f32 v46, v108, v109
  v_cvt_pk_bf16_f32 v47, v110, v111
  v_exp_f32 v80, v80
  v_exp_f32 v81, v81
  v_mfma_f32_32x32x16_bf16 v[112:127], v[58:61], v[44:47], v[112:127]
  v_exp_f32 v82, v82
  ds_read_b128 v[48:51], v248 offset:11264
  ds_read_b64 v[52:53], v249 offset:11264
  ds_read_b32 v2, v251 offset:116
  v_exp_f32 v83, v83
  v_cvt_pk_bf16_f32 v40, v80, v81
  v_cvt_pk_bf16_f32 v41, v82, v83
  s_waitcnt lgkmcnt(3)
  v_mfma_f32_32x32x16_bf16 v[96:111], v[62:65], v[34:37], 0
  v_exp_f32 v84, v84
  v_exp_f32 v85, v85
  s_mov_b64 exec, s[78:79]
  ds_read_b128 v[68:71], v218 offset:11264
  ds_read_b128 v[72:75], v218 offset:11904
  s_mov_b64 exec, -1
  v_exp_f32 v86, v86
  v_exp_f32 v87, v87
  v_cvt_pk_bf16_f32 v42, v84, v85
  v_cvt_pk_bf16_f32 v43, v86, v87
  v_mfma_f32_32x32x8_bf16 v[96:111], v[66:67], v[38:39], v[96:111]
  v_exp_f32 v88, v88
  v_exp_f32 v89, v89
  v_exp_f32 v90, v90
  v_exp_f32 v91, v91
  v_mfma_f32_32x32x16_bf16 v[128:143], v[54:57], v[40:43], v[128:143]
  v_cvt_pk_bf16_f32 v44, v88, v89
  v_cvt_pk_bf16_f32 v45, v90, v91
  v_exp_f32 v92, v92
  v_exp_f32 v93, v93
  v_exp_f32 v94, v94
  v_exp_f32 v95, v95
  v_cvt_pk_bf16_f32 v46, v92, v93
  v_cvt_pk_bf16_f32 v47, v94, v95
  v_exp_f32 v96, v96
  v_exp_f32 v97, v97
  v_mfma_f32_32x32x16_bf16 v[128:143], v[58:61], v[44:47], v[128:143]
  v_exp_f32 v98, v98
  v_exp_f32 v99, v99
  v_cvt_pk_bf16_f32 v40, v96, v97
  v_cvt_pk_bf16_f32 v41, v98, v99
  s_waitcnt lgkmcnt(0)
  v_mfma_f32_32x32x16_bf16 v[80:95], v[48:51], v[34:37], 0
  v_exp_f32 v100, v100
  v_cmp_gt_u32 vcc, 1, v2
  v_exp_f32 v101, v101
  s_cbranch_vccnz L_g2w11
L_g2r11:
  ds_read_b128 v[62:65], v216 offset:5632
  ds_read_b64 v[66:67], v217 offset:5632
  s_mov_b64 exec, s[78:79]
  ds_read_b128 v[54:57], v250 offset:11264
  ds_read_b128 v[58:61], v250 offset:11904
  s_mov_b64 exec, -1
  v_exp_f32 v102, v102
  v_exp_f32 v103, v103
  v_cvt_pk_bf16_f32 v42, v100, v101
  v_cvt_pk_bf16_f32 v43, v102, v103
  v_mfma_f32_32x32x8_bf16 v[80:95], v[52:53], v[38:39], v[80:95]
  v_exp_f32 v104, v104
  v_exp_f32 v105, v105
  v_exp_f32 v106, v106
  v_exp_f32 v107, v107
  v_mfma_f32_32x32x16_bf16 v[128:143], v[68:71], v[40:43], v[128:143]
  v_cvt_pk_bf16_f32 v44, v104, v105
  v_cvt_pk_bf16_f32 v45, v106, v107
  v_exp_f32 v108, v108
  v_exp_f32 v109, v109
  v_exp_f32 v110, v110
  v_exp_f32 v111, v111
  v_cvt_pk_bf16_f32 v46, v108, v109
  v_cvt_pk_bf16_f32 v47, v110, v111
  v_exp_f32 v80, v80
  v_exp_f32 v81, v81
  v_mfma_f32_32x32x16_bf16 v[128:143], v[72:75], v[44:47], v[128:143]
  v_exp_f32 v82, v82
  ds_read_b128 v[48:51], v248 offset:5632
  ds_read_b64 v[52:53], v249 offset:5632
  v_exp_f32 v83, v83
  v_cvt_pk_bf16_f32 v40, v80, v81
  v_cvt_pk_bf16_f32 v41, v82, v83
  s_waitcnt lgkmcnt(2)
  v_mfma_f32_32x32x16_bf16 v[96:111], v[62:65], v[34:37], 0
  v_exp_f32 v84, v84
  v_exp_f32 v85, v85
  s_mov_b64 exec, s[78:79]
  ds_read_b128 v[68:71], v218 offset:5632
  ds_read_b128 v[72:75], v218 offset:6272
  s_mov_b64 exec, -1
  v_exp_f32 v86, v86
  v_exp_f32 v87, v87
  v_cvt_pk_bf16_f32 v42, v84, v85
  v_cvt_pk_bf16_f32 v43, v86, v87
  v_mfma_f32_32x32x8_bf16 v[96:111], v[66:67], v[38:39], v[96:111]
  v_exp_f32 v88, v88
  v_exp_f32 v89, v89
  v_exp_f32 v90, v90
  v_exp_f32 v91, v91
  v_mfma_f32_32x32x16_bf16 v[128:143], v[54:57], v[40:43], v[128:143]
  v_cvt_pk_bf16_f32 v44, v88, v89
  v_cvt_pk_bf16_f32 v45, v90, v91
  v_exp_f32 v92, v92
  v_exp_f32 v93, v93
  v_exp_f32 v94, v94
  v_exp_f32 v95, v95
  v_cvt_pk_bf16_f32 v46, v92, v93
  v_cvt_pk_bf16_f32 v47, v94, v95
  v_exp_f32 v96, v96
  v_exp_f32 v97, v97
  v_mfma_f32_32x32x16_bf16 v[128:143], v[58:61], v[44:47], v[128:143]
  v_exp_f32 v98, v98
  ds_read_b128 v[62:65], v216 offset:0
  ds_read_b64 v[66:67], v217 offset:0
  v_exp_f32 v99, v99
  v_cvt_pk_bf16_f32 v40, v96, v97
  v_cvt_pk_bf16_f32 v41, v98, v99
  s_waitcnt lgkmcnt(2)
  v_mfma_f32_32x32x16_bf16 v[80:95], v[48:51], v[34:37], 0
  v_exp_f32 v100, v100
  v_exp_f32 v101, v101
  s_mov_b64 exec, s[78:79]
  ds_read_b128 v[54:57], v250 offset:5632
  ds_read_b128 v[58:61], v250 offset:6272
  s_mov_b64 exec, -1
  v_exp_f32 v102, v102
  v_exp_f32 v103, v103
  v_cvt_pk_bf16_f32 v42, v100, v101
  v_cvt_pk_bf16_f32 v43, v102, v103
  v_mfma_f32_32x32x8_bf16 v[80:95], v[52:53], v[38:39], v[80:95]
  v_exp_f32 v104, v104
  v_exp_f32 v105, v105
  v_exp_f32 v106, v106
  v_exp_f32 v107, v107
  v_mfma_f32_32x32x16_bf16 v[128:143], v[68:71], v[40:43], v[128:143]
  v_cvt_pk_bf16_f32 v44, v104, v105
  v_cvt_pk_bf16_f32 v45, v106, v107
  v_exp_f32 v108, v108
  v_exp_f32 v109, v109
  v_exp_f32 v110, v110
  v_exp_f32 v111, v111
  v_cvt_pk_bf16_f32 v46, v108, v109
  v_cvt_pk_bf16_f32 v47, v110, v111
  v_exp_f32 v80, v80
  v_exp_f32 v81, v81
  v_mfma_f32_32x32x16_bf16 v[128:143], v[72:75], v[44:47], v[128:143]
  v_exp_f32 v82, v82
  v_exp_f32 v83, v83
  v_cvt_pk_bf16_f32 v40, v80, v81
  v_cvt_pk_bf16_f32 v41, v82, v83
  s_waitcnt lgkmcnt(0)
  v_mfma_f32_32x32x16_bf16 v[96:111], v[62:65], v[34:37], v[230:245]
  v_exp_f32 v84, v84
  v_exp_f32 v85, v85
  s_mov_b64 exec, s[78:79]
  ds_read_b128 v[68:71], v218 offset:0
  ds_read_b128 v[72:75], v218 offset:640
  s_mov_b64 exec, -1
  v_exp_f32 v86, v86
  v_exp_f32 v87, v87
  v_cvt_pk_bf16_f32 v42, v84, v85
  v_cvt_pk_bf16_f32 v43, v86, v87
  v_mfma_f32_32x32x8_bf16 v[96:111], v[66:67], v[38:39], v[96:111]
  v_exp_f32 v88, v88
  v_exp_f32 v89, v89
  v_exp_f32 v90, v90
  v_exp_f32 v91, v91
  v_mfma_f32_32x32x16_bf16 v[128:143], v[54:57], v[40:43], v[128:143]
  v_cvt_pk_bf16_f32 v44, v88, v89
  v_cvt_pk_bf16_f32 v45, v90, v91
  v_exp_f32 v92, v92
  v_exp_f32 v93, v93
  v_exp_f32 v94, v94
  v_exp_f32 v95, v95
  v_cvt_pk_bf16_f32 v46, v92, v93
  v_cvt_pk_bf16_f32 v47, v94, v95
  v_exp_f32 v96, v96
  v_exp_f32 v97, v97
  v_mfma_f32_32x32x16_bf16 v[128:143], v[58:61], v[44:47], v[128:143]
  s_mul_i32 s61, s44, 2560
  s_add_u32 m0, s61, 0
  s_add_u32 s61, s16, 6720
  s_add_u32 s62, s16, 13440
  s_mov_b32 exec_hi, 0x0fffffff
  buffer_load_dwordx4 v219, s[4:7], s16 offen lds
  buffer_load_dwordx4 v219, s[4:7], s61 offen offset:960 lds
  s_mov_b32 exec_hi, 0xff
  buffer_load_dwordx4 v219, s[4:7], s62 offen offset:1920 lds
  s_mov_b32 m0, 158208
  s_mov_b64 exec, 0x3ff
  buffer_load_dwordx4 v246, s[40:43], s17 offen lds
  s_mov_b64 exec, -1
  v_exp_f32 v98, v98
  v_exp_f32 v99, v99
  v_cvt_pk_bf16_f32 v40, v96, v97
  v_cvt_pk_bf16_f32 v41, v98, v99
  s_waitcnt lgkmcnt(0)
  v_exp_f32 v100, v100
  v_exp_f32 v101, v101
  v_exp_f32 v102, v102
  v_exp_f32 v103, v103
  v_cvt_pk_bf16_f32 v42, v100, v101
  v_cvt_pk_bf16_f32 v43, v102, v103
  v_exp_f32 v104, v104
  v_exp_f32 v105, v105
  v_exp_f32 v106, v106
  v_exp_f32 v107, v107
  v_mfma_f32_32x32x16_bf16 v[128:143], v[68:71], v[40:43], v[128:143]
  v_cvt_pk_bf16_f32 v44, v104, v105
  v_cvt_pk_bf16_f32 v45, v106, v107
  v_exp_f32 v108, v108
  v_exp_f32 v109, v109
  v_exp_f32 v110, v110
  v_exp_f32 v111, v111
  v_cvt_pk_bf16_f32 v46, v108, v109
  v_cvt_pk_bf16_f32 v47, v110, v111
  s_nop 1
  v_mfma_f32_32x32x16_bf16 v[128:143], v[72:75], v[44:47], v[128:143]
  s_branch L_afin
L_g2w10:
  v_mov_b32 v3, 159920
  s_mov_b32 s71, 1048576
Llw_89:
  ds_read_b32 v2, v3
  s_waitcnt lgkmcnt(0)
  v_cmp_gt_u32 vcc, 1, v2
  s_nop 0
  s_cbranch_vccz Llwok_90
  s_sub_u32 s71, s71, 1
  s_cbranch_scc1 Llwok_90
  s_branch Llw_89
Llwok_90:
  s_branch L_g2r10
L_g2w11:
  v_mov_b32 v3, 159924
  s_mov_b32 s71, 1048576
Llw_91:
  ds_read_b32 v2, v3
  s_waitcnt lgkmcnt(0)
  v_cmp_gt_u32 vcc, 1, v2
  s_nop 0
  s_cbranch_vccz Llwok_92
  s_sub_u32 s71, s71, 1
  s_cbranch_scc1 Llwok_92
  s_branch Llw_91
Llwok_92:
  s_branch L_g2r11
L_ex1:
  v_mfma_f32_32x32x16_bf16 v[128:143], v[58:61], v[44:47], v[128:143]
  s_mul_i32 s61, s44, 2560
  s_add_u32 m0, s61, 0
  s_add_u32 s61, s16, 6720
  s_add_u32 s62, s16, 13440
  s_mov_b32 exec_hi, 0x0fffffff
  buffer_load_dwordx4 v219, s[4:7], s16 offen lds
  buffer_load_dwordx4 v219, s[4:7], s61 offen offset:960 lds
  s_mov_b32 exec_hi, 0xff
  buffer_load_dwordx4 v219, s[4:7], s62 offen offset:1920 lds
  s_mov_b32 m0, 158208
  s_mov_b64 exec, 0x3ff
  buffer_load_dwordx4 v246, s[40:43], s17 offen lds
  s_mov_b64 exec, -1
  s_waitcnt lgkmcnt(0)
  s_branch L_afin
L_wo2w:
  s_mov_b32 s71, 1048576
Llw_109:
  ds_read_b32 v8, v9
  s_waitcnt lgkmcnt(0)
  v_cmp_gt_u32 vcc, 2, v8
  s_nop 0
  s_cbranch_vccz Llwok_110
  s_sub_u32 s71, s71, 1
  s_cbranch_scc1 Llwok_110
  s_branch Llw_109
Llwok_110:
  s_branch L_wo2r
L_ldw:
  v_add_u32 v9, 16, v9
  s_mov_b32 s71, 1048576
Llw_111:
  ds_read_b32 v8, v9
  s_waitcnt lgkmcnt(0)
  v_cmp_gt_u32 vcc, 4, v8
  s_nop 0
  s_cbranch_vccz Llwok_112
  s_sub_u32 s71, s71, 1
  s_cbranch_scc1 Llwok_112
  s_branch Llw_111
Llwok_112:
  s_branch L_ldr
L_hlw:
  s_sub_u32 s71, s71, 1
  s_cbranch_scc1 L_hlr
  buffer_load_dwordx2 v[20:21], v4, s[32:35], s56 offen sc1
  buffer_load_dwordx2 v[22:23], v4, s[32:35], s56 offen offset:1280 sc1
  s_waitcnt vmcnt(0)
  v_max_u32 v7, v20, v22
  v_cmp_eq_u32 vcc, -1, v7
  s_nop 0
  s_cbranch_vccnz L_hlw
  s_branch L_hlr
.p2alignl 12, 0xbf810000
L_av2:
  ds_read_b128 v[48:51], v216 offset:33792
  ds_read_b64 v[52:53], v217 offset:33792
  ds_read_b128 v[62:65], v248 offset:33792
  ds_read_b64 v[66:67], v249 offset:33792
  s_mov_b64 exec, s[78:79]
  ds_read_b128 v[54:57], v218 offset:33792
  ds_read_b128 v[58:61], v218 offset:34432
  s_mov_b64 exec, -1
  s_waitcnt lgkmcnt(0)
  v_mfma_f32_32x32x16_bf16 v[80:95], v[48:51], v[28:31], v[200:215]
  v_mfma_f32_32x32x8_bf16 v[80:95], v[52:53], v[32:33], v[80:95]
  s_nop 7
  s_nop 3
  v_exp_f32 v80, v80
  v_exp_f32 v81, v81
  v_exp_f32 v82, v82
  ds_read_b128 v[48:51], v216 offset:28160
  ds_read_b64 v[52:53], v217 offset:28160
  v_exp_f32 v83, v83
  v_cvt_pk_bf16_f32 v40, v80, v81
  v_cvt_pk_bf16_f32 v41, v82, v83
  v_mfma_f32_32x32x16_bf16 v[96:111], v[62:65], v[28:31], 0
  v_exp_f32 v84, v84
  v_exp_f32 v85, v85
  s_mov_b64 exec, s[78:79]
  ds_read_b128 v[68:71], v250 offset:33792
  ds_read_b128 v[72:75], v250 offset:34432
  s_mov_b64 exec, -1
  v_exp_f32 v86, v86
  v_exp_f32 v87, v87
  v_cvt_pk_bf16_f32 v42, v84, v85
  v_cvt_pk_bf16_f32 v43, v86, v87
  v_mfma_f32_32x32x8_bf16 v[96:111], v[66:67], v[32:33], v[96:111]
  v_exp_f32 v88, v88
  v_exp_f32 v89, v89
  v_exp_f32 v90, v90
  v_exp_f32 v91, v91
  v_mfma_f32_32x32x16_bf16 v[112:127], v[54:57], v[40:43], 0
  v_cvt_pk_bf16_f32 v44, v88, v89
  v_cvt_pk_bf16_f32 v45, v90, v91
  v_exp_f32 v92, v92
  v_exp_f32 v93, v93
  v_exp_f32 v94, v94
  v_exp_f32 v95, v95
  v_cvt_pk_bf16_f32 v46, v92, v93
  v_cvt_pk_bf16_f32 v47, v94, v95
  v_exp_f32 v96, v96
  v_exp_f32 v97, v97
  v_mfma_f32_32x32x16_bf16 v[112:127], v[58:61], v[44:47], v[112:127]
  v_exp_f32 v98, v98
  ds_read_b128 v[62:65], v248 offset:28160
  ds_read_b64 v[66:67], v249 offset:28160
  v_exp_f32 v99, v99
  v_cvt_pk_bf16_f32 v40, v96, v97
  v_cvt_pk_bf16_f32 v41, v98, v99
  s_waitcnt lgkmcnt(2)
  v_mfma_f32_32x32x16_bf16 v[80:95], v[48:51], v[28:31], 0
  v_exp_f32 v100, v100
  v_exp_f32 v101, v101
  s_mov_b64 exec, s[78:79]
  ds_read_b128 v[54:57], v218 offset:28160
  ds_read_b128 v[58:61], v218 offset:28800
  s_mov_b64 exec, -1
  v_exp_f32 v102, v102
  v_exp_f32 v103, v103
  v_cvt_pk_bf16_f32 v42, v100, v101
  v_cvt_pk_bf16_f32 v43, v102, v103
  v_mfma_f32_32x32x8_bf16 v[80:95], v[52:53], v[32:33], v[80:95]
  v_exp_f32 v104, v104
  v_exp_f32 v105, v105
  v_exp_f32 v106, v106
  v_exp_f32 v107, v107
  v_mfma_f32_32x32x16_bf16 v[112:127], v[68:71], v[40:43], v[112:127]
  v_cvt_pk_bf16_f32 v44, v104, v105
  v_cvt_pk_bf16_f32 v45, v106, v107
  v_exp_f32 v108, v108
  v_exp_f32 v109, v109
  v_exp_f32 v110, v110
  v_exp_f32 v111, v111
  v_cvt_pk_bf16_f32 v46, v108, v109
  v_cvt_pk_bf16_f32 v47, v110, v111
  v_exp_f32 v80, v80
  v_exp_f32 v81, v81
  v_mfma_f32_32x32x16_bf16 v[112:127], v[72:75], v[44:47], v[112:127]
  v_exp_f32 v82, v82
  v_exp_f32 v83, v83
  v_cvt_pk_bf16_f32 v40, v80, v81
  v_cvt_pk_bf16_f32 v41, v82, v83
  s_waitcnt lgkmcnt(0)
  v_mfma_f32_32x32x16_bf16 v[96:111], v[62:65], v[28:31], 0
  v_exp_f32 v84, v84
  v_exp_f32 v85, v85
  s_mov_b64 exec, s[78:79]
  ds_read_b128 v[68:71], v250 offset:28160
  ds_read_b128 v[72:75], v250 offset:28800
  s_mov_b64 exec, -1
  v_exp_f32 v86, v86
  v_exp_f32 v87, v87
  v_cvt_pk_bf16_f32 v42, v84, v85
  v_cvt_pk_bf16_f32 v43, v86, v87
  v_mfma_f32_32x32x8_bf16 v[96:111], v[66:67], v[32:33], v[96:111]
  v_exp_f32 v88, v88
  v_exp_f32 v89, v89
  v_exp_f32 v90, v90
  v_exp_f32 v91, v91
  v_mfma_f32_32x32x16_bf16 v[112:127], v[54:57], v[40:43], v[112:127]
  v_cvt_pk_bf16_f32 v44, v88, v89
  v_cvt_pk_bf16_f32 v45, v90, v91
  v_exp_f32 v92, v92
  v_exp_f32 v93, v93
  v_exp_f32 v94, v94
  v_exp_f32 v95, v95
  v_cvt_pk_bf16_f32 v46, v92, v93
  v_cvt_pk_bf16_f32 v47, v94, v95
  v_exp_f32 v96, v96
  v_exp_f32 v97, v97
  v_mfma_f32_32x32x16_bf16 v[112:127], v[58:61], v[44:47], v[112:127]
  v_exp_f32 v98, v98
  ds_read_b128 v[48:51], v216 offset:22528
  ds_read_b64 v[52:53], v217 offset:22528
  v_exp_f32 v99, v99
  v_cvt_pk_bf16_f32 v40, v96, v97
  v_cvt_pk_bf16_f32 v41, v98, v99
  s_waitcnt lgkmcnt(2)
  v_mfma_f32_32x32x16_bf16 v[80:95], v[62:65], v[34:37], v[200:215]
  v_exp_f32 v100, v100
  v_exp_f32 v101, v101
  v_exp_f32 v102, v102
  v_exp_f32 v103, v103
  v_cvt_pk_bf16_f32 v42, v100, v101
  v_cvt_pk_bf16_f32 v43, v102, v103
  v_mfma_f32_32x32x8_bf16 v[80:95], v[66:67], v[38:39], v[80:95]
  v_exp_f32 v104, v104
  v_exp_f32 v105, v105
  v_exp_f32 v106, v106
  v_exp_f32 v107, v107
  v_mfma_f32_32x32x16_bf16 v[112:127], v[68:71], v[40:43], v[112:127]
  v_cvt_pk_bf16_f32 v44, v104, v105
  v_cvt_pk_bf16_f32 v45, v106, v107
  v_exp_f32 v108, v108
  v_exp_f32 v109, v109
  v_exp_f32 v110, v110
  v_exp_f32 v111, v111
  v_cvt_pk_bf16_f32 v46, v108, v109
  v_cvt_pk_bf16_f32 v47, v110, v111
  v_exp_f32 v80, v80
  v_exp_f32 v81, v81
  v_mfma_f32_32x32x16_bf16 v[112:127], v[72:75], v[44:47], v[112:127]
  v_exp_f32 v82, v82
  v_exp_f32 v83, v83
  v_cvt_pk_bf16_f32 v40, v80, v81
  v_cvt_pk_bf16_f32 v41, v82, v83
  s_waitcnt lgkmcnt(0)
  v_mfma_f32_32x32x16_bf16 v[96:111], v[48:51], v[28:31], 0
  v_exp_f32 v84, v84
  v_exp_f32 v85, v85
  s_mov_b64 exec, s[78:79]
  ds_read_b128 v[54:57], v218 offset:22528
  ds_read_b128 v[58:61], v218 offset:23168
  s_mov_b64 exec, -1
  v_exp_f32 v86, v86
  v_exp_f32 v87, v87
  v_cvt_pk_bf16_f32 v42, v84, v85
  v_cvt_pk_bf16_f32 v43, v86, v87
  v_mfma_f32_32x32x8_bf16 v[96:111], v[52:53], v[32:33], v[96:111]
  v_exp_f32 v88, v88
  v_exp_f32 v89, v89
  v_exp_f32 v90, v90
  v_exp_f32 v91, v91
  v_mfma_f32_32x32x16_bf16 v[128:143], v[68:71], v[40:43], 0
  v_cvt_pk_bf16_f32 v44, v88, v89
  v_cvt_pk_bf16_f32 v45, v90, v91
  v_exp_f32 v92, v92
  v_exp_f32 v93, v93
  v_exp_f32 v94, v94
  v_exp_f32 v95, v95
  v_cvt_pk_bf16_f32 v46, v92, v93
  v_cvt_pk_bf16_f32 v47, v94, v95
  v_exp_f32 v96, v96
  v_exp_f32 v97, v97
  v_mfma_f32_32x32x16_bf16 v[128:143], v[72:75], v[44:47], v[128:143]
  v_exp_f32 v98, v98
  ds_read_b128 v[62:65], v248 offset:22528
  ds_read_b64 v[66:67], v249 offset:22528
  v_exp_f32 v99, v99
  v_cvt_pk_bf16_f32 v40, v96, v97
  v_cvt_pk_bf16_f32 v41, v98, v99
  s_waitcnt lgkmcnt(2)
  v_mfma_f32_32x32x16_bf16 v[80:95], v[48:51], v[34:37], 0
  v_exp_f32 v100, v100
  v_exp_f32 v101, v101
  v_exp_f32 v102, v102
  v_exp_f32 v103, v103
  v_cvt_pk_bf16_f32 v42, v100, v101
  v_cvt_pk_bf16_f32 v43, v102, v103
  v_mfma_f32_32x32x8_bf16 v[80:95], v[52:53], v[38:39], v[80:95]
  v_exp_f32 v104, v104
  v_exp_f32 v105, v105
  v_exp_f32 v106, v106
  v_exp_f32 v107, v107
  v_mfma_f32_32x32x16_bf16 v[112:127], v[54:57], v[40:43], v[112:127]
  v_cvt_pk_bf16_f32 v44, v104, v105
  v_cvt_pk_bf16_f32 v45, v106, v107
  v_exp_f32 v108, v108
  v_exp_f32 v109, v109
  v_exp_f32 v110, v110
  v_exp_f32 v111, v111
  v_cvt_pk_bf16_f32 v46, v108, v109
  v_cvt_pk_bf16_f32 v47, v110, v111
  v_exp_f32 v80, v80
  v_exp_f32 v81, v81
  v_mfma_f32_32x32x16_bf16 v[112:127], v[58:61], v[44:47], v[112:127]
  v_exp_f32 v82, v82
  ds_read_b32 v2, v251 offset:112
  v_exp_f32 v83, v83
  v_cvt_pk_bf16_f32 v40, v80, v81
  v_cvt_pk_bf16_f32 v41, v82, v83
  s_waitcnt lgkmcnt(1)
  v_mfma_f32_32x32x16_bf16 v[96:111], v[62:65], v[28:31], 0
  v_exp_f32 v84, v84
  v_exp_f32 v85, v85
  s_mov_b64 exec, s[78:79]
  ds_read_b128 v[68:71], v250 offset:22528
  ds_read_b128 v[72:75], v250 offset:23168
  s_mov_b64 exec, -1
  v_exp_f32 v86, v86
  v_exp_f32 v87, v87
  v_cvt_pk_bf16_f32 v42, v84, v85
  v_cvt_pk_bf16_f32 v43, v86, v87
  v_mfma_f32_32x32x8_bf16 v[96:111], v[66:67], v[32:33], v[96:111]
  v_exp_f32 v88, v88
  v_exp_f32 v89, v89
  v_exp_f32 v90, v90
  v_exp_f32 v91, v91
  v_mfma_f32_32x32x16_bf16 v[128:143], v[54:57], v[40:43], v[128:143]
  v_cvt_pk_bf16_f32 v44, v88, v89
  v_cvt_pk_bf16_f32 v45, v90, v91
  v_exp_f32 v92, v92
  v_exp_f32 v93, v93
  v_exp_f32 v94, v94
  v_exp_f32 v95, v95
  v_cvt_pk_bf16_f32 v46, v92, v93
  v_cvt_pk_bf16_f32 v47, v94, v95
  v_exp_f32 v96, v96
  v_exp_f32 v97, v97
  v_mfma_f32_32x32x16_bf16 v[128:143], v[58:61], v[44:47], v[128:143]
  v_exp_f32 v98, v98
  v_exp_f32 v99, v99
  v_cvt_pk_bf16_f32 v40, v96, v97
  v_cvt_pk_bf16_f32 v41, v98, v99
  s_waitcnt lgkmcnt(0)
  v_mfma_f32_32x32x16_bf16 v[80:95], v[62:65], v[34:37], 0
  v_exp_f32 v100, v100
  v_cmp_gt_u32 vcc, 1, v2
  v_exp_f32 v101, v101
  s_cbranch_vccnz L_g2w20
L_g2r20:
  ds_read_b128 v[48:51], v216 offset:16896
  ds_read_b64 v[52:53], v217 offset:16896
  v_exp_f32 v102, v102
  v_exp_f32 v103, v103
  v_cvt_pk_bf16_f32 v42, v100, v101
  v_cvt_pk_bf16_f32 v43, v102, v103
  v_mfma_f32_32x32x8_bf16 v[80:95], v[66:67], v[38:39], v[80:95]
  v_exp_f32 v104, v104
  v_exp_f32 v105, v105
  v_exp_f32 v106, v106
  v_exp_f32 v107, v107
  v_mfma_f32_32x32x16_bf16 v[112:127], v[68:71], v[40:43], v[112:127]
  v_cvt_pk_bf16_f32 v44, v104, v105
  v_cvt_pk_bf16_f32 v45, v106, v107
  v_exp_f32 v108, v108
  v_exp_f32 v109, v109
  v_exp_f32 v110, v110
  v_exp_f32 v111, v111
  v_cvt_pk_bf16_f32 v46, v108, v109
  v_cvt_pk_bf16_f32 v47, v110, v111
  v_exp_f32 v80, v80
  v_exp_f32 v81, v81
  v_mfma_f32_32x32x16_bf16 v[112:127], v[72:75], v[44:47], v[112:127]
  v_exp_f32 v82, v82
  v_exp_f32 v83, v83
  v_cvt_pk_bf16_f32 v40, v80, v81
  v_cvt_pk_bf16_f32 v41, v82, v83
  s_waitcnt lgkmcnt(0)
  v_mfma_f32_32x32x16_bf16 v[96:111], v[48:51], v[28:31], 0
  v_exp_f32 v84, v84
  v_exp_f32 v85, v85
  s_mov_b64 exec, s[78:79]
  ds_read_b128 v[54:57], v218 offset:16896
  ds_read_b128 v[58:61], v218 offset:17536
  s_mov_b64 exec, -1
  v_exp_f32 v86, v86
  v_exp_f32 v87, v87
  v_cvt_pk_bf16_f32 v42, v84, v85
  v_cvt_pk_bf16_f32 v43, v86, v87
  v_mfma_f32_32x32x8_bf16 v[96:111], v[52:53], v[32:33], v[96:111]
  v_exp_f32 v88, v88
  v_exp_f32 v89, v89
  v_exp_f32 v90, v90
  v_exp_f32 v91, v91
  v_mfma_f32_32x32x16_bf16 v[128:143], v[68:71], v[40:43], v[128:143]
  v_cvt_pk_bf16_f32 v44, v88, v89
  v_cvt_pk_bf16_f32 v45, v90, v91
  v_exp_f32 v92, v92
  v_exp_f32 v93, v93
  v_exp_f32 v94, v94
  v_exp_f32 v95, v95
  v_cvt_pk_bf16_f32 v46, v92, v93
  v_cvt_pk_bf16_f32 v47, v94, v95
  s_cmp_eq_u32 s23, 0
  s_cbranch_scc1 L_ex2
  v_exp_f32 v96, v96
  v_exp_f32 v97, v97
  v_mfma_f32_32x32x16_bf16 v[128:143], v[72:75], v[44:47], v[128:143]
  v_exp_f32 v98, v98
  ds_read_b128 v[62:65], v248 offset:16896
  ds_read_b64 v[66:67], v249 offset:16896
  v_exp_f32 v99, v99
  v_cvt_pk_bf16_f32 v40, v96, v97
  v_cvt_pk_bf16_f32 v41, v98, v99
  s_waitcnt lgkmcnt(2)
  v_mfma_f32_32x32x16_bf16 v[80:95], v[48:51], v[34:37], 0
  v_exp_f32 v100, v100
  v_exp_f32 v101, v101
  v_exp_f32 v102, v102
  v_exp_f32 v103, v103
  v_cvt_pk_bf16_f32 v42, v100, v101
  v_cvt_pk_bf16_f32 v43, v102, v103
  v_mfma_f32_32x32x8_bf16 v[80:95], v[52:53], v[38:39], v[80:95]
  v_exp_f32 v104, v104
  v_exp_f32 v105, v105
  v_exp_f32 v106, v106
  v_exp_f32 v107, v107
  v_mfma_f32_32x32x16_bf16 v[112:127], v[54:57], v[40:43], v[112:127]
  v_cvt_pk_bf16_f32 v44, v104, v105
  v_cvt_pk_bf16_f32 v45, v106, v107
  v_exp_f32 v108, v108
  v_exp_f32 v109, v109
  v_exp_f32 v110, v110
  v_exp_f32 v111, v111
  v_cvt_pk_bf16_f32 v46, v108, v109
  v_cvt_pk_bf16_f32 v47, v110, v111
  v_exp_f32 v80, v80
  v_exp_f32 v81, v81
  v_mfma_f32_32x32x16_bf16 v[112:127], v[58:61], v[44:47], v[112:127]
  v_exp_f32 v82, v82
  v_exp_f32 v83, v83
  v_cvt_pk_bf16_f32 v40, v80, v81
  v_cvt_pk_bf16_f32 v41, v82, v83
  s_waitcnt lgkmcnt(0)
  v_mfma_f32_32x32x16_bf16 v[96:111], v[62:65], v[28:31], 0
  v_exp_f32 v84, v84
  v_exp_f32 v85, v85
  s_mov_b64 exec, s[78:79]
  ds_read_b128 v[68:71], v250 offset:16896
  ds_read_b128 v[72:75], v250 offset:17536
  s_mov_b64 exec, -1
  v_exp_f32 v86, v86
  v_exp_f32 v87, v87
  v_cvt_pk_bf16_f32 v42, v84, v85
  v_cvt_pk_bf16_f32 v43, v86, v87
  v_mfma_f32_32x32x8_bf16 v[96:111], v[66:67], v[32:33], v[96:111]
  v_exp_f32 v88, v88
  v_exp_f32 v89, v89
  v_exp_f32 v90, v90
  v_exp_f32 v91, v91
  v_mfma_f32_32x32x16_bf16 v[128:143], v[54:57], v[40:43], v[128:143]
  v_cvt_pk_bf16_f32 v44, v88, v89
  v_cvt_pk_bf16_f32 v45, v90, v91
  v_exp_f32 v92, v92
  v_exp_f32 v93, v93
  v_exp_f32 v94, v94
  v_exp_f32 v95, v95
  v_cvt_pk_bf16_f32 v46, v92, v93
  v_cvt_pk_bf16_f32 v47, v94, v95
  v_exp_f32 v96, v96
  v_exp_f32 v97, v97
  v_mfma_f32_32x32x16_bf16 v[128:143], v[58:61], v[44:47], v[128:143]
  v_exp_f32 v98, v98
  ds_read_b128 v[48:51], v216 offset:11264
  ds_read_b64 v[52:53], v217 offset:11264
  v_exp_f32 v99, v99
  v_cvt_pk_bf16_f32 v40, v96, v97
  v_cvt_pk_bf16_f32 v41, v98, v99
  s_waitcnt lgkmcnt(2)
  v_mfma_f32_32x32x16_bf16 v[80:95], v[62:65], v[34:37], 0
  v_exp_f32 v100, v100
  v_exp_f32 v101, v101
  v_exp_f32 v102, v102
  v_exp_f32 v103, v103
  v_cvt_pk_bf16_f32 v42, v100, v101
  v_cvt_pk_bf16_f32 v43, v102, v103
  v_mfma_f32_32x32x8_bf16 v[80:95], v[66:67], v[38:39], v[80:95]
  v_exp_f32 v104, v104
  v_exp_f32 v105, v105
  v_exp_f32 v106, v106
  v_exp_f32 v107, v107
  v_mfma_f32_32x32x16_bf16 v[112:127], v[68:71], v[40:43], v[112:127]
  v_cvt_pk_bf16_f32 v44, v104, v105
  v_cvt_pk_bf16_f32 v45, v106, v107
  v_exp_f32 v108, v108
  v_exp_f32 v109, v109
  v_exp_f32 v110, v110
  v_exp_f32 v111, v111
  v_cvt_pk_bf16_f32 v46, v108, v109
  v_cvt_pk_bf16_f32 v47, v110, v111
  v_exp_f32 v80, v80
  v_exp_f32 v81, v81
  v_mfma_f32_32x32x16_bf16 v[112:127], v[72:75], v[44:47], v[112:127]
  v_exp_f32 v82, v82
  v_exp_f32 v83, v83
  v_cvt_pk_bf16_f32 v40, v80, v81
  v_cvt_pk_bf16_f32 v41, v82, v83
  s_waitcnt lgkmcnt(0)
  v_mfma_f32_32x32x16_bf16 v[96:111], v[48:51], v[28:31], v[230:245]
  v_exp_f32 v84, v84
  v_exp_f32 v85, v85
  s_mov_b64 exec, s[78:79]
  ds_read_b128 v[54:57], v218 offset:11264
  ds_read_b128 v[58:61], v218 offset:11904
  s_mov_b64 exec, -1
  v_exp_f32 v86, v86
  v_exp_f32 v87, v87
  v_cvt_pk_bf16_f32 v42, v84, v85
  v_cvt_pk_bf16_f32 v43, v86, v87
  v_mfma_f32_32x32x8_bf16 v[96:111], v[52:53], v[32:33], v[96:111]
  v_exp_f32 v88, v88
  v_exp_f32 v89, v89
  v_exp_f32 v90, v90
  v_exp_f32 v91, v91
  v_mfma_f32_32x32x16_bf16 v[128:143], v[68:71], v[40:43], v[128:143]
  v_cvt_pk_bf16_f32 v44, v88, v89
  v_cvt_pk_bf16_f32 v45, v90, v91
  v_exp_f32 v92, v92
  v_exp_f32 v93, v93
  v_exp_f32 v94, v94
  v_exp_f32 v95, v95
  v_cvt_pk_bf16_f32 v46, v92, v93
  v_cvt_pk_bf16_f32 v47, v94, v95
  v_exp_f32 v96, v96
  v_exp_f32 v97, v97
  v_mfma_f32_32x32x16_bf16 v[128:143], v[72:75], v[44:47], v[128:143]
  v_exp_f32 v98, v98
  ds_read_b128 v[62:65], v248 offset:11264
  ds_read_b64 v[66:67], v249 offset:11264
  ds_read_b32 v2, v251 offset:116
  v_exp_f32 v99, v99
  v_cvt_pk_bf16_f32 v40, v96, v97
  v_cvt_pk_bf16_f32 v41, v98, v99
  s_waitcnt lgkmcnt(3)
  v_mfma_f32_32x32x16_bf16 v[80:95], v[48:51], v[34:37], 0
  v_exp_f32 v100, v100
  v_exp_f32 v101, v101
  v_exp_f32 v102, v102
  v_exp_f32 v103, v103
  v_cvt_pk_bf16_f32 v42, v100, v101
  v_cvt_pk_bf16_f32 v43, v102, v103
  v_mfma_f32_32x32x8_bf16 v[80:95], v[52:53], v[38:39], v[80:95]
  v_exp_f32 v104, v104
  v_exp_f32 v105, v105
  v_exp_f32 v106, v106
  v_exp_f32 v107, v107
  v_mfma_f32_32x32x16_bf16 v[112:127], v[54:57], v[40:43], v[112:127]
  v_cvt_pk_bf16_f32 v44, v104, v105
  v_cvt_pk_bf16_f32 v45, v106, v107
  v_exp_f32 v108, v108
  v_exp_f32 v109, v109
  v_exp_f32 v110, v110
  v_exp_f32 v111, v111
  v_cvt_pk_bf16_f32 v46, v108, v109
  v_cvt_pk_bf16_f32 v47, v110, v111
  v_exp_f32 v80, v80
  v_exp_f32 v81, v81
  v_mfma_f32_32x32x16_bf16 v[112:127], v[58:61], v[44:47], v[112:127]
  v_exp_f32 v82, v82
  v_exp_f32 v83, v83
  v_cvt_pk_bf16_f32 v40, v80, v81
  v_cvt_pk_bf16_f32 v41, v82, v83
  s_waitcnt lgkmcnt(0)
  v_mfma_f32_32x32x16_bf16 v[96:111], v[62:65], v[34:37], 0
  v_exp_f32 v84, v84
  v_cmp_gt_u32 vcc, 1, v2
  v_exp_f32 v85, v85
  s_cbranch_vccnz L_g2w21
L_g2r21:
  ds_read_b128 v[48:51], v216 offset:5632
  ds_read_b64 v[52:53], v217 offset:5632
  s_mov_b64 exec, s[78:79]
  ds_read_b128 v[68:71], v250 offset:11264
  ds_read_b128 v[72:75], v250 offset:11904
  s_mov_b64 exec, -1
  v_exp_f32 v86, v86
  v_exp_f32 v87, v87
  v_cvt_pk_bf16_f32 v42, v84, v85
  v_cvt_pk_bf16_f32 v43, v86, v87
  v_mfma_f32_32x32x8_bf16 v[96:111], v[66:67], v[38:39], v[96:111]
  v_exp_f32 v88, v88
  v_exp_f32 v89, v89
  v_exp_f32 v90, v90
  v_exp_f32 v91, v91
  v_mfma_f32_32x32x16_bf16 v[128:143], v[54:57], v[40:43], v[128:143]
  v_cvt_pk_bf16_f32 v44, v88, v89
  v_cvt_pk_bf16_f32 v45, v90, v91
  v_exp_f32 v92, v92
  v_exp_f32 v93, v93
  v_exp_f32 v94, v94
  v_exp_f32 v95, v95
  v_cvt_pk_bf16_f32 v46, v92, v93
  v_cvt_pk_bf16_f32 v47, v94, v95
  v_exp_f32 v96, v96
  v_exp_f32 v97, v97
  v_mfma_f32_32x32x16_bf16 v[128:143], v[58:61], v[44:47], v[128:143]
  v_exp_f32 v98, v98
  ds_read_b128 v[62:65], v248 offset:5632
  ds_read_b64 v[66:67], v249 offset:5632
  v_exp_f32 v99, v99
  v_cvt_pk_bf16_f32 v40, v96, v97
  v_cvt_pk_bf16_f32 v41, v98, v99
  s_waitcnt lgkmcnt(2)
  v_mfma_f32_32x32x16_bf16 v[80:95], v[48:51], v[34:37], 0
  v_exp_f32 v100, v100
  v_exp_f32 v101, v101
  s_mov_b64 exec, s[78:79]
  ds_read_b128 v[54:57], v218 offset:5632
  ds_read_b128 v[58:61], v218 offset:6272
  s_mov_b64 exec, -1
  v_exp_f32 v102, v102
  v_exp_f32 v103, v103
  v_cvt_pk_bf16_f32 v42, v100, v101
  v_cvt_pk_bf16_f32 v43, v102, v103
  v_mfma_f32_32x32x8_bf16 v[80:95], v[52:53], v[38:39], v[80:95]
  v_exp_f32 v104, v104
  v_exp_f32 v105, v105
  v_exp_f32 v106, v106
  v_exp_f32 v107, v107
  v_mfma_f32_32x32x16_bf16 v[128:143], v[68:71], v[40:43], v[128:143]
  v_cvt_pk_bf16_f32 v44, v104, v105
  v_cvt_pk_bf16_f32 v45, v106, v107
  v_exp_f32 v108, v108
  v_exp_f32 v109, v109
  v_exp_f32 v110, v110
  v_exp_f32 v111, v111
  v_cvt_pk_bf16_f32 v46, v108, v109
  v_cvt_pk_bf16_f32 v47, v110, v111
  v_exp_f32 v80, v80
  v_exp_f32 v81, v81
  v_mfma_f32_32x32x16_bf16 v[128:143], v[72:75], v[44:47], v[128:143]
  v_exp_f32 v82, v82
  v_exp_f32 v83, v83
  v_cvt_pk_bf16_f32 v40, v80, v81
  v_cvt_pk_bf16_f32 v41, v82, v83
  s_waitcnt lgkmcnt(0)
  v_mfma_f32_32x32x16_bf16 v[96:111], v[62:65], v[34:37], v[230:245]
  v_exp_f32 v84, v84
  v_exp_f32 v85, v85
  s_mov_b64 exec, s[78:79]
  ds_read_b128 v[68:71], v250 offset:5632
  ds_read_b128 v[72:75], v250 offset:6272
  s_mov_b64 exec, -1
  v_exp_f32 v86, v86
  v_exp_f32 v87, v87
  v_cvt_pk_bf16_f32 v42, v84, v85
  v_cvt_pk_bf16_f32 v43, v86, v87
  v_mfma_f32_32x32x8_bf16 v[96:111], v[66:67], v[38:39], v[96:111]
  v_exp_f32 v88, v88
  v_exp_f32 v89, v89
  v_exp_f32 v90, v90
  v_exp_f32 v91, v91
  v_mfma_f32_32x32x16_bf16 v[128:143], v[54:57], v[40:43], v[128:143]
  v_cvt_pk_bf16_f32 v44, v88, v89
  v_cvt_pk_bf16_f32 v45, v90, v91
  v_exp_f32 v92, v92
  v_exp_f32 v93, v93
  v_exp_f32 v94, v94
  v_exp_f32 v95, v95
  v_cvt_pk_bf16_f32 v46, v92, v93
  v_cvt_pk_bf16_f32 v47, v94, v95
  v_exp_f32 v96, v96
  v_exp_f32 v97, v97
  v_mfma_f32_32x32x16_bf16 v[128:143], v[58:61], v[44:47], v[128:143]
  s_mul_i32 s61, s44, 2560
  s_add_u32 m0, s61, 0
  s_add_u32 s61, s16, 6720
  s_add_u32 s62, s16, 13440
  s_mov_b32 exec_hi, 0x0fffffff
  buffer_load_dwordx4 v219, s[4:7], s16 offen lds
  buffer_load_dwordx4 v219, s[4:7], s61 offen offset:960 lds
  s_mov_b32 exec_hi, 0xff
  buffer_load_dwordx4 v219, s[4:7], s62 offen offset:1920 lds
  s_mov_b32 m0, 158208
  s_mov_b64 exec, 0x3ff
  buffer_load_dwordx4 v246, s[40:43], s17 offen lds
  s_mov_b64 exec, -1
  v_exp_f32 v98, v98
  v_exp_f32 v99, v99
  v_cvt_pk_bf16_f32 v40, v96, v97
  v_cvt_pk_bf16_f32 v41, v98, v99
  s_waitcnt lgkmcnt(0)
  v_exp_f32 v100, v100
  v_exp_f32 v101, v101
  v_exp_f32 v102, v102
  v_exp_f32 v103, v103
  v_cvt_pk_bf16_f32 v42, v100, v101
  v_cvt_pk_bf16_f32 v43, v102, v103
  v_exp_f32 v104, v104
  v_exp_f32 v105, v105
  v_exp_f32 v106, v106
  v_exp_f32 v107, v107
  v_mfma_f32_32x32x16_bf16 v[128:143], v[68:71], v[40:43], v[128:143]
  v_cvt_pk_bf16_f32 v44, v104, v105
  v_cvt_pk_bf16_f32 v45, v106, v107
  v_exp_f32 v108, v108
  v_exp_f32 v109, v109
  v_exp_f32 v110, v110
  v_exp_f32 v111, v111
  v_cvt_pk_bf16_f32 v46, v108, v109
  v_cvt_pk_bf16_f32 v47, v110, v111
  s_nop 1
  v_mfma_f32_32x32x16_bf16 v[128:143], v[72:75], v[44:47], v[128:143]
  s_branch L_afin
L_g2w20:
  v_mov_b32 v3, 159920
  s_mov_b32 s71, 1048576
Llw_93:
  ds_read_b32 v2, v3
  s_waitcnt lgkmcnt(0)
  v_cmp_gt_u32 vcc, 1, v2
  s_nop 0
  s_cbranch_vccz Llwok_94
  s_sub_u32 s71, s71, 1
  s_cbranch_scc1 Llwok_94
  s_branch Llw_93
Llwok_94:
  s_branch L_g2r20
L_g2w21:
  v_mov_b32 v3, 159924
  s_mov_b32 s71, 1048576
Llw_95:
  ds_read_b32 v2, v3
  s_waitcnt lgkmcnt(0)
  v_cmp_gt_u32 vcc, 1, v2
  s_nop 0
  s_cbranch_vccz Llwok_96
  s_sub_u32 s71, s71, 1
  s_cbranch_scc1 Llwok_96
  s_branch Llw_95
Llwok_96:
  s_branch L_g2r21
L_ex2:
  v_mfma_f32_32x32x16_bf16 v[128:143], v[72:75], v[44:47], v[128:143]
  s_mul_i32 s61, s44, 2560
  s_add_u32 m0, s61, 0
  s_add_u32 s61, s16, 6720
  s_add_u32 s62, s16, 13440
  s_mov_b32 exec_hi, 0x0fffffff
  buffer_load_dwordx4 v219, s[4:7], s16 offen lds
  buffer_load_dwordx4 v219, s[4:7], s61 offen offset:960 lds
  s_mov_b32 exec_hi, 0xff
  buffer_load_dwordx4 v219, s[4:7], s62 offen offset:1920 lds
  s_mov_b32 m0, 158208
  s_mov_b64 exec, 0x3ff
  buffer_load_dwordx4 v246, s[40:43], s17 offen lds
  s_mov_b64 exec, -1
  s_waitcnt lgkmcnt(0)
  s_branch L_afin
L_og5:
  s_sub_u32 s67, s67, 1
  s_cbranch_scc1 L_ogr5
  buffer_load_dwordx4 v[68:71], v246, s[32:35], s59 offen offset:0 sc1
  buffer_load_dwordx4 v[72:75], v246, s[32:35], s60 offen offset:0 sc1
  buffer_load_dwordx4 v[76:79], v246, s[32:35], s59 offen offset:1024 sc1
  buffer_load_dwordx4 v[80:83], v246, s[32:35], s60 offen offset:1024 sc1
  buffer_load_dwordx4 v[84:87], v246, s[32:35], s59 offen offset:2048 sc1
  buffer_load_dwordx4 v[88:91], v246, s[32:35], s60 offen offset:2048 sc1
  buffer_load_dwordx4 v[92:95], v246, s[32:35], s59 offen offset:3072 sc1
  buffer_load_dwordx4 v[96:99], v246, s[32:35], s60 offen offset:3072 sc1
  buffer_load_dwordx4 v[100:103], v221, s[32:35], s59 offen offset:0 sc1
  buffer_load_dwordx4 v[104:107], v221, s[32:35], s60 offen offset:0 sc1
  s_waitcnt vmcnt(6)
  v_max_u32 v10, v68, v70
  v_max3_u32 v10, v72, v74, v10
  v_max3_u32 v10, v76, v78, v10
  v_max3_u32 v10, v80, v82, v10
  v_cmp_eq_u32 vcc, -1, v10
  s_nop 0
  s_cbranch_vccnz L_og5
  s_branch L_ogr5
L_og7:
  s_sub_u32 s67, s67, 1
  s_cbranch_scc1 L_ogr7
  buffer_load_dwordx4 v[84:87], v246, s[32:35], s59 offen offset:2048 sc1
  buffer_load_dwordx4 v[88:91], v246, s[32:35], s60 offen offset:2048 sc1
  buffer_load_dwordx4 v[92:95], v246, s[32:35], s59 offen offset:3072 sc1
  buffer_load_dwordx4 v[96:99], v246, s[32:35], s60 offen offset:3072 sc1
  buffer_load_dwordx4 v[100:103], v221, s[32:35], s59 offen offset:0 sc1
  buffer_load_dwordx4 v[104:107], v221, s[32:35], s60 offen offset:0 sc1
  s_waitcnt vmcnt(0)
  v_max_u32 v10, v84, v86
  v_max3_u32 v10, v88, v90, v10
  v_max3_u32 v10, v92, v94, v10
  v_max3_u32 v10, v96, v98, v10
  v_max3_u32 v10, v100, v102, v10
  v_max3_u32 v10, v104, v106, v10
  v_cmp_eq_u32 vcc, -1, v10
  s_nop 0
  s_cbranch_vccnz L_og7
  s_branch L_ogr7
.p2alignl 12, 0xbf810000
L_av3:
  ds_read_b128 v[48:51], v248 offset:33792
  ds_read_b64 v[52:53], v249 offset:33792
  ds_read_b128 v[62:65], v216 offset:28160
  ds_read_b64 v[66:67], v217 offset:28160
  s_mov_b64 exec, s[78:79]
  ds_read_b128 v[54:57], v250 offset:33792
  ds_read_b128 v[58:61], v250 offset:34432
  s_mov_b64 exec, -1
  s_waitcnt lgkmcnt(0)
  v_mfma_f32_32x32x16_bf16 v[80:95], v[48:51], v[28:31], v[200:215]
  v_mfma_f32_32x32x8_bf16 v[80:95], v[52:53], v[32:33], v[80:95]
  s_nop 7
  s_nop 3
  v_exp_f32 v80, v80
  v_exp_f32 v81, v81
  v_exp_f32 v82, v82
  v_exp_f32 v83, v83
  v_cvt_pk_bf16_f32 v40, v80, v81
  v_cvt_pk_bf16_f32 v41, v82, v83
  v_mfma_f32_32x32x16_bf16 v[96:111], v[62:65], v[28:31], 0
  v_exp_f32 v84, v84
  v_exp_f32 v85, v85
  s_mov_b64 exec, s[78:79]
  ds_read_b128 v[68:71], v218 offset:28160
  ds_read_b128 v[72:75], v218 offset:28800
  s_mov_b64 exec, -1
  v_exp_f32 v86, v86
  v_exp_f32 v87, v87
  v_cvt_pk_bf16_f32 v42, v84, v85
  v_cvt_pk_bf16_f32 v43, v86, v87
  v_mfma_f32_32x32x8_bf16 v[96:111], v[66:67], v[32:33], v[96:111]
  v_exp_f32 v88, v88
  v_exp_f32 v89, v89
  v_exp_f32 v90, v90
  v_exp_f32 v91, v91
  v_mfma_f32_32x32x16_bf16 v[112:127], v[54:57], v[40:43], 0
  v_cvt_pk_bf16_f32 v44, v88, v89
  v_cvt_pk_bf16_f32 v45, v90, v91
  v_exp_f32 v92, v92
  v_exp_f32 v93, v93
  v_exp_f32 v94, v94
  v_exp_f32 v95, v95
  v_cvt_pk_bf16_f32 v46, v92, v93
  v_cvt_pk_bf16_f32 v47, v94, v95
  v_exp_f32 v96, v96
  v_exp_f32 v97, v97
  v_mfma_f32_32x32x16_bf16 v[112:127], v[58:61], v[44:47], v[112:127]
  v_exp_f32 v98, v98
  ds_read_b128 v[48:51], v248 offset:28160
  ds_read_b64 v[52:53], v249 offset:28160
  v_exp_f32 v99, v99
  v_cvt_pk_bf16_f32 v40, v96, v97
  v_cvt_pk_bf16_f32 v41, v98, v99
  s_waitcnt lgkmcnt(2)
  v_mfma_f32_32x32x16_bf16 v[80:95], v[62:65], v[34:37], v[200:215]
  v_exp_f32 v100, v100
  v_exp_f32 v101, v101
  v_exp_f32 v102, v102
  v_exp_f32 v103, v103
  v_cvt_pk_bf16_f32 v42, v100, v101
  v_cvt_pk_bf16_f32 v43, v102, v103
  v_mfma_f32_32x32x8_bf16 v[80:95], v[66:67], v[38:39], v[80:95]
  v_exp_f32 v104, v104
  v_exp_f32 v105, v105
  v_exp_f32 v106, v106
  v_exp_f32 v107, v107
  v_mfma_f32_32x32x16_bf16 v[112:127], v[68:71], v[40:43], v[112:127]
  v_cvt_pk_bf16_f32 v44, v104, v105
  v_cvt_pk_bf16_f32 v45, v106, v107
  v_exp_f32 v108, v108
  v_exp_f32 v109, v109
  v_exp_f32 v110, v110
  v_exp_f32 v111, v111
  v_cvt_pk_bf16_f32 v46, v108, v109
  v_cvt_pk_bf16_f32 v47, v110, v111
  v_exp_f32 v80, v80
  v_exp_f32 v81, v81
  v_mfma_f32_32x32x16_bf16 v[112:127], v[72:75], v[44:47], v[112:127]
  v_exp_f32 v82, v82
  v_exp_f32 v83, v83
  v_cvt_pk_bf16_f32 v40, v80, v81
  v_cvt_pk_bf16_f32 v41, v82, v83
  s_waitcnt lgkmcnt(0)
  v_mfma_f32_32x32x16_bf16 v[96:111], v[48:51], v[28:31], 0
  v_exp_f32 v84, v84
  v_exp_f32 v85, v85
  s_mov_b64 exec, s[78:79]
  ds_read_b128 v[54:57], v250 offset:28160
  ds_read_b128 v[58:61], v250 offset:28800
  s_mov_b64 exec, -1
  v_exp_f32 v86, v86
  v_exp_f32 v87, v87
  v_cvt_pk_bf16_f32 v42, v84, v85
  v_cvt_pk_bf16_f32 v43, v86, v87
  v_mfma_f32_32x32x8_bf16 v[96:111], v[52:53], v[32:33], v[96:111]
  v_exp_f32 v88, v88
  v_exp_f32 v89, v89
  v_exp_f32 v90, v90
  v_exp_f32 v91, v91
  v_mfma_f32_32x32x16_bf16 v[128:143], v[68:71], v[40:43], 0
  v_cvt_pk_bf16_f32 v44, v88, v89
  v_cvt_pk_bf16_f32 v45, v90, v91
  v_exp_f32 v92, v92
  v_exp_f32 v93, v93
  v_exp_f32 v94, v94
  v_exp_f32 v95, v95
  v_cvt_pk_bf16_f32 v46, v92, v93
  v_cvt_pk_bf16_f32 v47, v94, v95
  v_exp_f32 v96, v96
  v_exp_f32 v97, v97
  v_mfma_f32_32x32x16_bf16 v[128:143], v[72:75], v[44:47], v[128:143]
  v_exp_f32 v98, v98
  ds_read_b128 v[62:65], v216 offset:22528
  ds_read_b64 v[66:67], v217 offset:22528
  v_exp_f32 v99, v99
  v_cvt_pk_bf16_f32 v40, v96, v97
  v_cvt_pk_bf16_f32 v41, v98, v99
  s_waitcnt lgkmcnt(2)
  v_mfma_f32_32x32x16_bf16 v[80:95], v[48:51], v[34:37], 0
  v_exp_f32 v100, v100
  v_exp_f32 v101, v101
  v_exp_f32 v102, v102
  v_exp_f32 v103, v103
  v_cvt_pk_bf16_f32 v42, v100, v101
  v_cvt_pk_bf16_f32 v43, v102, v103
  v_mfma_f32_32x32x8_bf16 v[80:95], v[52:53], v[38:39], v[80:95]
  v_exp_f32 v104, v104
  v_exp_f32 v105, v105
  v_exp_f32 v106, v106
  v_exp_f32 v107, v107
  v_mfma_f32_32x32x16_bf16 v[112:127], v[54:57], v[40:43], v[112:127]
  v_cvt_pk_bf16_f32 v44, v104, v105
  v_cvt_pk_bf16_f32 v45, v106, v107
  v_exp_f32 v108, v108
  v_exp_f32 v109, v109
  v_exp_f32 v110, v110
  v_exp_f32 v111, v111
  v_cvt_pk_bf16_f32 v46, v108, v109
  v_cvt_pk_bf16_f32 v47, v110, v111
  v_exp_f32 v80, v80
  v_exp_f32 v81, v81
  v_mfma_f32_32x32x16_bf16 v[112:127], v[58:61], v[44:47], v[112:127]
  v_exp_f32 v82, v82
  v_exp_f32 v83, v83
  v_cvt_pk_bf16_f32 v40, v80, v81
  v_cvt_pk_bf16_f32 v41, v82, v83
  s_waitcnt lgkmcnt(0)
  v_mfma_f32_32x32x16_bf16 v[96:111], v[62:65], v[28:31], 0
  v_exp_f32 v84, v84
  v_exp_f32 v85, v85
  s_mov_b64 exec, s[78:79]
  ds_read_b128 v[68:71], v218 offset:22528
  ds_read_b128 v[72:75], v218 offset:23168
  s_mov_b64 exec, -1
  v_exp_f32 v86, v86
  v_exp_f32 v87, v87
  v_cvt_pk_bf16_f32 v42, v84, v85
  v_cvt_pk_bf16_f32 v43, v86, v87
  v_mfma_f32_32x32x8_bf16 v[96:111], v[66:67], v[32:33], v[96:111]
  v_exp_f32 v88, v88
  v_exp_f32 v89, v89
  v_exp_f32 v90, v90
  v_exp_f32 v91, v91
  v_mfma_f32_32x32x16_bf16 v[128:143], v[54:57], v[40:43], v[128:143]
  v_cvt_pk_bf16_f32 v44, v88, v89
  v_cvt_pk_bf16_f32 v45, v90, v91
  v_exp_f32 v92, v92
  v_exp_f32 v93, v93
  v_exp_f32 v94, v94
  v_exp_f32 v95, v95
  v_cvt_pk_bf16_f32 v46, v92, v93
  v_cvt_pk_bf16_f32 v47, v94, v95
  v_exp_f32 v96, v96
  v_exp_f32 v97, v97
  v_mfma_f32_32x32x16_bf16 v[128:143], v[58:61], v[44:47], v[128:143]
  v_exp_f32 v98, v98
  ds_read_b128 v[48:51], v248 offset:22528
  ds_read_b64 v[52:53], v249 offset:22528
  v_exp_f32 v99, v99
  v_cvt_pk_bf16_f32 v40, v96, v97
  v_cvt_pk_bf16_f32 v41, v98, v99
  s_waitcnt lgkmcnt(2)
  v_mfma_f32_32x32x16_bf16 v[80:95], v[62:65], v[34:37], 0
  v_exp_f32 v100, v100
  v_exp_f32 v101, v101
  v_exp_f32 v102, v102
  v_exp_f32 v103, v103
  v_cvt_pk_bf16_f32 v42, v100, v101
  v_cvt_pk_bf16_f32 v43, v102, v103
  v_mfma_f32_32x32x8_bf16 v[80:95], v[66:67], v[38:39], v[80:95]
  v_exp_f32 v104, v104
  v_exp_f32 v105, v105
  v_exp_f32 v106, v106
  v_exp_f32 v107, v107
  v_mfma_f32_32x32x16_bf16 v[112:127], v[68:71], v[40:43], v[112:127]
  v_cvt_pk_bf16_f32 v44, v104, v105
  v_cvt_pk_bf16_f32 v45, v106, v107
  v_exp_f32 v108, v108
  v_exp_f32 v109, v109
  v_exp_f32 v110, v110
  v_exp_f32 v111, v111
  v_cvt_pk_bf16_f32 v46, v108, v109
  v_cvt_pk_bf16_f32 v47, v110, v111
  v_exp_f32 v80, v80
  v_exp_f32 v81, v81
  v_mfma_f32_32x32x16_bf16 v[112:127], v[72:75], v[44:47], v[112:127]
  v_exp_f32 v82, v82
  ds_read_b32 v2, v251 offset:112
  v_exp_f32 v83, v83
  v_cvt_pk_bf16_f32 v40, v80, v81
  v_cvt_pk_bf16_f32 v41, v82, v83
  s_waitcnt lgkmcnt(1)
  v_mfma_f32_32x32x16_bf16 v[96:111], v[48:51], v[28:31], 0
  v_exp_f32 v84, v84
  v_exp_f32 v85, v85
  s_mov_b64 exec, s[78:79]
  ds_read_b128 v[54:57], v250 offset:22528
  ds_read_b128 v[58:61], v250 offset:23168
  s_mov_b64 exec, -1
  v_exp_f32 v86, v86
  v_exp_f32 v87, v87
  v_cvt_pk_bf16_f32 v42, v84, v85
  v_cvt_pk_bf16_f32 v43, v86, v87
  v_mfma_f32_32x32x8_bf16 v[96:111], v[52:53], v[32:33], v[96:111]
  v_exp_f32 v88, v88
  v_exp_f32 v89, v89
  v_exp_f32 v90, v90
  v_exp_f32 v91, v91
  v_mfma_f32_32x32x16_bf16 v[128:143], v[68:71], v[40:43], v[128:143]
  v_cvt_pk_bf16_f32 v44, v88, v89
  v_cvt_pk_bf16_f32 v45, v90, v91
  v_exp_f32 v92, v92
  v_exp_f32 v93, v93
  v_exp_f32 v94, v94
  v_exp_f32 v95, v95
  v_cvt_pk_bf16_f32 v46, v92, v93
  v_cvt_pk_bf16_f32 v47, v94, v95
  v_exp_f32 v96, v96
  v_exp_f32 v97, v97
  v_mfma_f32_32x32x16_bf16 v[128:143], v[72:75], v[44:47], v[128:143]
  v_exp_f32 v98, v98
  v_exp_f32 v99, v99
  v_cvt_pk_bf16_f32 v40, v96, v97
  v_cvt_pk_bf16_f32 v41, v98, v99
  s_waitcnt lgkmcnt(0)
  v_mfma_f32_32x32x16_bf16 v[80:95], v[48:51], v[34:37], 0
  v_exp_f32 v100, v100
  v_cmp_gt_u32 vcc, 1, v2
  v_exp_f32 v101, v101
  s_cbranch_vccnz L_g2w30
L_g2r30:
  ds_read_b128 v[62:65], v216 offset:16896
  ds_read_b64 v[66:67], v217 offset:16896
  v_exp_f32 v102, v102
  v_exp_f32 v103, v103
  v_cvt_pk_bf16_f32 v42, v100, v101
  v_cvt_pk_bf16_f32 v43, v102, v103
  v_mfma_f32_32x32x8_bf16 v[80:95], v[52:53], v[38:39], v[80:95]
  v_exp_f32 v104, v104
  v_exp_f32 v105, v105
  v_exp_f32 v106, v106
  v_exp_f32 v107, v107
  v_mfma_f32_32x32x16_bf16 v[112:127], v[54:57], v[40:43], v[112:127]
  v_cvt_pk_bf16_f32 v44, v104, v105
  v_cvt_pk_bf16_f32 v45, v106, v107
  v_exp_f32 v108, v108
  v_exp_f32 v109, v109
  v_exp_f32 v110, v110
  v_exp_f32 v111, v111
  v_cvt_pk_bf16_f32 v46, v108, v109
  v_cvt_pk_bf16_f32 v47, v110, v111
  v_exp_f32 v80, v80
  v_exp_f32 v81, v81
  v_mfma_f32_32x32x16_bf16 v[112:127], v[58:61], v[44:47], v[112:127]
  v_exp_f32 v82, v82
  v_exp_f32 v83, v83
  v_cvt_pk_bf16_f32 v40, v80, v81
  v_cvt_pk_bf16_f32 v41, v82, v83
  s_waitcnt lgkmcnt(0)
  v_mfma_f32_32x32x16_bf16 v[96:111], v[62:65], v[28:31], 0
  v_exp_f32 v84, v84
  v_exp_f32 v85, v85
  s_mov_b64 exec, s[78:79]
  ds_read_b128 v[68:71], v218 offset:16896
  ds_read_b128 v[72:75], v218 offset:17536
  s_mov_b64 exec, -1
  v_exp_f32 v86, v86
  v_exp_f32 v87, v87
  v_cvt_pk_bf16_f32 v42, v84, v85
  v_cvt_pk_bf16_f32 v43, v86, v87
  v_mfma_f32_32x32x8_bf16 v[96:111], v[66:67], v[32:33], v[96:111]
  v_exp_f32 v88, v88
  v_exp_f32 v89, v89
  v_exp_f32 v90, v90
  v_exp_f32 v91, v91
  v_mfma_f32_32x32x16_bf16 v[128:143], v[54:57], v[40:43], v[128:143]
  v_cvt_pk_bf16_f32 v44, v88, v89
  v_cvt_pk_bf16_f32 v45, v90, v91
  v_exp_f32 v92, v92
  v_exp_f32 v93, v93
  v_exp_f32 v94, v94
  v_exp_f32 v95, v95
  v_cvt_pk_bf16_f32 v46, v92, v93
  v_cvt_pk_bf16_f32 v47, v94, v95
  s_cmp_eq_u32 s23, 0
  s_cbranch_scc1 L_ex3
  v_exp_f32 v96, v96
  v_exp_f32 v97, v97
  v_mfma_f32_32x32x16_bf16 v[128:143], v[58:61], v[44:47], v[128:143]
  v_exp_f32 v98, v98
  ds_read_b128 v[48:51], v248 offset:16896
  ds_read_b64 v[52:53], v249 offset:16896
  v_exp_f32 v99, v99
  v_cvt_pk_bf16_f32 v40, v96, v97
  v_cvt_pk_bf16_f32 v41, v98, v99
  s_waitcnt lgkmcnt(2)
  v_mfma_f32_32x32x16_bf16 v[80:95], v[62:65], v[34:37], 0
  v_exp_f32 v100, v100
  v_exp_f32 v101, v101
  v_exp_f32 v102, v102
  v_exp_f32 v103, v103
  v_cvt_pk_bf16_f32 v42, v100, v101
  v_cvt_pk_bf16_f32 v43, v102, v103
  v_mfma_f32_32x32x8_bf16 v[80:95], v[66:67], v[38:39], v[80:95]
  v_exp_f32 v104, v104
  v_exp_f32 v105, v105
  v_exp_f32 v106, v106
  v_exp_f32 v107, v107
  v_mfma_f32_32x32x16_bf16 v[112:127], v[68:71], v[40:43], v[112:127]
  v_cvt_pk_bf16_f32 v44, v104, v105
  v_cvt_pk_bf16_f32 v45, v106, v107
  v_exp_f32 v108, v108
  v_exp_f32 v109, v109
  v_exp_f32 v110, v110
  v_exp_f32 v111, v111
  v_cvt_pk_bf16_f32 v46, v108, v109
  v_cvt_pk_bf16_f32 v47, v110, v111
  v_exp_f32 v80, v80
  v_exp_f32 v81, v81
  v_mfma_f32_32x32x16_bf16 v[112:127], v[72:75], v[44:47], v[112:127]
  v_exp_f32 v82, v82
  v_exp_f32 v83, v83
  v_cvt_pk_bf16_f32 v40, v80, v81
  v_cvt_pk_bf16_f32 v41, v82, v83
  s_waitcnt lgkmcnt(0)
  v_mfma_f32_32x32x16_bf16 v[96:111], v[48:51], v[28:31], 0
  v_exp_f32 v84, v84
  v_exp_f32 v85, v85
  s_mov_b64 exec, s[78:79]
  ds_read_b128 v[54:57], v250 offset:16896
  ds_read_b128 v[58:61], v250 offset:17536
  s_mov_b64 exec, -1
  v_exp_f32 v86, v86
  v_exp_f32 v87, v87
  v_cvt_pk_bf16_f32 v42, v84, v85
  v_cvt_pk_bf16_f32 v43, v86, v87
  v_mfma_f32_32x32x8_bf16 v[96:111], v[52:53], v[32:33], v[96:111]
  v_exp_f32 v88, v88
  v_exp_f32 v89, v89
  v_exp_f32 v90, v90
  v_exp_f32 v91, v91
  v_mfma_f32_32x32x16_bf16 v[128:143], v[68:71], v[40:43], v[128:143]
  v_cvt_pk_bf16_f32 v44, v88, v89
  v_cvt_pk_bf16_f32 v45, v90, v91
  v_exp_f32 v92, v92
  v_exp_f32 v93, v93
  v_exp_f32 v94, v94
  v_exp_f32 v95, v95
  v_cvt_pk_bf16_f32 v46, v92, v93
  v_cvt_pk_bf16_f32 v47, v94, v95
  v_exp_f32 v96, v96
  v_exp_f32 v97, v97
  v_mfma_f32_32x32x16_bf16 v[128:143], v[72:75], v[44:47], v[128:143]
  v_exp_f32 v98, v98
  ds_read_b128 v[62:65], v216 offset:11264
  ds_read_b64 v[66:67], v217 offset:11264
  v_exp_f32 v99, v99
  v_cvt_pk_bf16_f32 v40, v96, v97
  v_cvt_pk_bf16_f32 v41, v98, v99
  s_waitcnt lgkmcnt(2)
  v_mfma_f32_32x32x16_bf16 v[80:95], v[48:51], v[34:37], 0
  v_exp_f32 v100, v100
  v_exp_f32 v101, v101
  v_exp_f32 v102, v102
  v_exp_f32 v103, v103
  v_cvt_pk_bf16_f32 v42, v100, v101
  v_cvt_pk_bf16_f32 v43, v102, v103
  v_mfma_f32_32x32x8_bf16 v[80:95], v[52:53], v[38:39], v[80:95]
  v_exp_f32 v104, v104
  v_exp_f32 v105, v105
  v_exp_f32 v106, v106
  v_exp_f32 v107, v107
  v_mfma_f32_32x32x16_bf16 v[112:127], v[54:57], v[40:43], v[112:127]
  v_cvt_pk_bf16_f32 v44, v104, v105
  v_cvt_pk_bf16_f32 v45, v106, v107
  v_exp_f32 v108, v108
  v_exp_f32 v109, v109
  v_exp_f32 v110, v110
  v_exp_f32 v111, v111
  v_cvt_pk_bf16_f32 v46, v108, v109
  v_cvt_pk_bf16_f32 v47, v110, v111
  v_exp_f32 v80, v80
  v_exp_f32 v81, v81
  v_mfma_f32_32x32x16_bf16 v[112:127], v[58:61], v[44:47], v[112:127]
  v_exp_f32 v82, v82
  v_exp_f32 v83, v83
  v_cvt_pk_bf16_f32 v40, v80, v81
  v_cvt_pk_bf16_f32 v41, v82, v83
  s_waitcnt lgkmcnt(0)
  v_mfma_f32_32x32x16_bf16 v[96:111], v[62:65], v[28:31], 0
  v_exp_f32 v84, v84
  v_exp_f32 v85, v85
  s_mov_b64 exec, s[78:79]
  ds_read_b128 v[68:71], v218 offset:11264
  ds_read_b128 v[72:75], v218 offset:11904
  s_mov_b64 exec, -1
  v_exp_f32 v86, v86
  v_exp_f32 v87, v87
  v_cvt_pk_bf16_f32 v42, v84, v85
  v_cvt_pk_bf16_f32 v43, v86, v87
  v_mfma_f32_32x32x8_bf16 v[96:111], v[66:67], v[32:33], v[96:111]
  v_exp_f32 v88, v88
  v_exp_f32 v89, v89
  v_exp_f32 v90, v90
  v_exp_f32 v91, v91
  v_mfma_f32_32x32x16_bf16 v[128:143], v[54:57], v[40:43], v[128:143]
  v_cvt_pk_bf16_f32 v44, v88, v89
  v_cvt_pk_bf16_f32 v45, v90, v91
  v_exp_f32 v92, v92
  v_exp_f32 v93, v93
  v_exp_f32 v94, v94
  v_exp_f32 v95, v95
  v_cvt_pk_bf16_f32 v46, v92, v93
  v_cvt_pk_bf16_f32 v47, v94, v95
  v_exp_f32 v96, v96
  v_exp_f32 v97, v97
  v_mfma_f32_32x32x16_bf16 v[128:143], v[58:61], v[44:47], v[128:143]
  v_exp_f32 v98, v98
  ds_read_b128 v[48:51], v248 offset:11264
  ds_read_b64 v[52:53], v249 offset:11264
  v_exp_f32 v99, v99
  v_cvt_pk_bf16_f32 v40, v96, v97
  v_cvt_pk_bf16_f32 v41, v98, v99
  s_waitcnt lgkmcnt(2)
  v_mfma_f32_32x32x16_bf16 v[80:95], v[62:65], v[34:37], 0
  v_exp_f32 v100, v100
  v_exp_f32 v101, v101
  v_exp_f32 v102, v102
  v_exp_f32 v103, v103
  v_cvt_pk_bf16_f32 v42, v100, v101
  v_cvt_pk_bf16_f32 v43, v102, v103
  v_mfma_f32_32x32x8_bf16 v[80:95], v[66:67], v[38:39], v[80:95]
  v_exp_f32 v104, v104
  v_exp_f32 v105, v105
  v_exp_f32 v106, v106
  v_exp_f32 v107, v107
  v_mfma_f32_32x32x16_bf16 v[112:127], v[68:71], v[40:43], v[112:127]
  v_cvt_pk_bf16_f32 v44, v104, v105
  v_cvt_pk_bf16_f32 v45, v106, v107
  v_exp_f32 v108, v108
  v_exp_f32 v109, v109
  v_exp_f32 v110, v110
  v_exp_f32 v111, v111
  v_cvt_pk_bf16_f32 v46, v108, v109
  v_cvt_pk_bf16_f32 v47, v110, v111
  v_exp_f32 v80, v80
  v_exp_f32 v81, v81
  v_mfma_f32_32x32x16_bf16 v[112:127], v[72:75], v[44:47], v[112:127]
  v_exp_f32 v82, v82
  ds_read_b32 v2, v251 offset:116
  v_exp_f32 v83, v83
  v_cvt_pk_bf16_f32 v40, v80, v81
  v_cvt_pk_bf16_f32 v41, v82, v83
  s_waitcnt lgkmcnt(1)
  v_mfma_f32_32x32x16_bf16 v[96:111], v[48:51], v[28:31], v[230:245]
  v_exp_f32 v84, v84
  v_exp_f32 v85, v85
  s_mov_b64 exec, s[78:79]
  ds_read_b128 v[54:57], v250 offset:11264
  ds_read_b128 v[58:61], v250 offset:11904
  s_mov_b64 exec, -1
  v_exp_f32 v86, v86
  v_exp_f32 v87, v87
  v_cvt_pk_bf16_f32 v42, v84, v85
  v_cvt_pk_bf16_f32 v43, v86, v87
  v_mfma_f32_32x32x8_bf16 v[96:111], v[52:53], v[32:33], v[96:111]
  v_exp_f32 v88, v88
  v_exp_f32 v89, v89
  v_exp_f32 v90, v90
  v_exp_f32 v91, v91
  v_mfma_f32_32x32x16_bf16 v[128:143], v[68:71], v[40:43], v[128:143]
  v_cvt_pk_bf16_f32 v44, v88, v89
  v_cvt_pk_bf16_f32 v45, v90, v91
  v_exp_f32 v92, v92
  v_exp_f32 v93, v93
  v_exp_f32 v94, v94
  v_exp_f32 v95, v95
  v_cvt_pk_bf16_f32 v46, v92, v93
  v_cvt_pk_bf16_f32 v47, v94, v95
  v_exp_f32 v96, v96
  v_exp_f32 v97, v97
  v_mfma_f32_32x32x16_bf16 v[128:143], v[72:75], v[44:47], v[128:143]
  v_exp_f32 v98, v98
  v_exp_f32 v99, v99
  v_cvt_pk_bf16_f32 v40, v96, v97
  v_cvt_pk_bf16_f32 v41, v98, v99
  s_waitcnt lgkmcnt(0)
  v_mfma_f32_32x32x16_bf16 v[80:95], v[48:51], v[34:37], 0
  v_exp_f32 v100, v100
  v_cmp_gt_u32 vcc, 1, v2
  v_exp_f32 v101, v101
  s_cbranch_vccnz L_g2w31
L_g2r31:
  ds_read_b128 v[62:65], v216 offset:5632
  ds_read_b64 v[66:67], v217 offset:5632
  v_exp_f32 v102, v102
  v_exp_f32 v103, v103
  v_cvt_pk_bf16_f32 v42, v100, v101
  v_cvt_pk_bf16_f32 v43, v102, v103
  v_mfma_f32_32x32x8_bf16 v[80:95], v[52:53], v[38:39], v[80:95]
  v_exp_f32 v104, v104
  v_exp_f32 v105, v105
  v_exp_f32 v106, v106
  v_exp_f32 v107, v107
  v_mfma_f32_32x32x16_bf16 v[112:127], v[54:57], v[40:43], v[112:127]
  v_cvt_pk_bf16_f32 v44, v104, v105
  v_cvt_pk_bf16_f32 v45, v106, v107
  v_exp_f32 v108, v108
  v_exp_f32 v109, v109
  v_exp_f32 v110, v110
  v_exp_f32 v111, v111
  v_cvt_pk_bf16_f32 v46, v108, v109
  v_cvt_pk_bf16_f32 v47, v110, v111
  v_exp_f32 v80, v80
  v_exp_f32 v81, v81
  v_mfma_f32_32x32x16_bf16 v[112:127], v[58:61], v[44:47], v[112:127]
  v_exp_f32 v82, v82
  v_exp_f32 v83, v83
  v_cvt_pk_bf16_f32 v40, v80, v81
  v_cvt_pk_bf16_f32 v41, v82, v83
  s_waitcnt lgkmcnt(0)
  v_mfma_f32_32x32x16_bf16 v[96:111], v[62:65], v[34:37], v[230:245]
  v_exp_f32 v84, v84
  v_exp_f32 v85, v85
  s_mov_b64 exec, s[78:79]
  ds_read_b128 v[68:71], v218 offset:5632
  ds_read_b128 v[72:75], v218 offset:6272
  s_mov_b64 exec, -1
  v_exp_f32 v86, v86
  v_exp_f32 v87, v87
  v_cvt_pk_bf16_f32 v42, v84, v85
  v_cvt_pk_bf16_f32 v43, v86, v87
  v_mfma_f32_32x32x8_bf16 v[96:111], v[66:67], v[38:39], v[96:111]
  v_exp_f32 v88, v88
  v_exp_f32 v89, v89
  v_exp_f32 v90, v90
  v_exp_f32 v91, v91
  v_mfma_f32_32x32x16_bf16 v[128:143], v[54:57], v[40:43], v[128:143]
  v_cvt_pk_bf16_f32 v44, v88, v89
  v_cvt_pk_bf16_f32 v45, v90, v91
  v_exp_f32 v92, v92
  v_exp_f32 v93, v93
  v_exp_f32 v94, v94
  v_exp_f32 v95, v95
  v_cvt_pk_bf16_f32 v46, v92, v93
  v_cvt_pk_bf16_f32 v47, v94, v95
  v_exp_f32 v96, v96
  v_exp_f32 v97, v97
  v_mfma_f32_32x32x16_bf16 v[128:143], v[58:61], v[44:47], v[128:143]
  s_mul_i32 s61, s44, 2560
  s_add_u32 m0, s61, 0
  s_add_u32 s61, s16, 6720
  s_add_u32 s62, s16, 13440
  s_mov_b32 exec_hi, 0x0fffffff
  buffer_load_dwordx4 v219, s[4:7], s16 offen lds
  buffer_load_dwordx4 v219, s[4:7], s61 offen offset:960 lds
  s_mov_b32 exec_hi, 0xff
  buffer_load_dwordx4 v219, s[4:7], s62 offen offset:1920 lds
  s_mov_b32 m0, 158208
  s_mov_b64 exec, 0x3ff
  buffer_load_dwordx4 v246, s[40:43], s17 offen lds
  s_mov_b64 exec, -1
  v_exp_f32 v98, v98
  v_exp_f32 v99, v99
  v_cvt_pk_bf16_f32 v40, v96, v97
  v_cvt_pk_bf16_f32 v41, v98, v99
  s_waitcnt lgkmcnt(0)
  v_exp_f32 v100, v100
  v_exp_f32 v101, v101
  v_exp_f32 v102, v102
  v_exp_f32 v103, v103
  v_cvt_pk_bf16_f32 v42, v100, v101
  v_cvt_pk_bf16_f32 v43, v102, v103
  v_exp_f32 v104, v104
  v_exp_f32 v105, v105
  v_exp_f32 v106, v106
  v_exp_f32 v107, v107
  v_mfma_f32_32x32x16_bf16 v[128:143], v[68:71], v[40:43], v[128:143]
  v_cvt_pk_bf16_f32 v44, v104, v105
  v_cvt_pk_bf16_f32 v45, v106, v107
  v_exp_f32 v108, v108
  v_exp_f32 v109, v109
  v_exp_f32 v110, v110
  v_exp_f32 v111, v111
  v_cvt_pk_bf16_f32 v46, v108, v109
  v_cvt_pk_bf16_f32 v47, v110, v111
  s_nop 1
  v_mfma_f32_32x32x16_bf16 v[128:143], v[72:75], v[44:47], v[128:143]
  s_branch L_afin
L_g2w30:
  v_mov_b32 v3, 159920
  s_mov_b32 s71, 1048576
Llw_97:
  ds_read_b32 v2, v3
  s_waitcnt lgkmcnt(0)
  v_cmp_gt_u32 vcc, 1, v2
  s_nop 0
  s_cbranch_vccz Llwok_98
  s_sub_u32 s71, s71, 1
  s_cbranch_scc1 Llwok_98
  s_branch Llw_97
Llwok_98:
  s_branch L_g2r30
L_g2w31:
  v_mov_b32 v3, 159924
  s_mov_b32 s71, 1048576
Llw_99:
  ds_read_b32 v2, v3
  s_waitcnt lgkmcnt(0)
  v_cmp_gt_u32 vcc, 1, v2
  s_nop 0
  s_cbranch_vccz Llwok_100
  s_sub_u32 s71, s71, 1
  s_cbranch_scc1 Llwok_100
  s_branch Llw_99
Llwok_100:
  s_branch L_g2r31
L_ex3:
  v_mfma_f32_32x32x16_bf16 v[128:143], v[58:61], v[44:47], v[128:143]
  s_mul_i32 s61, s44, 2560
  s_add_u32 m0, s61, 0
  s_add_u32 s61, s16, 6720
  s_add_u32 s62, s16, 13440
  s_mov_b32 exec_hi, 0x0fffffff
  buffer_load_dwordx4 v219, s[4:7], s16 offen lds
  buffer_load_dwordx4 v219, s[4:7], s61 offen offset:960 lds
  s_mov_b32 exec_hi, 0xff
  buffer_load_dwordx4 v219, s[4:7], s62 offen offset:1920 lds
  s_mov_b32 m0, 158208
  s_mov_b64 exec, 0x3ff
  buffer_load_dwordx4 v246, s[40:43], s17 offen lds
  s_mov_b64 exec, -1
  s_waitcnt lgkmcnt(0)
  s_branch L_afin
L_og0:
  s_sub_u32 s67, s67, 1
  s_cbranch_scc1 L_ogr0
  buffer_load_dwordx4 v[28:31], v246, s[32:35], s56 offen offset:0 sc1
  buffer_load_dwordx4 v[32:35], v246, s[32:35], s57 offen offset:0 sc1
  buffer_load_dwordx4 v[36:39], v246, s[32:35], s56 offen offset:1024 sc1
  buffer_load_dwordx4 v[40:43], v246, s[32:35], s57 offen offset:1024 sc1
  buffer_load_dwordx4 v[44:47], v246, s[32:35], s56 offen offset:2048 sc1
  buffer_load_dwordx4 v[48:51], v246, s[32:35], s57 offen offset:2048 sc1
  buffer_load_dwordx4 v[52:55], v246, s[32:35], s56 offen offset:3072 sc1
  buffer_load_dwordx4 v[56:59], v246, s[32:35], s57 offen offset:3072 sc1
  buffer_load_dwordx4 v[60:63], v221, s[32:35], s56 offen offset:0 sc1
  buffer_load_dwordx4 v[64:67], v221, s[32:35], s57 offen offset:0 sc1
  s_waitcnt vmcnt(0)
  v_max_u32 v10, v28, v30
  v_max3_u32 v10, v32, v34, v10
  v_cmp_eq_u32 vcc, -1, v10
  s_nop 0
  s_cbranch_vccnz L_og0
  s_branch L_ogr0
L_og1:
  s_sub_u32 s67, s67, 1
  s_cbranch_scc1 L_ogr1
  buffer_load_dwordx4 v[36:39], v246, s[32:35], s56 offen offset:1024 sc1
  buffer_load_dwordx4 v[40:43], v246, s[32:35], s57 offen offset:1024 sc1
  buffer_load_dwordx4 v[44:47], v246, s[32:35], s56 offen offset:2048 sc1
  buffer_load_dwordx4 v[48:51], v246, s[32:35], s57 offen offset:2048 sc1
  buffer_load_dwordx4 v[52:55], v246, s[32:35], s56 offen offset:3072 sc1
  buffer_load_dwordx4 v[56:59], v246, s[32:35], s57 offen offset:3072 sc1
  buffer_load_dwordx4 v[60:63], v221, s[32:35], s56 offen offset:0 sc1
  buffer_load_dwordx4 v[64:67], v221, s[32:35], s57 offen offset:0 sc1
  s_waitcnt vmcnt(0)
  v_max_u32 v10, v36, v38
  v_max3_u32 v10, v40, v42, v10
  v_max3_u32 v10, v44, v46, v10
  v_max3_u32 v10, v48, v50, v10
  v_cmp_eq_u32 vcc, -1, v10
  s_nop 0
  s_cbranch_vccnz L_og1
  s_branch L_ogr1
L_og3:
  s_sub_u32 s67, s67, 1
  s_cbranch_scc1 L_ogr3
  buffer_load_dwordx4 v[52:55], v246, s[32:35], s56 offen offset:3072 sc1
  buffer_load_dwordx4 v[56:59], v246, s[32:35], s57 offen offset:3072 sc1
  buffer_load_dwordx4 v[60:63], v221, s[32:35], s56 offen offset:0 sc1
  buffer_load_dwordx4 v[64:67], v221, s[32:35], s57 offen offset:0 sc1
  s_waitcnt vmcnt(0)
  v_max_u32 v10, v52, v54
  v_max3_u32 v10, v56, v58, v10
  v_max3_u32 v10, v60, v62, v10
  v_max3_u32 v10, v64, v66, v10
  v_cmp_eq_u32 vcc, -1, v10
  s_nop 0
  s_cbranch_vccnz L_og3
  s_branch L_ogr3
.p2alignl 12, 0xbf810000
L_afin:
  s_mov_b32 s61, 0x2b800000
  s_mov_b32 s62, 0x28000000
  v_cndmask_b32 v2, v120, v124, s[76:77]
  v_pk_add_f32 v[4:5], v[112:113], v[114:115]
  v_rcp_f32 v3, v2
  v_pk_add_f32 v[6:7], v[116:117], v[118:119]
  v_pk_add_f32 v[8:9], v[120:121], v[122:123]
  v_subrev_u32 v2, s61, v2
  v_pk_add_f32 v[4:5], v[4:5], v[6:7]
  v_cmp_lt_u32 s[72:73], s62, v2
  v_pk_add_f32 v[4:5], v[4:5], v[8:9]
  v_add_f32 v4, v4, v5
  v_cmp_class_f32 vcc, v4, v255
  v_pk_mul_f32 v[112:113], v[112:113], v[2:3] op_sel:[0,1] op_sel_hi:[1,1]
  v_pk_mul_f32 v[114:115], v[114:115], v[2:3] op_sel:[0,1] op_sel_hi:[1,1]
  v_pk_mul_f32 v[116:117], v[116:117], v[2:3] op_sel:[0,1] op_sel_hi:[1,1]
  v_pk_mul_f32 v[118:119], v[118:119], v[2:3] op_sel:[0,1] op_sel_hi:[1,1]
  v_pk_mul_f32 v[120:121], v[120:121], v[2:3] op_sel:[0,1] op_sel_hi:[1,1]
  v_pk_mul_f32 v[122:123], v[122:123], v[2:3] op_sel:[0,1] op_sel_hi:[1,1]
  s_or_b64 vcc, vcc, s[72:73]
  s_cbranch_scc1 L_afb0
L_afr0:
  v_cvt_pk_bf16_f32 v112, v112, v113
  v_cvt_pk_bf16_f32 v113, v114, v115
  v_cvt_pk_bf16_f32 v114, v116, v117
  v_cvt_pk_bf16_f32 v115, v118, v119
  v_cvt_pk_bf16_f32 v116, v120, v121
  v_cvt_pk_bf16_f32 v117, v122, v123
  s_cmp_lg_u32 s69, 0
  s_cbranch_scc1 L_osc0
  buffer_store_dwordx4 v[112:115], v252, s[32:35], s12 offen
  s_mov_b64 exec, s[76:77]
  buffer_store_dwordx2 v[116:117], v252, s[32:35], s14 offen offset:512
  s_mov_b64 exec, -1
  s_branch L_osr0
L_osc0:
  buffer_store_dwordx4 v[112:115], v252, s[32:35], s12 offen sc1
  s_mov_b64 exec, s[76:77]
  buffer_store_dwordx2 v[116:117], v252, s[32:35], s14 offen offset:512 sc1
  s_mov_b64 exec, -1
L_osr0:
  v_cndmask_b32 v2, v136, v140, s[76:77]
  v_pk_add_f32 v[4:5], v[128:129], v[130:131]
  v_rcp_f32 v3, v2
  v_pk_add_f32 v[6:7], v[132:133], v[134:135]
  v_pk_add_f32 v[8:9], v[136:137], v[138:139]
  v_subrev_u32 v2, s61, v2
  v_pk_add_f32 v[4:5], v[4:5], v[6:7]
  v_cmp_lt_u32 s[72:73], s62, v2
  v_pk_add_f32 v[4:5], v[4:5], v[8:9]
  v_add_f32 v4, v4, v5
  v_cmp_class_f32 vcc, v4, v255
  v_pk_mul_f32 v[128:129], v[128:129], v[2:3] op_sel:[0,1] op_sel_hi:[1,1]
  v_pk_mul_f32 v[130:131], v[130:131], v[2:3] op_sel:[0,1] op_sel_hi:[1,1]
  v_pk_mul_f32 v[132:133], v[132:133], v[2:3] op_sel:[0,1] op_sel_hi:[1,1]
  v_pk_mul_f32 v[134:135], v[134:135], v[2:3] op_sel:[0,1] op_sel_hi:[1,1]
  v_pk_mul_f32 v[136:137], v[136:137], v[2:3] op_sel:[0,1] op_sel_hi:[1,1]
  v_pk_mul_f32 v[138:139], v[138:139], v[2:3] op_sel:[0,1] op_sel_hi:[1,1]
  s_or_b64 vcc, vcc, s[72:73]
  s_cbranch_scc1 L_afb1
L_afr1:
  v_cvt_pk_bf16_f32 v128, v128, v129
  v_cvt_pk_bf16_f32 v129, v130, v131
  v_cvt_pk_bf16_f32 v130, v132, v133
  v_cvt_pk_bf16_f32 v131, v134, v135
  v_cvt_pk_bf16_f32 v132, v136, v137
  v_cvt_pk_bf16_f32 v133, v138, v139
  s_cmp_lg_u32 s69, 0
  s_cbranch_scc1 L_osc1
  buffer_store_dwordx4 v[128:131], v252, s[32:35], s13 offen
  s_mov_b64 exec, s[76:77]
  buffer_store_dwordx2 v[132:133], v252, s[32:35], s15 offen offset:512
  s_mov_b64 exec, -1
  s_branch L_osr1
L_osc1:
  buffer_store_dwordx4 v[128:131], v252, s[32:35], s13 offen sc1
  s_mov_b64 exec, s[76:77]
  buffer_store_dwordx2 v[132:133], v252, s[32:35], s15 offen offset:512 sc1
  s_mov_b64 exec, -1
L_osr1:
  v_mov_b32 v2, 159844
  v_mov_b32 v3, 1
  s_mov_b64 exec, 1
  ds_add_u32 v2, v3
  s_mov_b64 exec, -1
  s_cmp_lg_u32 s51, 0
  s_cbranch_scc1 L_plsl
L_plr:
  v_mov_b32 v2, 159844
  s_waitcnt vmcnt(4)
  ds_read_b64 v[176:177], v223 offset:0
  ds_read_b64 v[178:179], v223 offset:8
  ds_read_b64 v[180:181], v223 offset:16
  ds_read_b64 v[182:183], v223 offset:24
  ds_read_b64 v[184:185], v223 offset:32
  ds_read_b64 v[186:187], v225 offset:0
  ds_read_b64 v[188:189], v225 offset:8
  ds_read_b64 v[190:191], v225 offset:16
  ds_read_b64 v[192:193], v225 offset:24
  ds_read_b64 v[194:195], v225 offset:32
  s_mov_b32 s71, 1048576
Llw_105:
  ds_read_b32 v3, v2
  s_waitcnt lgkmcnt(0)
  v_cmp_gt_u32 vcc, 4, v3
  s_nop 0
  s_cbranch_vccz Llwok_106
  s_sub_u32 s71, s71, 1
  s_cbranch_scc1 Llwok_106
  s_branch Llw_105
Llwok_106:
  buffer_load_dwordx4 v[28:31], v246, s[32:35], s56 offen offset:0 sc1
  buffer_load_dwordx4 v[32:35], v246, s[32:35], s57 offen offset:0 sc1
  buffer_load_dwordx4 v[36:39], v246, s[32:35], s56 offen offset:1024 sc1
  buffer_load_dwordx4 v[40:43], v246, s[32:35], s57 offen offset:1024 sc1
  buffer_load_dwordx4 v[44:47], v246, s[32:35], s56 offen offset:2048 sc1
  buffer_load_dwordx4 v[48:51], v246, s[32:35], s57 offen offset:2048 sc1
  buffer_load_dwordx4 v[52:55], v246, s[32:35], s56 offen offset:3072 sc1
  buffer_load_dwordx4 v[56:59], v246, s[32:35], s57 offen offset:3072 sc1
  buffer_load_dwordx4 v[60:63], v221, s[32:35], s56 offen offset:0 sc1
  buffer_load_dwordx4 v[64:67], v221, s[32:35], s57 offen offset:0 sc1
  v_lshlrev_b32 v200, 16, v176
  v_and_b32 v201, 0xffff0000, v176
  v_lshlrev_b32 v202, 16, v177
  v_and_b32 v203, 0xffff0000, v177
  v_lshlrev_b32 v204, 16, v178
  v_and_b32 v205, 0xffff0000, v178
  v_lshlrev_b32 v206, 16, v179
  v_and_b32 v207, 0xffff0000, v179
  v_lshlrev_b32 v208, 16, v180
  v_and_b32 v209, 0xffff0000, v180
  v_lshlrev_b32 v210, 16, v181
  v_and_b32 v211, 0xffff0000, v181
  v_lshlrev_b32 v212, 16, v182
  v_and_b32 v213, 0xffff0000, v182
  v_lshlrev_b32 v214, 16, v183
  v_and_b32 v215, 0xffff0000, v183
  v_lshlrev_b32 v216, 16, v184
  v_and_b32 v217, 0xffff0000, v184
  v_lshlrev_b32 v218, 16, v185
  v_and_b32 v219, 0xffff0000, v185
  v_mov_b32 v2, 159848
  s_mov_b32 s71, 1048576
Llw_107:
  ds_read_b32 v3, v2
  s_waitcnt lgkmcnt(0)
  v_cmp_gt_u32 vcc, 2, v3
  s_nop 0
  s_cbranch_vccz Llwok_108
  s_sub_u32 s71, s71, 1
  s_cbranch_scc1 Llwok_108
  s_branch Llw_107
Llwok_108:
  ds_read_b32 v220, v2 offset:40
  ds_read_b64_tr_b16 v[108:109], v198 offset:0
  ds_read_b64_tr_b16 v[110:111], v198 offset:2560
  ds_read_b64_tr_b16 v[112:113], v198 offset:8
  ds_read_b64_tr_b16 v[114:115], v198 offset:2568
  ds_read_b64_tr_b16 v[116:117], v198 offset:16
  ds_read_b64_tr_b16 v[118:119], v198 offset:2576
  ds_read_b64_tr_b16 v[120:121], v198 offset:24
  ds_read_b64_tr_b16 v[122:123], v198 offset:2584
  ds_read_b64_tr_b16 v[124:125], v198 offset:32
  ds_read_b64_tr_b16 v[126:127], v198 offset:2592
  ds_read_b64_tr_b16 v[128:129], v198 offset:5120
  ds_read_b64_tr_b16 v[130:131], v198 offset:7680
  ds_read_b64_tr_b16 v[132:133], v198 offset:5128
  ds_read_b64_tr_b16 v[134:135], v198 offset:7688
  v_lshrrev_b32 v9, 2, v0
  v_and_b32 v172, 3, v0
  v_lshlrev_b32 v172, 4, v172
  v_lshl_add_u32 v172, v9, 7, v172
  v_mov_b32 v9, 159880
  s_mov_b32 s67, 262144
  s_lshl_b32 s61, s44, 2
  s_add_u32 s61, s61, 159904
  v_mov_b32 v12, s61
  v_xor_b32 v13, 4, v12
  v_mov_b32 v14, 1
  s_waitcnt vmcnt(8)
  v_max_u32 v10, v28, v30
  v_max3_u32 v10, v32, v34, v10
  v_cmp_eq_u32 vcc, -1, v10
  s_nop 0
  s_cbranch_vccnz L_og0
L_ogr0:
  s_waitcnt lgkmcnt(10)
  v_mfma_f32_16x16x32_bf16 v[148:151], v[108:111], v[32:35], 0
  ds_read_b64_tr_b16 v[136:137], v198 offset:5136
  v_mfma_f32_16x16x32_bf16 v[200:203], v[108:111], v[28:31], v[200:203]
  ds_read_b64_tr_b16 v[138:139], v198 offset:7696
  s_waitcnt vmcnt(4)
  v_mfma_f32_16x16x32_bf16 v[152:155], v[112:115], v[32:35], 0
  ds_read_b64_tr_b16 v[140:141], v198 offset:5144
  v_mfma_f32_16x16x32_bf16 v[204:207], v[112:115], v[28:31], v[204:207]
  ds_read_b64_tr_b16 v[142:143], v198 offset:7704
  v_max_u32 v10, v36, v38
  v_max3_u32 v10, v40, v42, v10
  s_waitcnt lgkmcnt(10)
  v_mfma_f32_16x16x32_bf16 v[156:159], v[116:119], v[32:35], 0
  ds_read_b64_tr_b16 v[144:145], v198 offset:5152
  v_mfma_f32_16x16x32_bf16 v[208:211], v[116:119], v[28:31], v[208:211]
  ds_read_b64_tr_b16 v[146:147], v198 offset:7712
  v_max3_u32 v10, v44, v46, v10
  v_max3_u32 v10, v48, v50, v10
  v_mfma_f32_16x16x32_bf16 v[160:163], v[120:123], v[32:35], 0
  ds_read_b64_tr_b16 v[108:109], v198 offset:10240
  v_mfma_f32_16x16x32_bf16 v[212:215], v[120:123], v[28:31], v[212:215]
  ds_read_b64_tr_b16 v[110:111], v198 offset:12800
  v_cmp_eq_u32 vcc, -1, v10
  s_waitcnt lgkmcnt(10)
  v_mfma_f32_16x16x32_bf16 v[164:167], v[124:127], v[32:35], 0
  ds_read_b64_tr_b16 v[112:113], v198 offset:10248
  v_mfma_f32_16x16x32_bf16 v[216:219], v[124:127], v[28:31], v[216:219]
  ds_read_b64_tr_b16 v[114:115], v198 offset:12808
  s_cbranch_vccnz L_og1
L_ogr1:
  v_mfma_f32_16x16x32_bf16 v[148:151], v[128:131], v[40:43], v[148:151]
  ds_read_b64_tr_b16 v[116:117], v198 offset:10256
  v_mfma_f32_16x16x32_bf16 v[200:203], v[128:131], v[36:39], v[200:203]
  ds_read_b64_tr_b16 v[118:119], v198 offset:12816
  s_waitcnt lgkmcnt(10)
  v_mfma_f32_16x16x32_bf16 v[152:155], v[132:135], v[40:43], v[152:155]
  ds_read_b64_tr_b16 v[120:121], v198 offset:10264
  v_mfma_f32_16x16x32_bf16 v[204:207], v[132:135], v[36:39], v[204:207]
  ds_read_b64_tr_b16 v[122:123], v198 offset:12824
  buffer_load_dwordx4 v[68:71], v246, s[32:35], s59 offen offset:0 sc1
  v_mfma_f32_16x16x32_bf16 v[156:159], v[136:139], v[40:43], v[156:159]
  ds_read_b64_tr_b16 v[124:125], v198 offset:10272
  v_mfma_f32_16x16x32_bf16 v[208:211], v[136:139], v[36:39], v[208:211]
  ds_read_b64_tr_b16 v[126:127], v198 offset:12832
  buffer_load_dwordx4 v[72:75], v246, s[32:35], s60 offen offset:0 sc1
  s_waitcnt lgkmcnt(10)
  v_mfma_f32_16x16x32_bf16 v[160:163], v[140:143], v[40:43], v[160:163]
  ds_read_b64_tr_b16 v[128:129], v198 offset:15360
  v_mfma_f32_16x16x32_bf16 v[212:215], v[140:143], v[36:39], v[212:215]
  ds_read_b64_tr_b16 v[130:131], v198 offset:17920
  buffer_load_dwordx4 v[76:79], v246, s[32:35], s59 offen offset:1024 sc1
  v_mfma_f32_16x16x32_bf16 v[164:167], v[144:147], v[40:43], v[164:167]
  ds_read_b64_tr_b16 v[132:133], v198 offset:15368
  v_mfma_f32_16x16x32_bf16 v[216:219], v[144:147], v[36:39], v[216:219]
  ds_read_b64_tr_b16 v[134:135], v198 offset:17928
  buffer_load_dwordx4 v[80:83], v246, s[32:35], s60 offen offset:1024 sc1
  s_waitcnt lgkmcnt(10)
  v_mfma_f32_16x16x32_bf16 v[148:151], v[108:111], v[48:51], v[148:151]
  ds_read_b32 v8, v9
  ds_read_b64_tr_b16 v[136:137], v198 offset:15376
  v_mfma_f32_16x16x32_bf16 v[200:203], v[108:111], v[44:47], v[200:203]
  ds_read_b64_tr_b16 v[138:139], v198 offset:17936
  buffer_load_dwordx4 v[84:87], v246, s[32:35], s59 offen offset:2048 sc1
  s_waitcnt vmcnt(5)
  v_mfma_f32_16x16x32_bf16 v[152:155], v[112:115], v[48:51], v[152:155]
  ds_read_b64_tr_b16 v[140:141], v198 offset:15384
  v_mfma_f32_16x16x32_bf16 v[204:207], v[112:115], v[44:47], v[204:207]
  ds_read_b64_tr_b16 v[142:143], v198 offset:17944
  buffer_load_dwordx4 v[88:91], v246, s[32:35], s60 offen offset:2048 sc1
  v_max_u32 v10, v52, v54
  v_max3_u32 v10, v56, v58, v10
  s_waitcnt lgkmcnt(11)
  v_mfma_f32_16x16x32_bf16 v[156:159], v[116:119], v[48:51], v[156:159]
  ds_read_b64_tr_b16 v[144:145], v198 offset:15392
  v_mfma_f32_16x16x32_bf16 v[208:211], v[116:119], v[44:47], v[208:211]
  ds_read_b64_tr_b16 v[146:147], v198 offset:17952
  buffer_load_dwordx4 v[92:95], v246, s[32:35], s59 offen offset:3072 sc1
  v_max3_u32 v10, v60, v62, v10
  v_max3_u32 v10, v64, v66, v10
  v_mfma_f32_16x16x32_bf16 v[160:163], v[120:123], v[48:51], v[160:163]
  ds_read_b64_tr_b16 v[108:109], v198 offset:20480
  v_mfma_f32_16x16x32_bf16 v[212:215], v[120:123], v[44:47], v[212:215]
  ds_read_b64_tr_b16 v[110:111], v198 offset:23040
  buffer_load_dwordx4 v[96:99], v246, s[32:35], s60 offen offset:3072 sc1
  v_cmp_eq_u32 vcc, -1, v10
  s_waitcnt lgkmcnt(11)
  v_mfma_f32_16x16x32_bf16 v[164:167], v[124:127], v[48:51], v[164:167]
  ds_read_b64_tr_b16 v[112:113], v198 offset:20488
  v_mfma_f32_16x16x32_bf16 v[216:219], v[124:127], v[44:47], v[216:219]
  ds_read_b64_tr_b16 v[114:115], v198 offset:23048
  buffer_load_dwordx4 v[100:103], v221, s[32:35], s59 offen offset:0 sc1
  s_cbranch_vccnz L_og3
L_ogr3:
  v_mfma_f32_16x16x32_bf16 v[148:151], v[128:131], v[56:59], v[148:151]
  ds_read_b64_tr_b16 v[116:117], v198 offset:20496
  v_mfma_f32_16x16x32_bf16 v[200:203], v[128:131], v[52:55], v[200:203]
  ds_read_b64_tr_b16 v[118:119], v198 offset:23056
  buffer_load_dwordx4 v[104:107], v221, s[32:35], s60 offen offset:0 sc1
  s_mov_b64 exec, 1
  v_mov_b32 v6, 159816
  ds_add_u32 v6, v14
  s_mov_b64 exec, -1
  s_waitcnt lgkmcnt(11)
  v_mfma_f32_16x16x32_bf16 v[152:155], v[132:135], v[56:59], v[152:155]
  ds_read_b64_tr_b16 v[120:121], v198 offset:20504
  v_mfma_f32_16x16x32_bf16 v[204:207], v[132:135], v[52:55], v[204:207]
  ds_read_b64_tr_b16 v[122:123], v198 offset:23064
  v_mfma_f32_16x16x32_bf16 v[156:159], v[136:139], v[56:59], v[156:159]
  ds_read_b64_tr_b16 v[124:125], v198 offset:20512
  v_mfma_f32_16x16x32_bf16 v[208:211], v[136:139], v[52:55], v[208:211]
  ds_read_b64_tr_b16 v[126:127], v198 offset:23072
  s_waitcnt lgkmcnt(11)
  v_mfma_f32_16x16x32_bf16 v[160:163], v[140:143], v[56:59], v[160:163]
  v_cmp_gt_u32 vcc, 2, v8
  s_nop 0
  s_cbranch_vccnz L_wo2w
L_wo2r:
  ds_read_b64_tr_b16 v[128:129], v199 offset:0
  v_mfma_f32_16x16x32_bf16 v[212:215], v[140:143], v[52:55], v[212:215]
  ds_read_b64_tr_b16 v[130:131], v199 offset:2560
  v_mfma_f32_16x16x32_bf16 v[164:167], v[144:147], v[56:59], v[164:167]
  ds_read_b64_tr_b16 v[132:133], v199 offset:8
  v_mfma_f32_16x16x32_bf16 v[216:219], v[144:147], v[52:55], v[216:219]
  ds_read_b64_tr_b16 v[134:135], v199 offset:2568
  s_waitcnt lgkmcnt(11)
  v_mfma_f32_16x16x32_bf16 v[148:151], v[108:111], v[64:67], v[148:151]
  ds_read_b64_tr_b16 v[136:137], v199 offset:16
  v_mfma_f32_16x16x32_bf16 v[200:203], v[108:111], v[60:63], v[200:203]
  ds_read_b64_tr_b16 v[138:139], v199 offset:2576
  s_waitcnt vmcnt(6)
  v_mfma_f32_16x16x32_bf16 v[152:155], v[112:115], v[64:67], v[152:155]
  ds_read_b64_tr_b16 v[140:141], v199 offset:24
  v_mfma_f32_16x16x32_bf16 v[204:207], v[112:115], v[60:63], v[204:207]
  ds_read_b64_tr_b16 v[142:143], v199 offset:2584
  v_max_u32 v10, v68, v70
  v_max3_u32 v10, v72, v74, v10
  s_waitcnt lgkmcnt(10)
  v_mfma_f32_16x16x32_bf16 v[156:159], v[116:119], v[64:67], v[156:159]
  ds_read_b64_tr_b16 v[144:145], v199 offset:32
  v_mfma_f32_16x16x32_bf16 v[208:211], v[116:119], v[60:63], v[208:211]
  ds_read_b64_tr_b16 v[146:147], v199 offset:2592
  v_max3_u32 v10, v76, v78, v10
  v_max3_u32 v10, v80, v82, v10
  v_mfma_f32_16x16x32_bf16 v[160:163], v[120:123], v[64:67], v[160:163]
  ds_read_b64_tr_b16 v[108:109], v199 offset:5120
  v_mfma_f32_16x16x32_bf16 v[212:215], v[120:123], v[60:63], v[212:215]
  ds_read_b64_tr_b16 v[110:111], v199 offset:7680
  v_cmp_eq_u32 vcc, -1, v10
  s_waitcnt lgkmcnt(10)
  v_mfma_f32_16x16x32_bf16 v[164:167], v[124:127], v[64:67], v[164:167]
  ds_read_b64_tr_b16 v[112:113], v199 offset:5128
  v_mfma_f32_16x16x32_bf16 v[216:219], v[124:127], v[60:63], v[216:219]
  ds_read_b64_tr_b16 v[114:115], v199 offset:7688
  s_cbranch_vccnz L_og5
L_ogr5:
  s_mov_b64 exec, 1
  ds_add_u32 v9, v14 offset:16
  s_mov_b64 exec, -1
  v_mfma_f32_16x16x32_bf16 v[148:151], v[128:131], v[72:75], v[148:151]
  ds_read_b64_tr_b16 v[116:117], v199 offset:5136
  v_mfma_f32_16x16x32_bf16 v[200:203], v[128:131], v[68:71], v[200:203]
  ds_read_b64_tr_b16 v[118:119], v199 offset:7696
  s_waitcnt lgkmcnt(11)
  v_mfma_f32_16x16x32_bf16 v[152:155], v[132:135], v[72:75], v[152:155]
  ds_read_b64_tr_b16 v[120:121], v199 offset:5144
  v_mfma_f32_16x16x32_bf16 v[204:207], v[132:135], v[68:71], v[204:207]
  ds_read_b64_tr_b16 v[122:123], v199 offset:7704
  v_mfma_f32_16x16x32_bf16 v[156:159], v[136:139], v[72:75], v[156:159]
  ds_read_b64_tr_b16 v[124:125], v199 offset:5152
  v_mfma_f32_16x16x32_bf16 v[208:211], v[136:139], v[68:71], v[208:211]
  ds_read_b64_tr_b16 v[126:127], v199 offset:7712
  s_waitcnt lgkmcnt(11)
  v_mfma_f32_16x16x32_bf16 v[160:163], v[140:143], v[72:75], v[160:163]
  ds_read_b64_tr_b16 v[128:129], v199 offset:10240
  v_mfma_f32_16x16x32_bf16 v[212:215], v[140:143], v[68:71], v[212:215]
  ds_read_b64_tr_b16 v[130:131], v199 offset:12800
  v_mfma_f32_16x16x32_bf16 v[164:167], v[144:147], v[72:75], v[164:167]
  ds_read_b64_tr_b16 v[132:133], v199 offset:10248
  v_mfma_f32_16x16x32_bf16 v[216:219], v[144:147], v[68:71], v[216:219]
  ds_read_b64_tr_b16 v[134:135], v199 offset:12808
  s_waitcnt lgkmcnt(11)
  v_mfma_f32_16x16x32_bf16 v[148:151], v[108:111], v[80:83], v[148:151]
  ds_read_b64_tr_b16 v[136:137], v199 offset:10256
  v_mfma_f32_16x16x32_bf16 v[200:203], v[108:111], v[76:79], v[200:203]
  ds_read_b64_tr_b16 v[138:139], v199 offset:12816
  s_waitcnt vmcnt(0)
  v_mfma_f32_16x16x32_bf16 v[152:155], v[112:115], v[80:83], v[152:155]
  ds_read_b64_tr_b16 v[140:141], v199 offset:10264
  v_mfma_f32_16x16x32_bf16 v[204:207], v[112:115], v[76:79], v[204:207]
  ds_read_b64_tr_b16 v[142:143], v199 offset:12824
  v_max_u32 v10, v84, v86
  v_max3_u32 v10, v88, v90, v10
  v_max3_u32 v10, v92, v94, v10
  s_waitcnt lgkmcnt(10)
  v_mfma_f32_16x16x32_bf16 v[156:159], v[116:119], v[80:83], v[156:159]
  ds_read_b64_tr_b16 v[144:145], v199 offset:10272
  v_mfma_f32_16x16x32_bf16 v[208:211], v[116:119], v[76:79], v[208:211]
  ds_read_b64_tr_b16 v[146:147], v199 offset:12832
  v_max3_u32 v10, v96, v98, v10
  v_max3_u32 v10, v100, v102, v10
  v_max3_u32 v10, v104, v106, v10
  v_mfma_f32_16x16x32_bf16 v[160:163], v[120:123], v[80:83], v[160:163]
  ds_read_b64_tr_b16 v[108:109], v199 offset:15360
  v_mfma_f32_16x16x32_bf16 v[212:215], v[120:123], v[76:79], v[212:215]
  ds_read_b64_tr_b16 v[110:111], v199 offset:17920
  v_cmp_eq_u32 vcc, -1, v10
  s_waitcnt lgkmcnt(10)
  v_mfma_f32_16x16x32_bf16 v[164:167], v[124:127], v[80:83], v[164:167]
  ds_read_b64_tr_b16 v[112:113], v199 offset:15368
  v_mfma_f32_16x16x32_bf16 v[216:219], v[124:127], v[76:79], v[216:219]
  ds_read_b64_tr_b16 v[114:115], v199 offset:17928
  s_cbranch_vccnz L_og7
L_ogr7:
  v_mfma_f32_16x16x32_bf16 v[148:151], v[128:131], v[88:91], v[148:151]
  ds_read_b64_tr_b16 v[116:117], v199 offset:15376
  v_mfma_f32_16x16x32_bf16 v[200:203], v[128:131], v[84:87], v[200:203]
  ds_read_b64_tr_b16 v[118:119], v199 offset:17936
  s_waitcnt lgkmcnt(10)
  v_mfma_f32_16x16x32_bf16 v[152:155], v[132:135], v[88:91], v[152:155]
  ds_read_b64_tr_b16 v[120:121], v199 offset:15384
  v_mfma_f32_16x16x32_bf16 v[204:207], v[132:135], v[84:87], v[204:207]
  ds_read_b64_tr_b16 v[122:123], v199 offset:17944
  v_mfma_f32_16x16x32_bf16 v[156:159], v[136:139], v[88:91], v[156:159]
  ds_read_b32 v8, v9 offset:16
  ds_read_b64_tr_b16 v[124:125], v199 offset:15392
  v_mfma_f32_16x16x32_bf16 v[208:211], v[136:139], v[84:87], v[208:211]
  ds_read_b64_tr_b16 v[126:127], v199 offset:17952
  s_waitcnt lgkmcnt(11)
  v_mfma_f32_16x16x32_bf16 v[160:163], v[140:143], v[88:91], v[160:163]
  ds_read_b64_tr_b16 v[128:129], v199 offset:20480
  v_mfma_f32_16x16x32_bf16 v[212:215], v[140:143], v[84:87], v[212:215]
  ds_read_b64_tr_b16 v[130:131], v199 offset:23040
  v_mfma_f32_16x16x32_bf16 v[164:167], v[144:147], v[88:91], v[164:167]
  ds_read_b64_tr_b16 v[132:133], v199 offset:20488
  v_mfma_f32_16x16x32_bf16 v[216:219], v[144:147], v[84:87], v[216:219]
  ds_read_b64_tr_b16 v[134:135], v199 offset:23048
  s_waitcnt lgkmcnt(11)
  v_mfma_f32_16x16x32_bf16 v[148:151], v[108:111], v[96:99], v[148:151]
  ds_read_b64_tr_b16 v[136:137], v199 offset:20496
  v_mfma_f32_16x16x32_bf16 v[200:203], v[108:111], v[92:95], v[200:203]
  ds_read_b64_tr_b16 v[138:139], v199 offset:23056
  v_mfma_f32_16x16x32_bf16 v[152:155], v[112:115], v[96:99], v[152:155]
  ds_read_b64_tr_b16 v[140:141], v199 offset:20504
  v_mfma_f32_16x16x32_bf16 v[204:207], v[112:115], v[92:95], v[204:207]
  ds_read_b64_tr_b16 v[142:143], v199 offset:23064
  s_waitcnt lgkmcnt(11)
  v_mfma_f32_16x16x32_bf16 v[156:159], v[116:119], v[96:99], v[156:159]
  ds_read_b64_tr_b16 v[144:145], v199 offset:20512
  v_mfma_f32_16x16x32_bf16 v[208:211], v[116:119], v[92:95], v[208:211]
  ds_read_b64_tr_b16 v[146:147], v199 offset:23072
  v_mfma_f32_16x16x32_bf16 v[160:163], v[120:123], v[96:99], v[160:163]
  v_mfma_f32_16x16x32_bf16 v[212:215], v[120:123], v[92:95], v[212:215]
  s_waitcnt lgkmcnt(8)
  v_mfma_f32_16x16x32_bf16 v[164:167], v[124:127], v[96:99], v[164:167]
  v_mfma_f32_16x16x32_bf16 v[216:219], v[124:127], v[92:95], v[216:219]
  v_mfma_f32_16x16x32_bf16 v[148:151], v[128:131], v[104:107], v[148:151]
  v_cmp_gt_u32 vcc, 4, v8
  v_mov_b32 v2, 0x3f803f80
  s_cbranch_vccnz L_ldw
L_ldr:
  s_waitcnt lgkmcnt(6)
  v_mfma_f32_16x16x32_bf16 v[152:155], v[132:135], v[104:107], v[152:155]
  s_waitcnt lgkmcnt(4)
  v_mfma_f32_16x16x32_bf16 v[156:159], v[136:139], v[104:107], v[156:159]
  s_waitcnt lgkmcnt(2)
  v_mfma_f32_16x16x32_bf16 v[160:163], v[140:143], v[104:107], v[160:163]
  s_waitcnt lgkmcnt(0)
  v_mfma_f32_16x16x32_bf16 v[164:167], v[144:147], v[104:107], v[164:167]
  v_mov_b32 v4, 0
  v_mov_b32 v5, 0
  v_mov_b32 v6, 0
  v_xor_b32 v7, 1024, v222
  ds_write_b128 v222, v[148:151] offset:0
  v_mfma_f32_16x16x32_bf16 v[200:203], v[128:131], v[100:103], v[200:203]
  ds_write_b128 v222, v[152:155] offset:2048
  v_mfma_f32_16x16x32_bf16 v[204:207], v[132:135], v[100:103], v[204:207]
  ds_write_b128 v222, v[156:159] offset:4096
  v_mfma_f32_16x16x32_bf16 v[208:211], v[136:139], v[100:103], v[208:211]
  ds_write_b128 v222, v[160:163] offset:6144
  v_mfma_f32_16x16x32_bf16 v[212:215], v[140:143], v[100:103], v[212:215]
  ds_write_b128 v222, v[164:167] offset:8192
  v_mfma_f32_16x16x32_bf16 v[216:219], v[144:147], v[100:103], v[216:219]
  ds_write_b32 v12, v14
  s_mov_b32 s71, 1048576
Lxw_113:
  ds_read_b32 v8, v13
  ds_read_b128 v[28:31], v7 offset:0
  ds_read_b128 v[32:35], v7 offset:2048
  ds_read_b128 v[36:39], v7 offset:4096
  ds_read_b128 v[40:43], v7 offset:6144
  ds_read_b128 v[44:47], v7 offset:8192
  s_waitcnt lgkmcnt(5)
  v_cmp_eq_u32 vcc, 0, v8
  s_nop 0
  s_cbranch_vccz Lxok_114
  s_sub_u32 s71, s71, 1
  s_cbranch_scc1 Lxok_114
  s_waitcnt lgkmcnt(0)
  s_branch Lxw_113
Lxok_114:
  s_waitcnt lgkmcnt(4)
  v_pk_add_f32 v[200:201], v[200:201], v[28:29]
  v_pk_add_f32 v[202:203], v[202:203], v[30:31]
  s_waitcnt lgkmcnt(3)
  v_pk_add_f32 v[204:205], v[204:205], v[32:33]
  v_pk_add_f32 v[206:207], v[206:207], v[34:35]
  s_waitcnt lgkmcnt(2)
  v_pk_add_f32 v[208:209], v[208:209], v[36:37]
  v_pk_add_f32 v[210:211], v[210:211], v[38:39]
  s_waitcnt lgkmcnt(1)
  v_pk_add_f32 v[212:213], v[212:213], v[40:41]
  v_pk_add_f32 v[214:215], v[214:215], v[42:43]
  s_waitcnt lgkmcnt(0)
  v_pk_add_f32 v[216:217], v[216:217], v[44:45]
  v_pk_add_f32 v[218:219], v[218:219], v[46:47]
  v_cvt_pk_bf16_f32 v40, v200, v201
  v_cvt_pk_bf16_f32 v41, v202, v203
  v_cvt_pk_bf16_f32 v42, v204, v205
  v_cvt_pk_bf16_f32 v43, v206, v207
  v_cvt_pk_bf16_f32 v44, v208, v209
  v_cvt_pk_bf16_f32 v45, v210, v211
  v_cvt_pk_bf16_f32 v46, v212, v213
  v_cvt_pk_bf16_f32 v47, v214, v215
  v_cvt_pk_bf16_f32 v48, v216, v217
  v_cvt_pk_bf16_f32 v49, v218, v219
  v_dot2_f32_bf16 v4, v40, v2, v4
  v_dot2_f32_bf16 v6, v40, v40, v6
  v_dot2_f32_bf16 v5, v40, v186, v5
  v_dot2_f32_bf16 v4, v41, v2, v4
  v_dot2_f32_bf16 v6, v41, v41, v6
  v_dot2_f32_bf16 v5, v41, v187, v5
  v_dot2_f32_bf16 v4, v42, v2, v4
  v_dot2_f32_bf16 v6, v42, v42, v6
  v_dot2_f32_bf16 v5, v42, v188, v5
  v_dot2_f32_bf16 v4, v43, v2, v4
  v_dot2_f32_bf16 v6, v43, v43, v6
  v_dot2_f32_bf16 v5, v43, v189, v5
  v_dot2_f32_bf16 v4, v44, v2, v4
  v_dot2_f32_bf16 v6, v44, v44, v6
  v_dot2_f32_bf16 v5, v44, v190, v5
  v_dot2_f32_bf16 v4, v45, v2, v4
  v_dot2_f32_bf16 v6, v45, v45, v6
  v_dot2_f32_bf16 v5, v45, v191, v5
  v_dot2_f32_bf16 v4, v46, v2, v4
  v_dot2_f32_bf16 v6, v46, v46, v6
  v_dot2_f32_bf16 v5, v46, v192, v5
  v_dot2_f32_bf16 v4, v47, v2, v4
  v_dot2_f32_bf16 v6, v47, v47, v6
  v_dot2_f32_bf16 v5, v47, v193, v5
  v_dot2_f32_bf16 v4, v48, v2, v4
  v_dot2_f32_bf16 v6, v48, v48, v6
  v_dot2_f32_bf16 v5, v48, v194, v5
  v_dot2_f32_bf16 v4, v49, v2, v4
  v_dot2_f32_bf16 v6, v49, v49, v6
  v_dot2_f32_bf16 v5, v49, v195, v5
  s_lshl_b32 s61, s64, 4
  s_add_u32 s61, s61, s66
  v_mov_b32 v7, v6
  s_nop 0
  v_permlane32_swap_b32 v4, v5
  v_permlane32_swap_b32 v6, v7
  s_nop 0
  v_add_f32 v4, v4, v5
  v_add_f32 v6, v6, v7
  s_nop 1
  v_permlane16_swap_b32 v4, v6
  s_nop 0
  v_add_f32 v4, v4, v6
  v_add_f32 v6, v4, 0
  s_nop 1
  v_permlane16_swap_b32 v4, v6
  s_nop 0
  v_mov_b32 v5, v4
  s_nop 1
  v_permlane32_swap_b32 v4, v5
  v_mov_b32 v7, s53
  s_mov_b64 exec, 0xffff
  s_cmp_lg_u32 s51, 0
  s_cbranch_scc1 L_pssc
  buffer_store_dwordx4 v[4:7], v197, s[32:35], s61 offen
L_psr:
  s_mov_b64 exec, 1
  v_mov_b32 v12, 159840
  v_mov_b32 v13, 1
  ds_add_u32 v12, v13
  s_mov_b64 exec, -1
  buffer_load_dwordx4 v[12:15], v172, s[32:35], s66 offen sc1
  buffer_load_dwordx4 v[16:19], v172, s[32:35], s66 offen offset:64 sc1
  v_lshlrev_b32 v50, 16, v40
  v_and_b32 v51, 0xffff0000, v40
  v_lshlrev_b32 v52, 16, v41
  v_and_b32 v53, 0xffff0000, v41
  v_lshlrev_b32 v54, 16, v42
  v_and_b32 v55, 0xffff0000, v42
  v_lshlrev_b32 v56, 16, v43
  v_and_b32 v57, 0xffff0000, v43
  v_lshlrev_b32 v58, 16, v44
  v_and_b32 v59, 0xffff0000, v44
  v_lshlrev_b32 v60, 16, v45
  v_and_b32 v61, 0xffff0000, v45
  v_lshlrev_b32 v62, 16, v46
  v_and_b32 v63, 0xffff0000, v46
  v_lshlrev_b32 v64, 16, v47
  v_and_b32 v65, 0xffff0000, v47
  v_lshlrev_b32 v66, 16, v48
  v_and_b32 v67, 0xffff0000, v48
  v_lshlrev_b32 v68, 16, v49
  v_and_b32 v69, 0xffff0000, v49
  s_lshl_b32 s61, s55, 4
  s_sub_u32 s61, 2047, s61
  v_lshrrev_b32 v2, 2, v0
  v_sub_u32 v11, s61, v2
  v_lshlrev_b32 v11, 3, v11
  s_lshl_b32 s61, s44, 6
  s_add_u32 s61, s61, 159936
  v_lshl_add_u32 v223, v2, 2, s61
  v_and_b32 v2, 3, v0
  v_lshlrev_b32 v2, 6, v2
  v_add_u32 v10, 159936, v2
  v_and_b32 v2, 15, v0
  v_lshlrev_b32 v173, 4, v2
  s_mov_b32 s71, 262144
  s_branch Lpsm_117
.p2alignl 12, 0xbf810000
Lps_115:
  buffer_load_dwordx4 v[12:15], v172, s[32:35], s66 offen sc1
  buffer_load_dwordx4 v[16:19], v172, s[32:35], s66 offen offset:64 sc1
Lpsm_117:
  s_waitcnt vmcnt(0)
  v_cmp_ne_u32 vcc, s53, v15
  v_cmp_ne_u32 s[68:69], s53, v19
  v_pk_add_f32 v[6:7], v[12:13], v[16:17]
  v_add_f32 v8, v14, v18
  s_or_b64 vcc, vcc, s[68:69]
  s_cbranch_scc0 Lpsok_116
  s_sub_u32 s71, s71, 1
  s_cbranch_scc1 Lpsok_116
  s_branch Lps_115
Lpsok_116:
  s_mov_b64 exec, 1
  v_mov_b32 v12, 159884
  v_mov_b32 v13, 1
  ds_add_u32 v12, v13
  s_mov_b64 exec, -1
  v_add_f32_dpp v6, v6, v6 quad_perm:[1,0,3,2] row_mask:0xf bank_mask:0xf
  v_add_f32_dpp v7, v7, v7 quad_perm:[1,0,3,2] row_mask:0xf bank_mask:0xf
  v_add_f32_dpp v8, v8, v8 quad_perm:[1,0,3,2] row_mask:0xf bank_mask:0xf
  v_add_f32_dpp v6, v6, v6 quad_perm:[2,3,0,1] row_mask:0xf bank_mask:0xf
  v_add_f32_dpp v7, v7, v7 quad_perm:[2,3,0,1] row_mask:0xf bank_mask:0xf
  v_add_f32_dpp v8, v8, v8 quad_perm:[2,3,0,1] row_mask:0xf bank_mask:0xf
  v_mul_f32 v6, 0.0015625, v6
  v_mul_f32 v8, 0.0015625, v8
  v_fma_f32 v8, -v6, v6, v8
  v_max_f32 v8, 0, v8
  v_cvt_pk_bf16_f32 v8, v8, v8
  v_and_b32 v8, 0xffff0000, v8
  v_add_f32 v8, 0x3727c5ac, v8
  v_cvt_pk_bf16_f32 v8, v8, v8
  v_and_b32 v8, 0xffff0000, v8
  v_sqrt_f32 v8, v8
  v_cvt_pk_bf16_f32 v6, v6, v6
  v_and_b32 v6, 0xffff0000, v6
  v_cvt_pk_bf16_f32 v8, v8, v8
  v_and_b32 v8, 0xffff0000, v8
  v_rcp_f32 v4, v8
  v_fma_f32 v7, -v6, v220, v7
  v_mul_f32 v7, v7, v4
  v_cvt_pk_bf16_f32 v7, v7, v7
  v_mul_f32 v5, -v6, v4
  v_ashrrev_i32 v8, 31, v7
  v_or_b32 v8, 0x80000000, v8
  v_xor_b32 v7, v7, v8
  v_and_b32 v7, 0xffff0000, v7
  v_or_b32 v228, v7, v11
  ds_write_b32 v223, v228
  ds_bpermute_b32 v4, v173, v4
  ds_bpermute_b32 v5, v173, v5
  ds_read_b128 v[108:111], v10 offset:0
  ds_read_b128 v[112:115], v10 offset:16
  ds_read_b128 v[116:119], v10 offset:32
  ds_read_b128 v[120:123], v10 offset:48
  s_mov_b32 s71, 1048576
  s_waitcnt lgkmcnt(4)
  v_pk_fma_f32 v[200:201], v[50:51], v[4:5], v[4:5] op_sel:[0,0,1] op_sel_hi:[1,0,1]
  v_pk_fma_f32 v[202:203], v[52:53], v[4:5], v[4:5] op_sel:[0,0,1] op_sel_hi:[1,0,1]
  v_pk_fma_f32 v[204:205], v[54:55], v[4:5], v[4:5] op_sel:[0,0,1] op_sel_hi:[1,0,1]
  v_pk_fma_f32 v[206:207], v[56:57], v[4:5], v[4:5] op_sel:[0,0,1] op_sel_hi:[1,0,1]
  v_pk_fma_f32 v[208:209], v[58:59], v[4:5], v[4:5] op_sel:[0,0,1] op_sel_hi:[1,0,1]
  v_pk_fma_f32 v[210:211], v[60:61], v[4:5], v[4:5] op_sel:[0,0,1] op_sel_hi:[1,0,1]
  v_pk_fma_f32 v[212:213], v[62:63], v[4:5], v[4:5] op_sel:[0,0,1] op_sel_hi:[1,0,1]
  v_pk_fma_f32 v[214:215], v[64:65], v[4:5], v[4:5] op_sel:[0,0,1] op_sel_hi:[1,0,1]
  v_pk_fma_f32 v[216:217], v[66:67], v[4:5], v[4:5] op_sel:[0,0,1] op_sel_hi:[1,0,1]
  v_pk_fma_f32 v[218:219], v[68:69], v[4:5], v[4:5] op_sel:[0,0,1] op_sel_hi:[1,0,1]
  s_branch Lkym_120
Lky_118:
  ds_read_b128 v[108:111], v10 offset:0
  ds_read_b128 v[112:115], v10 offset:16
  ds_read_b128 v[116:119], v10 offset:32
  ds_read_b128 v[120:123], v10 offset:48
Lkym_120:
  s_waitcnt lgkmcnt(0)
  v_max3_u32 v2, v108, v109, v110
  v_max3_u32 v2, v111, v112, v2
  v_max3_u32 v2, v113, v114, v2
  v_max3_u32 v2, v115, v116, v2
  v_max3_u32 v2, v117, v118, v2
  v_max3_u32 v2, v119, v120, v2
  v_max3_u32 v2, v121, v122, v2
  v_max_u32 v2, v2, v123
  v_cmp_eq_u32 vcc, -1, v2
  v_mov_b32 v2, 0
  s_cbranch_vccz Lkyok_119
  s_sub_u32 s71, s71, 1
  s_cbranch_scc1 Lkyok_119
  s_branch Lky_118
Lkyok_119:
  v_cmp_gt_u32 s[68:69], v108, v228
  v_cmp_gt_u32 s[70:71], v109, v228
  v_cmp_gt_u32 s[72:73], v110, v228
  v_addc_co_u32 v2, vcc, 0, v2, s[68:69]
  v_cmp_gt_u32 s[68:69], v111, v228
  v_addc_co_u32 v2, vcc, 0, v2, s[70:71]
  v_cmp_gt_u32 s[70:71], v112, v228
  v_addc_co_u32 v2, vcc, 0, v2, s[72:73]
  v_cmp_gt_u32 s[72:73], v113, v228
  v_addc_co_u32 v2, vcc, 0, v2, s[68:69]
  v_cmp_gt_u32 s[68:69], v114, v228
  v_addc_co_u32 v2, vcc, 0, v2, s[70:71]
  v_cmp_gt_u32 s[70:71], v115, v228
  v_addc_co_u32 v2, vcc, 0, v2, s[72:73]
  v_cmp_gt_u32 s[72:73], v116, v228
  v_addc_co_u32 v2, vcc, 0, v2, s[68:69]
  v_cmp_gt_u32 s[68:69], v117, v228
  v_addc_co_u32 v2, vcc, 0, v2, s[70:71]
  v_cmp_gt_u32 s[70:71], v118, v228
  v_addc_co_u32 v2, vcc, 0, v2, s[72:73]
  v_cmp_gt_u32 s[72:73], v119, v228
  v_addc_co_u32 v2, vcc, 0, v2, s[68:69]
  v_cmp_gt_u32 s[68:69], v120, v228
  v_addc_co_u32 v2, vcc, 0, v2, s[70:71]
  v_cmp_gt_u32 s[70:71], v121, v228
  v_addc_co_u32 v2, vcc, 0, v2, s[72:73]
  v_cmp_gt_u32 s[72:73], v122, v228
  v_addc_co_u32 v2, vcc, 0, v2, s[68:69]
  v_cmp_gt_u32 s[68:69], v123, v228
  v_addc_co_u32 v2, vcc, 0, v2, s[70:71]
  s_nop 0
  v_addc_co_u32 v2, vcc, 0, v2, s[72:73]
  v_addc_co_u32 v2, vcc, 0, v2, s[68:69]
  v_cvt_pk_bf16_f32 v70, v200, v201
  v_cvt_pk_bf16_f32 v71, v202, v203
  v_add_u32_dpp v2, v2, v2 quad_perm:[1,0,3,2] row_mask:0xf bank_mask:0xf
  v_cvt_pk_bf16_f32 v72, v204, v205
  v_cvt_pk_bf16_f32 v73, v206, v207
  v_add_u32_dpp v2, v2, v2 quad_perm:[2,3,0,1] row_mask:0xf bank_mask:0xf
  v_cmp_gt_u32 s[74:75], 8, v2
  v_or_b32 v228, v228, v2
  v_mov_b32 v3, 131072
  v_lshl_add_u32 v3, v2, 3, v3
  v_mov_b32 v229, s53
  s_cmp_lg_u32 s64, 0
  s_cbranch_scc1 L_noca
  s_and_b32 exec_lo, s74, 0x11111111
  s_and_b32 exec_hi, s75, 0x11111111
  ds_write_b64 v3, v[228:229] offset:29120
  s_mov_b64 exec, 0xff
  s_cmp_lg_u32 s44, 0
  s_cbranch_scc1 L_cab
  v_lshlrev_b32 v4, 3, v0
  v_add_u32 v5, 160192, v4
  s_lshl_b32 s61, s63, 7
  s_add_u32 s61, s61, 16646144
  s_mov_b32 s71, 1048576
L_cal:
  ds_read_b64 v[6:7], v5
  s_waitcnt lgkmcnt(0)
  v_cmp_ne_u32 vcc, s53, v7
  s_nop 0
  s_cbranch_vccz L_caok
  s_sub_u32 s71, s71, 1
  s_cbranch_scc1 L_caok
  s_branch L_cal
L_caok:
  buffer_store_dwordx2 v[6:7], v4, s[32:35], s61 offen sc1
L_cab:
  s_barrier
L_noca:
  s_mov_b64 exec, -1
  ds_bpermute_b32 v2, v173, v2
  ds_bpermute_b32 v228, v173, v228
  v_cvt_pk_bf16_f32 v74, v208, v209
  v_cvt_pk_bf16_f32 v75, v210, v211
  v_cvt_pk_bf16_f32 v76, v212, v213
  v_cvt_pk_bf16_f32 v77, v214, v215
  v_cvt_pk_bf16_f32 v78, v216, v217
  v_cvt_pk_bf16_f32 v79, v218, v219
  v_lshrrev_b32 v3, 4, v0
  v_mul_u32_u24 v3, 40, v3
  s_waitcnt lgkmcnt(0)
  v_cmp_gt_u32 s[74:75], 8, v2
  v_mul_u32_u24 v2, 2560, v2
  v_add_u32 v224, v2, v3
  s_mul_i32 s61, s63, 20480
  s_mul_i32 s62, s64, 160
  s_add_u32 s61, s61, s62
  s_add_u32 s61, s61, 15728640
  s_and_b64 exec, s[74:75], -1
  s_cbranch_scc0 L_nocd
  buffer_store_dwordx4 v[70:73], v224, s[32:35], s61 offen offset:0 sc1
  buffer_store_dwordx4 v[74:77], v224, s[32:35], s61 offen offset:16 sc1
  buffer_store_dwordx2 v[78:79], v224, s[32:35], s61 offen offset:32 sc1
  buffer_store_dwordx4 v[40:43], v224, s[32:35], s61 offen offset:1280 sc1
  buffer_store_dwordx4 v[44:47], v224, s[32:35], s61 offen offset:1296 sc1
  buffer_store_dwordx2 v[48:49], v224, s[32:35], s61 offen offset:1312 sc1
L_nocd:
  s_mov_b64 exec, -1
  v_pk_add_f32 v[200:201], v[200:201], v[50:51]
  v_pk_add_f32 v[202:203], v[202:203], v[52:53]
  v_pk_add_f32 v[204:205], v[204:205], v[54:55]
  v_pk_add_f32 v[206:207], v[206:207], v[56:57]
  v_pk_add_f32 v[208:209], v[208:209], v[58:59]
  v_pk_add_f32 v[210:211], v[210:211], v[60:61]
  v_pk_add_f32 v[212:213], v[212:213], v[62:63]
  v_pk_add_f32 v[214:215], v[214:215], v[64:65]
  v_pk_add_f32 v[216:217], v[216:217], v[66:67]
  v_pk_add_f32 v[218:219], v[218:219], v[68:69]
  v_cvt_pk_bf16_f32 v80, v200, v201
  v_cvt_pk_bf16_f32 v81, v202, v203
  v_cvt_pk_bf16_f32 v82, v204, v205
  v_cvt_pk_bf16_f32 v83, v206, v207
  v_cvt_pk_bf16_f32 v84, v208, v209
  v_cvt_pk_bf16_f32 v85, v210, v211
  v_cvt_pk_bf16_f32 v86, v212, v213
  v_cvt_pk_bf16_f32 v87, v214, v215
  v_cvt_pk_bf16_f32 v88, v216, v217
  v_cvt_pk_bf16_f32 v89, v218, v219
  s_andn2_b64 exec, -1, s[74:75]
  s_cbranch_scc0 L_noo1
  buffer_store_dwordx4 v[80:83], v196, s[28:31], s16 offen offset:0
  buffer_store_dwordx4 v[84:87], v196, s[28:31], s16 offen offset:16
  buffer_store_dwordx2 v[88:89], v196, s[28:31], s16 offen offset:32
L_noo1:
  s_mov_b64 exec, 1
  v_mov_b32 v6, 159852
  v_mov_b32 v7, 1
  ds_add_u32 v6, v7
  s_mov_b64 exec, -1
  s_cmp_ge_u32 s39, 17
  s_cbranch_scc1 L_plain
  v_lshrrev_b32 v2, 3, v0
  v_and_b32 v3, 7, v0
  v_lshlrev_b32 v3, 3, v3
  v_lshl_add_u32 v22, v2, 7, v3
  s_mov_b32 s62, 16646144
  s_cmp_lg_u32 s44, 0
  s_cbranch_scc1 L_nocal
  buffer_load_dwordx2 v[12:13], v22, s[32:35], s62 offen offset:0 sc1
  buffer_load_dwordx2 v[14:15], v22, s[32:35], s62 offen offset:1024 sc1
  buffer_load_dwordx2 v[16:17], v22, s[32:35], s62 offen offset:2048 sc1
  buffer_load_dwordx2 v[18:19], v22, s[32:35], s62 offen offset:3072 sc1
L_nocal:
  v_bfe_i32 v20, v0, 1, 1
  v_bfe_i32 v21, v0, 0, 1
  v_not_b32 v20, v20
  v_not_b32 v21, v21
  s_add_u32 s57, s44, 0
  s_and_b32 s57, s57, 3
  s_lshl_b32 s61, s57, 2
  s_add_u32 s61, s61, 159856
  v_mov_b32 v104, s61
  s_mul_i32 s61, s57, 12288
  v_lshl_add_u32 v103, v0, 3, s61
  v_and_b32 v2, 7, v0
  v_lshlrev_b32 v2, 2, v2
  v_add_u32 v102, 160256, v2
  v_add_u32 v99, 160256, v2
  s_cmp_ge_u32 s39, 12
  s_cbranch_scc1 L_now
  v_lshrrev_b32 v2, 3, v0
  v_lshlrev_b32 v2, 2, v2
  v_add_u32 v99, 160256, v2
  v_and_b32 v101, 7, v0
  v_lshrrev_b32 v2, 4, v0
  v_lshlrev_b32 v2, 4, v2
  v_lshl_add_u32 v2, v101, 7, v2
  s_mul_i32 s61, s44, 3072
  s_add_u32 s61, s61, 63488
  v_add_u32 v100, s61, v2
  v_lshlrev_b32 v101, 4, v101
  s_mov_b32 m0, s61
  s_mov_b32 s71, 1048576
Llw_121:
  ds_read_b32 v108, v104
  s_waitcnt lgkmcnt(0)
  v_cmp_eq_u32 vcc, 0, v108
  s_nop 0
  s_cbranch_vccz Llwok_122
  s_sub_u32 s71, s71, 1
  s_cbranch_scc1 Llwok_122
  s_branch Llw_121
Llwok_122:
  ds_read_b64_tr_b16 v[108:109], v103 offset:0
  ds_read_b64_tr_b16 v[110:111], v103 offset:512
  ds_read_b64_tr_b16 v[112:113], v103 offset:1024
  ds_read_b64_tr_b16 v[114:115], v103 offset:1536
  ds_read_b64_tr_b16 v[116:117], v103 offset:2048
  ds_read_b64_tr_b16 v[118:119], v103 offset:2560
  ds_read_b64_tr_b16 v[120:121], v103 offset:3072
  ds_read_b64_tr_b16 v[122:123], v103 offset:3584
  ds_read_b64_tr_b16 v[124:125], v103 offset:4096
  ds_read_b64_tr_b16 v[126:127], v103 offset:4608
  ds_read_b64_tr_b16 v[128:129], v103 offset:5120
  ds_read_b64_tr_b16 v[130:131], v103 offset:5632
  ds_read_b64_tr_b16 v[132:133], v103 offset:6144
  ds_read_b64_tr_b16 v[134:135], v103 offset:6656
  ds_read_b64_tr_b16 v[136:137], v103 offset:7168
  ds_read_b64_tr_b16 v[138:139], v103 offset:7680
  ds_read_b64_tr_b16 v[140:141], v103 offset:8192
  ds_read_b64_tr_b16 v[142:143], v103 offset:8704
  ds_read_b64_tr_b16 v[144:145], v103 offset:9216
  ds_read_b64_tr_b16 v[146:147], v103 offset:9728
  ds_read_b64_tr_b16 v[148:149], v103 offset:10240
  ds_read_b64_tr_b16 v[150:151], v103 offset:10752
  ds_read_b64_tr_b16 v[152:153], v103 offset:11264
  ds_read_b64_tr_b16 v[154:155], v103 offset:11776
L_now:
  s_cmp_lg_u32 s44, 0
  s_cbranch_scc1 L_topw
  s_mov_b32 s71, 262144
  s_branch Lcam_125
Lca_123:
  buffer_load_dwordx2 v[12:13], v22, s[32:35], s62 offen offset:0 sc1
  buffer_load_dwordx2 v[14:15], v22, s[32:35], s62 offen offset:1024 sc1
  buffer_load_dwordx2 v[16:17], v22, s[32:35], s62 offen offset:2048 sc1
  buffer_load_dwordx2 v[18:19], v22, s[32:35], s62 offen offset:3072 sc1
Lcam_125:
  s_waitcnt vmcnt(0)
  v_xor_b32 v2, v13, v15
  v_xor_b32 v3, v17, v19
  v_xor_b32 v13, s53, v13
  v_xor_b32 v17, s53, v17
  v_or3_b32 v2, v2, v3, v13
  v_or_b32 v2, v2, v17
  v_cmp_ne_u32 vcc, 0, v2
  s_nop 0
  s_cbranch_vccz Lcaok_124
  s_sub_u32 s71, s71, 1
  s_cbranch_scc1 Lcaok_124
  s_branch Lca_123
Lcaok_124:
  v_max_u32_dpp v12, v14, v12 row_half_mirror row_mask:0xf bank_mask:0xf
  v_max_u32_dpp v16, v18, v16 row_half_mirror row_mask:0xf bank_mask:0xf
  s_nop 0
  v_max_u32_dpp v2, v12, v12 row_shl:4 row_mask:0xf bank_mask:0x5
  v_max_u32_dpp v3, v16, v16 row_shl:4 row_mask:0xf bank_mask:0x5
  s_nop 0
  v_min_u32_dpp v2, v12, v12 row_shr:4 row_mask:0xf bank_mask:0xa
  v_min_u32_dpp v3, v16, v16 row_shr:4 row_mask:0xf bank_mask:0xa
  s_nop 0
  v_mov_b32_dpp v4, v2 quad_perm:[2,3,0,1] row_mask:0xf bank_mask:0xf
  v_mov_b32_dpp v5, v3 quad_perm:[2,3,0,1] row_mask:0xf bank_mask:0xf
  v_med3_u32 v2, v2, v4, v20
  v_med3_u32 v3, v3, v5, v20
  s_nop 0
  v_mov_b32_dpp v4, v2 quad_perm:[1,0,3,2] row_mask:0xf bank_mask:0xf
  v_mov_b32_dpp v5, v3 quad_perm:[1,0,3,2] row_mask:0xf bank_mask:0xf
  v_med3_u32 v12, v2, v4, v21
  v_med3_u32 v16, v3, v5, v21
  s_nop 1
  v_max_u32_dpp v12, v16, v12 row_half_mirror row_mask:0xf bank_mask:0xf
  s_nop 1
  v_max_u32_dpp v2, v12, v12 row_shl:4 row_mask:0xf bank_mask:0x5
  s_nop 1
  v_min_u32_dpp v2, v12, v12 row_shr:4 row_mask:0xf bank_mask:0xa
  s_nop 1
  v_mov_b32_dpp v4, v2 quad_perm:[2,3,0,1] row_mask:0xf bank_mask:0xf
  v_med3_u32 v2, v2, v4, v20
  s_nop 1
  v_mov_b32_dpp v4, v2 quad_perm:[1,0,3,2] row_mask:0xf bank_mask:0xf
  v_med3_u32 v12, v2, v4, v21
  s_nop 1
  v_max_u32_dpp v12, v12, v12 row_mirror row_mask:0xf bank_mask:0xf
  s_nop 1
  v_max_u32_dpp v2, v12, v12 row_shl:4 row_mask:0xf bank_mask:0x5
  s_nop 1
  v_min_u32_dpp v2, v12, v12 row_shr:4 row_mask:0xf bank_mask:0xa
  s_nop 1
  v_mov_b32_dpp v4, v2 quad_perm:[2,3,0,1] row_mask:0xf bank_mask:0xf
  v_med3_u32 v2, v2, v4, v20
  s_nop 1
  v_mov_b32_dpp v4, v2 quad_perm:[1,0,3,2] row_mask:0xf bank_mask:0xf
  v_med3_u32 v12, v2, v4, v21
  s_nop 1
  v_mov_b32_dpp v12, v12 row_half_mirror row_mask:0xa bank_mask:0xf
  v_mov_b32 v4, v12
  s_nop 1
  v_permlane16_swap_b32 v12, v4
  s_nop 0
  v_max_u32 v12, v12, v4
  s_nop 1
  v_max_u32_dpp v2, v12, v12 row_shl:4 row_mask:0xf bank_mask:0x5
  s_nop 1
  v_min_u32_dpp v2, v12, v12 row_shr:4 row_mask:0xf bank_mask:0xa
  s_nop 1
  v_mov_b32_dpp v4, v2 quad_perm:[2,3,0,1] row_mask:0xf bank_mask:0xf
  v_med3_u32 v2, v2, v4, v20
  s_nop 1
  v_mov_b32_dpp v4, v2 quad_perm:[1,0,3,2] row_mask:0xf bank_mask:0xf
  v_med3_u32 v12, v2, v4, v21
  s_nop 1
  v_mov_b32_dpp v12, v12 row_half_mirror row_mask:0xc bank_mask:0xf
  v_mov_b32 v4, v12
  s_nop 1
  v_permlane32_swap_b32 v12, v4
  s_nop 0
  v_max_u32 v12, v12, v4
  s_nop 1
  v_max_u32_dpp v2, v12, v12 row_shl:4 row_mask:0xf bank_mask:0x5
  s_nop 1
  v_min_u32_dpp v2, v12, v12 row_shr:4 row_mask:0xf bank_mask:0xa
  s_nop 1
  v_mov_b32_dpp v4, v2 quad_perm:[2,3,0,1] row_mask:0xf bank_mask:0xf
  v_med3_u32 v2, v2, v4, v20
  s_nop 1
  v_mov_b32_dpp v4, v2 quad_perm:[1,0,3,2] row_mask:0xf bank_mask:0xf
  v_med3_u32 v12, v2, v4, v21
  ds_write_b32 v102, v12
  s_cmp_ge_u32 s39, 12
  s_cbranch_scc1 L_top
L_topw:
  s_waitcnt vmcnt(0)
  s_mov_b32 s71, 1048576
Llw_126:
  ds_read_b32 v12, v99
  s_waitcnt lgkmcnt(0)
  v_cmp_eq_u32 vcc, -1, v12
  s_nop 0
  s_cbranch_vccz Llwok_127
  s_sub_u32 s71, s71, 1
  s_cbranch_scc1 Llwok_127
  s_branch Llw_126
Llwok_127:
  s_cmp_ge_u32 s39, 12
  s_cbranch_scc1 L_top
  v_bfe_u32 v3, v12, 9, 5
  v_and_b32 v4, 7, v12
  v_xor_b32 v3, 31, v3
  s_mul_i32 s61, s57, 320
  v_lshl_add_u32 v4, v3, 3, v4
  s_add_u32 s61, s61, 15728640
  v_mov_b32 v2, 2560
  s_sub_u32 s62, s61, 896
  v_mad_u32_u24 v4, v4, v2, v101
  s_sub_u32 s58, s61, 1792
  s_mov_b32 s71, 262144
Lgl_128:
  s_mov_b64 exec, -1
  buffer_load_dwordx4 v4, s[32:35], s61 offen sc1 lds
  buffer_load_dwordx4 v4, s[32:35], s62 offen offset:1024 sc1 lds
  s_mov_b32 exec_lo, 0x0f0f0f0f
  s_mov_b32 exec_hi, 0x0f0f0f0f
  buffer_load_dwordx4 v4, s[32:35], s58 offen offset:2048 sc1 lds
  s_mov_b64 exec, -1
  v_readlane_b32 s68, v12, 56
  s_lshl_b32 s59, s44, 11
  s_add_u32 s59, s59, 55296
  v_lshl_add_u32 v5, v0, 4, s59
  s_mov_b32 exec_lo, 0x00ff00ff
  s_mov_b32 exec_hi, 0x00ff00ff
  s_waitcnt vmcnt(2)
  ds_read_b128 v[160:163], v100 offset:0
  ds_read_b128 v[164:167], v100 offset:64
  s_waitcnt vmcnt(1)
  ds_read_b128 v[168:171], v100 offset:1024
  ds_read_b128 v[172:175], v100 offset:1088
  s_waitcnt vmcnt(0)
  ds_read_b128 v[176:179], v100 offset:2048
  s_mov_b64 exec, -1
  s_waitcnt lgkmcnt(4)
  v_mfma_f32_16x16x32_bf16 v[20:23], v[108:111], v[160:163], 0
  v_max3_u32 v6, v160, v162, 0
  v_mfma_f32_16x16x32_bf16 v[24:27], v[112:115], v[160:163], 0
  s_waitcnt lgkmcnt(3)
  v_mfma_f32_16x16x32_bf16 v[20:23], v[116:119], v[164:167], v[20:23]
  v_max3_u32 v6, v164, v166, v6
  v_mfma_f32_16x16x32_bf16 v[24:27], v[120:123], v[164:167], v[24:27]
  s_waitcnt lgkmcnt(2)
  v_mfma_f32_16x16x32_bf16 v[20:23], v[124:127], v[168:171], v[20:23]
  v_max3_u32 v6, v168, v170, v6
  v_mfma_f32_16x16x32_bf16 v[24:27], v[128:131], v[168:171], v[24:27]
  s_waitcnt lgkmcnt(1)
  v_mfma_f32_16x16x32_bf16 v[20:23], v[132:135], v[172:175], v[20:23]
  v_max3_u32 v6, v172, v174, v6
  v_mfma_f32_16x16x32_bf16 v[24:27], v[136:139], v[172:175], v[24:27]
  s_waitcnt lgkmcnt(0)
  v_mfma_f32_16x16x32_bf16 v[20:23], v[140:143], v[176:179], v[20:23]
  v_max3_u32 v6, v176, v178, v6
  v_mfma_f32_16x16x32_bf16 v[24:27], v[144:147], v[176:179], v[24:27]
  v_cmp_eq_u32 vcc, -1, v6
  s_nop 0
  s_and_b32 vcc_lo, vcc_lo, 0x00ff00ff
  s_and_b32 vcc_hi, vcc_hi, 0x00ff00ff
  s_or_b32 s59, vcc_lo, vcc_hi
  s_cbranch_scc0 L_glok
  s_sub_u32 s71, s71, 1
  s_cbranch_scc1 L_glok
  s_branch Lgl_128
L_top:
  v_bfe_u32 v3, v12, 3, 11
  v_sub_u32 v3, 2047, v3
  v_lshrrev_b32 v2, 6, v3
  v_and_b32 v4, 7, v12
  v_lshl_add_u32 v4, v2, 3, v4
  v_mul_u32_u24 v4, 2560, v4
  v_lshrrev_b32 v2, 4, v0
  v_readlane_b32 s68, v12, 7
  s_branch L_down
L_glok:
  s_cmp_eq_u32 s44, 0
  s_cbranch_scc1 Lguw0_130
  ds_write_b128 v5, v[20:23]
  ds_write_b128 v5, v[24:27] offset:1024
  s_waitcnt lgkmcnt(0)
  s_barrier
  s_xor_b32 s62, s44, 1
  s_or_b32 s62, s39, s62
  s_cbranch_scc1 Lnoth_131
  v_mov_b32 v6, s68
  v_mov_b32 v7, s53
  s_lshl_b32 s62, s45, 7
  s_add_u32 s62, s62, 19410944
  v_mov_b32 v8, 0
  s_mov_b64 exec, 1
  buffer_store_dwordx2 v[6:7], v8, s[32:35], s62 offen sc1
  s_mov_b64 exec, -1
Lnoth_131:
  v_cmp_gt_u32 vcc, s68, v228
  s_nop 0
  s_and_b64 exec, vcc, s[74:75]
  s_cbranch_scc0 L_ndg1
  buffer_store_dwordx4 v[80:83], v196, s[28:31], s16 offen offset:0
  buffer_store_dwordx4 v[84:87], v196, s[28:31], s16 offen offset:16
  buffer_store_dwordx2 v[88:89], v196, s[28:31], s16 offen offset:32
L_ndg1:
  s_mov_b64 exec, -1
  s_endpgm
Lguw0_130:
  s_mul_i32 s61, s45, 12
  s_add_u32 s61, s61, s39
  s_lshl_b32 s61, s61, 8
  s_add_u32 s61, s61, 16650240
  v_and_b32 v6, 7, v0
  v_lshlrev_b32 v6, 4, v6
  v_lshrrev_b32 v7, 5, v0
  v_lshl_add_u32 v6, v7, 7, v6
  v_bfe_u32 v7, v0, 4, 1
  v_lshl_add_u32 v6, v7, 3, v6
  s_barrier
  ds_read_b128 v[28:31], v5 offset:2048
  ds_read_b128 v[32:35], v5 offset:3072
  ds_read_b128 v[36:39], v5 offset:4096
  ds_read_b128 v[40:43], v5 offset:5120
  ds_read_b128 v[44:47], v5 offset:6144
  ds_read_b128 v[48:51], v5 offset:7168
  s_mov_b32 s62, 0xbfb8aa3b
  s_waitcnt lgkmcnt(4)
  v_pk_add_f32 v[20:21], v[20:21], v[28:29]
  v_pk_add_f32 v[22:23], v[22:23], v[30:31]
  v_pk_add_f32 v[24:25], v[24:25], v[32:33]
  v_pk_add_f32 v[26:27], v[26:27], v[34:35]
  s_waitcnt lgkmcnt(2)
  v_pk_add_f32 v[20:21], v[20:21], v[36:37]
  v_pk_add_f32 v[22:23], v[22:23], v[38:39]
  v_pk_add_f32 v[24:25], v[24:25], v[40:41]
  v_pk_add_f32 v[26:27], v[26:27], v[42:43]
  s_waitcnt lgkmcnt(0)
  v_pk_add_f32 v[20:21], v[20:21], v[44:45]
  v_pk_add_f32 v[22:23], v[22:23], v[46:47]
  v_pk_add_f32 v[24:25], v[24:25], v[48:49]
  v_pk_add_f32 v[26:27], v[26:27], v[50:51]
  v_cvt_pk_bf16_f32 v28, v20, v21
  v_cvt_pk_bf16_f32 v29, v22, v23
  v_cvt_pk_bf16_f32 v30, v24, v25
  v_cvt_pk_bf16_f32 v31, v26, v27
  v_lshlrev_b32 v20, 16, v28
  v_and_b32 v21, 0xffff0000, v28
  v_lshlrev_b32 v22, 16, v29
  v_and_b32 v23, 0xffff0000, v29
  v_lshlrev_b32 v24, 16, v30
  v_and_b32 v25, 0xffff0000, v30
  v_lshlrev_b32 v26, 16, v31
  v_and_b32 v27, 0xffff0000, v31
  v_mul_f32 v28, s62, v20
  v_mul_f32 v29, s62, v21
  v_mul_f32 v30, s62, v22
  v_mul_f32 v31, s62, v23
  v_exp_f32 v28, v28
  v_exp_f32 v29, v29
  v_exp_f32 v30, v30
  v_exp_f32 v31, v31
  v_add_f32 v28, 1.0, v28
  v_add_f32 v29, 1.0, v29
  v_add_f32 v30, 1.0, v30
  v_add_f32 v31, 1.0, v31
  v_rcp_f32 v28, v28
  v_rcp_f32 v29, v29
  v_rcp_f32 v30, v30
  v_rcp_f32 v31, v31
  v_mul_f32 v20, v20, v28
  v_mul_f32 v21, v21, v29
  v_mul_f32 v22, v22, v30
  v_mul_f32 v23, v23, v31
  v_cvt_pk_bf16_f32 v28, v20, v21
  v_cvt_pk_bf16_f32 v29, v22, v23
  v_lshlrev_b32 v20, 16, v28
  v_and_b32 v21, 0xffff0000, v28
  v_lshlrev_b32 v22, 16, v29
  v_and_b32 v23, 0xffff0000, v29
  v_pk_mul_f32 v[20:21], v[20:21], v[24:25]
  v_pk_mul_f32 v[22:23], v[22:23], v[26:27]
  v_cvt_pk_bf16_f32 v28, v20, v21
  v_cvt_pk_bf16_f32 v29, v22, v23
  s_mov_b32 exec_lo, 0x00ff00ff
  s_mov_b32 exec_hi, 0x00ff00ff
  buffer_store_dwordx2 v[28:29], v6, s[32:35], s61 offen sc1
  s_lshl_b32 s61, s45, 5
  s_add_u32 s61, s61, s39
  s_lshl_b32 s61, s61, 2
  s_add_u32 s61, s61, 19415040
  v_mov_b32 v6, 0
  v_mov_b32 v7, s53
  s_mov_b64 exec, 1
  s_cmp_lg_u32 s51, 0
  s_cbranch_scc1 Lslow_132
  buffer_store_dword v7, v6, s[32:35], s61 offen
  s_branch Ljn_133
Lslow_132:
  buffer_store_dword v7, v6, s[32:35], s61 offen sc1
Ljn_133:
  s_mov_b64 exec, -1
  v_cmp_gt_u32 vcc, s68, v228
  s_nop 0
  s_and_b64 exec, vcc, s[74:75]
  s_cbranch_scc0 L_ndg0
  buffer_store_dwordx4 v[80:83], v196, s[28:31], s16 offen offset:0
  buffer_store_dwordx4 v[84:87], v196, s[28:31], s16 offen offset:16
  buffer_store_dwordx2 v[88:89], v196, s[28:31], s16 offen offset:32
L_ndg0:
  s_mov_b64 exec, -1
  s_endpgm
L_down:
  v_lshl_add_u32 v4, v2, 3, v4
  v_mul_u32_u24 v11, 1280, v3
  v_lshl_add_u32 v11, v2, 3, v11
  v_and_b32 v6, 7, v0
  v_lshlrev_b32 v6, 4, v6
  v_lshl_add_u32 v6, v2, 7, v6
  v_bfe_u32 v7, v0, 3, 1
  v_lshl_add_u32 v6, v7, 9, v6
  s_mul_i32 s55, s45, 5
  s_add_u32 s55, s55, s39
  s_sub_u32 s55, s55, 12
  s_lshl_b32 s55, s55, 5
  s_add_u32 s56, s55, 15728640
  s_mul_i32 s61, s57, 6144
  s_add_u32 s61, s61, 16650240
  s_add_u32 s62, s61, 4096
  s_cmp_lg_u32 s44, 0
  s_cbranch_scc1 L_nohl
  s_mov_b32 exec_lo, 0x00ff00ff
  s_mov_b32 exec_hi, 0x00ff00ff
  buffer_load_dwordx2 v[20:21], v4, s[32:35], s56 offen sc1
  buffer_load_dwordx2 v[22:23], v4, s[32:35], s56 offen offset:1280 sc1
  s_mov_b64 exec, -1
L_nohl:
  v_cmp_gt_u32 vcc, s68, v228
  s_nop 0
  s_and_b64 exec, vcc, s[74:75]
  s_cbranch_scc0 L_ndd
  buffer_store_dwordx4 v[80:83], v196, s[28:31], s16 offen offset:0
  buffer_store_dwordx4 v[84:87], v196, s[28:31], s16 offen offset:16
  buffer_store_dwordx2 v[88:89], v196, s[28:31], s16 offen offset:32
L_ndd:
  s_mov_b64 exec, -1
  v_ashrrev_i32 v10, 31, v12
  v_not_b32 v10, v10
  v_or_b32 v10, 0x80000000, v10
  v_xor_b32 v10, v10, v12
  v_and_b32 v10, 0xffff0000, v10
  v_mul_f32 v10, 0xbfb8aa3b, v10
  v_exp_f32 v10, v10
  s_lshl_b32 s71, s44, 10
  v_add_f32 v10, 1.0, v10
  v_rcp_f32 v10, v10
  s_add_u32 s71, s71, 55296
  v_lshl_add_u32 v5, v0, 4, s71
  v_cvt_pk_bf16_f32 v10, v10, v10
  v_and_b32 v10, 0xffff0000, v10
  s_mov_b32 s71, 1048576
Llw_137:
  ds_read_b32 v108, v104
  s_waitcnt lgkmcnt(0)
  v_cmp_eq_u32 vcc, 0, v108
  s_nop 0
  s_cbranch_vccz Llwok_138
  s_sub_u32 s71, s71, 1
  s_cbranch_scc1 Llwok_138
  s_branch Llw_137
Llwok_138:
  ds_read_b64_tr_b16 v[108:109], v103 offset:0
  ds_read_b64_tr_b16 v[110:111], v103 offset:512
  ds_read_b64_tr_b16 v[112:113], v103 offset:1024
  ds_read_b64_tr_b16 v[114:115], v103 offset:1536
  ds_read_b64_tr_b16 v[116:117], v103 offset:2048
  ds_read_b64_tr_b16 v[118:119], v103 offset:2560
  ds_read_b64_tr_b16 v[120:121], v103 offset:3072
  ds_read_b64_tr_b16 v[122:123], v103 offset:3584
  ds_read_b64_tr_b16 v[124:125], v103 offset:4096
  ds_read_b64_tr_b16 v[126:127], v103 offset:4608
  ds_read_b64_tr_b16 v[128:129], v103 offset:5120
  ds_read_b64_tr_b16 v[130:131], v103 offset:5632
  ds_read_b64_tr_b16 v[132:133], v103 offset:6144
  ds_read_b64_tr_b16 v[134:135], v103 offset:6656
  ds_read_b64_tr_b16 v[136:137], v103 offset:7168
  ds_read_b64_tr_b16 v[138:139], v103 offset:7680
  ds_read_b64_tr_b16 v[140:141], v103 offset:8192
  ds_read_b64_tr_b16 v[142:143], v103 offset:8704
  ds_read_b64_tr_b16 v[144:145], v103 offset:9216
  ds_read_b64_tr_b16 v[146:147], v103 offset:9728
  ds_read_b64_tr_b16 v[148:149], v103 offset:10240
  ds_read_b64_tr_b16 v[150:151], v103 offset:10752
  ds_read_b64_tr_b16 v[152:153], v103 offset:11264
  ds_read_b64_tr_b16 v[154:155], v103 offset:11776
  v_min_u32 v8, 11, v0
  v_lshlrev_b32 v8, 2, v8
  s_lshl_b32 s58, s45, 7
  s_add_u32 s58, s58, 19415040
  s_mov_b32 s71, 262144
Lfp_139:
  buffer_load_dword v7, v8, s[32:35], s58 offen sc1
  s_waitcnt vmcnt(0)
  v_cmp_ne_u32 vcc, s53, v7
  s_nop 0
  s_cbranch_vccz Lfpok_140
  s_sub_u32 s71, s71, 1
  s_cbranch_scc1 Lfpok_140
  s_branch Lfp_139
Lfpok_140:
  s_mov_b32 s71, 262144
Lal_141:
  buffer_load_dwordx4 v[160:163], v6, s[32:35], s61 offen offset:0 sc1
  buffer_load_dwordx4 v[164:167], v6, s[32:35], s61 offen offset:1024 sc1
  buffer_load_dwordx4 v[168:171], v6, s[32:35], s61 offen offset:2048 sc1
  buffer_load_dwordx4 v[172:175], v6, s[32:35], s61 offen offset:3072 sc1
  buffer_load_dwordx4 v[176:179], v6, s[32:35], s62 offen offset:0 sc1
  buffer_load_dwordx4 v[180:183], v6, s[32:35], s62 offen offset:1024 sc1
  s_waitcnt lgkmcnt(0)
  s_waitcnt vmcnt(5)
  v_mfma_f32_16x16x32_bf16 v[24:27], v[108:111], v[160:163], 0
  v_max3_u32 v7, v160, v162, 0
  v_mfma_f32_16x16x32_bf16 v[184:187], v[112:115], v[160:163], 0
  s_waitcnt vmcnt(4)
  v_mfma_f32_16x16x32_bf16 v[24:27], v[116:119], v[164:167], v[24:27]
  v_max3_u32 v7, v164, v166, v7
  v_mfma_f32_16x16x32_bf16 v[184:187], v[120:123], v[164:167], v[184:187]
  s_waitcnt vmcnt(3)
  v_mfma_f32_16x16x32_bf16 v[24:27], v[124:127], v[168:171], v[24:27]
  v_max3_u32 v7, v168, v170, v7
  v_mfma_f32_16x16x32_bf16 v[184:187], v[128:131], v[168:171], v[184:187]
  s_waitcnt vmcnt(2)
  v_mfma_f32_16x16x32_bf16 v[24:27], v[132:135], v[172:175], v[24:27]
  v_max3_u32 v7, v172, v174, v7
  v_mfma_f32_16x16x32_bf16 v[184:187], v[136:139], v[172:175], v[184:187]
  s_waitcnt vmcnt(1)
  v_mfma_f32_16x16x32_bf16 v[24:27], v[140:143], v[176:179], v[24:27]
  v_max3_u32 v7, v176, v178, v7
  v_mfma_f32_16x16x32_bf16 v[184:187], v[144:147], v[176:179], v[184:187]
  s_waitcnt vmcnt(0)
  v_mfma_f32_16x16x32_bf16 v[24:27], v[148:151], v[180:183], v[24:27]
  v_max3_u32 v7, v180, v182, v7
  v_mfma_f32_16x16x32_bf16 v[184:187], v[152:155], v[180:183], v[184:187]
  v_cmp_eq_u32 vcc, -1, v7
  s_nop 0
  s_cbranch_vccz Lalok_142
  s_sub_u32 s71, s71, 1
  s_cbranch_scc1 Lalok_142
  s_branch Lal_141
Lalok_142:
  s_nop 4
  v_add_f32_dpp v24, v184, v24 row_ror:8 row_mask:0xf bank_mask:0xf
  v_add_f32_dpp v25, v185, v25 row_ror:8 row_mask:0xf bank_mask:0xf
  v_add_f32_dpp v26, v186, v26 row_ror:8 row_mask:0xf bank_mask:0xf
  v_add_f32_dpp v27, v187, v27 row_ror:8 row_mask:0xf bank_mask:0xf
  s_cmp_eq_u32 s44, 0
  s_cbranch_scc1 Ldnw0_143
  ds_write_b128 v5, v[24:27]
  s_waitcnt lgkmcnt(0)
  s_barrier
  s_endpgm
Ldnw0_143:
  s_mov_b32 exec_lo, 0x00ff00ff
  s_mov_b32 exec_hi, 0x00ff00ff
  v_max_u32 v7, v20, v22
  v_cmp_eq_u32 vcc, -1, v7
  s_mov_b32 s71, 262144
  s_cbranch_vccnz L_hlw
L_hlr:
  s_mov_b64 exec, -1
  v_lshlrev_b32 v40, 16, v20
  v_and_b32 v41, 0xffff0000, v20
  v_lshlrev_b32 v42, 16, v21
  v_and_b32 v43, 0xffff0000, v21
  v_lshlrev_b32 v44, 16, v22
  v_and_b32 v45, 0xffff0000, v22
  v_lshlrev_b32 v46, 16, v23
  v_and_b32 v47, 0xffff0000, v23
  s_barrier
  ds_read_b128 v[28:31], v5 offset:1024
  ds_read_b128 v[32:35], v5 offset:2048
  ds_read_b128 v[36:39], v5 offset:3072
  s_waitcnt lgkmcnt(2)
  v_pk_add_f32 v[24:25], v[24:25], v[28:29]
  v_pk_add_f32 v[26:27], v[26:27], v[30:31]
  s_waitcnt lgkmcnt(1)
  v_pk_add_f32 v[24:25], v[24:25], v[32:33]
  v_pk_add_f32 v[26:27], v[26:27], v[34:35]
  s_waitcnt lgkmcnt(0)
  v_pk_add_f32 v[24:25], v[24:25], v[36:37]
  v_pk_add_f32 v[26:27], v[26:27], v[38:39]
  v_cvt_pk_bf16_f32 v28, v24, v25
  v_cvt_pk_bf16_f32 v29, v26, v27
  v_lshlrev_b32 v24, 16, v28
  v_and_b32 v25, 0xffff0000, v28
  v_lshlrev_b32 v26, 16, v29
  v_and_b32 v27, 0xffff0000, v29
  v_mul_f32 v24, v10, v24
  v_mul_f32 v25, v10, v25
  v_mul_f32 v26, v10, v26
  v_mul_f32 v27, v10, v27
  v_cvt_pk_bf16_f32 v28, v24, v25
  v_cvt_pk_bf16_f32 v29, v26, v27
  v_lshlrev_b32 v24, 16, v28
  v_and_b32 v25, 0xffff0000, v28
  v_lshlrev_b32 v26, 16, v29
  v_and_b32 v27, 0xffff0000, v29
  v_pk_add_f32 v[24:25], v[24:25], v[40:41]
  v_pk_add_f32 v[26:27], v[26:27], v[42:43]
  v_cvt_pk_bf16_f32 v28, v24, v25
  v_cvt_pk_bf16_f32 v29, v26, v27
  v_lshlrev_b32 v24, 16, v28
  v_and_b32 v25, 0xffff0000, v28
  v_lshlrev_b32 v26, 16, v29
  v_and_b32 v27, 0xffff0000, v29
  v_pk_add_f32 v[24:25], v[24:25], v[44:45]
  v_pk_add_f32 v[26:27], v[26:27], v[46:47]
  v_cvt_pk_bf16_f32 v28, v24, v25
  v_cvt_pk_bf16_f32 v29, v26, v27
  s_mov_b32 exec_lo, 0x00ff00ff
  s_mov_b32 exec_hi, 0x00ff00ff
  buffer_store_dwordx2 v[28:29], v11, s[28:31], s55 offen sc1
  s_endpgm
L_plain:
  s_lshl_b32 s62, s45, 7
  s_add_u32 s62, s62, 19410944
  v_mov_b32 v2, 0
  s_mov_b32 s71, 262144
Lth_144:
  s_sleep 16
  buffer_load_dwordx2 v[4:5], v2, s[32:35], s62 offen sc1
  s_waitcnt vmcnt(0)
  v_cmp_ne_u32 vcc, s53, v5
  s_nop 0
  s_cbranch_vccz Lthok_145
  s_sub_u32 s71, s71, 1
  s_cbranch_scc1 Lthok_145
  s_branch Lth_144
Lthok_145:
  v_readfirstlane_b32 s68, v4
  s_nop 1
  v_cmp_gt_u32 vcc, s68, v228
  s_nop 0
  s_and_b64 exec, vcc, s[74:75]
  s_cbranch_scc0 L_ndp
  buffer_store_dwordx4 v[80:83], v196, s[28:31], s16 offen offset:0
  buffer_store_dwordx4 v[84:87], v196, s[28:31], s16 offen offset:16
  buffer_store_dwordx2 v[88:89], v196, s[28:31], s16 offen offset:32
L_ndp:
  s_mov_b64 exec, -1
  s_endpgm
L_afb0:
  s_cmp_lg_u32 s70, 0
  s_cbranch_scc1 L_afr0
  s_branch L_afb
L_afb1:
  s_cmp_lg_u32 s70, 0
  s_cbranch_scc1 L_afr1
  s_branch L_afb
L_afb:
  s_mov_b32 s70, 1
  s_waitcnt lgkmcnt(0)
  v_mov_b32 v112, 0
  v_mov_b32 v113, 0
  v_mov_b32 v114, 0
  v_mov_b32 v115, 0
  v_mov_b32 v116, 0
  v_mov_b32 v117, 0
  v_mov_b32 v118, 0
  v_mov_b32 v119, 0
  v_mov_b32 v120, 0
  v_mov_b32 v121, 0
  v_mov_b32 v122, 0
  v_mov_b32 v123, 0
  v_mov_b32 v124, 0
  v_mov_b32 v125, 0
  v_mov_b32 v126, 0
  v_mov_b32 v127, 0
  v_mov_b32 v12, 0xff800000
  s_mov_b32 s74, 0
Lfbps_151:
  s_sub_u32 s71, 15, s44
  s_sub_u32 s73, s71, 7
  s_cmp_eq_u32 s23, 0
  s_cselect_b32 s73, s73, 9
  s_mov_b32 s72, 0
Lfb_146:
  s_lshr_b32 s61, s71, 1
  s_mul_i32 s61, s61, 5632
  s_bitcmp1_b32 s71, 0
  s_cselect_b64 vcc, -1, 0
  s_nop 0
  v_cndmask_b32 v13, v248, v216, vcc
  v_cndmask_b32 v14, v249, v217, vcc
  v_cndmask_b32 v15, v250, v218, vcc
  v_add_u32 v13, s61, v13
  v_add_u32 v14, s61, v14
  v_add_u32 v15, s61, v15
  ds_read_b128 v[48:51], v13
  ds_read_b64 v[52:53], v14
  s_mov_b64 exec, s[78:79]
  ds_read_b128 v[54:57], v15
  ds_read_b128 v[58:61], v15 offset:640
  s_mov_b64 exec, -1
  s_waitcnt lgkmcnt(0)
  v_mfma_f32_32x32x16_bf16 v[80:95], v[48:51], v[28:31], 0
  v_mfma_f32_32x32x8_bf16 v[80:95], v[52:53], v[32:33], v[80:95]
  v_mov_b32 v13, 0xff800000
  s_nop 11
  s_cmp_lg_u32 s72, 0
  s_cbranch_scc1 Lfbnd_147
  v_cmp_eq_u32 vcc, 0, v200
  s_nop 1
  v_cndmask_b32 v80, v13, v80, vcc
  v_cmp_eq_u32 vcc, 0, v201
  s_nop 1
  v_cndmask_b32 v81, v13, v81, vcc
  v_cmp_eq_u32 vcc, 0, v202
  s_nop 1
  v_cndmask_b32 v82, v13, v82, vcc
  v_cmp_eq_u32 vcc, 0, v203
  s_nop 1
  v_cndmask_b32 v83, v13, v83, vcc
  v_cmp_eq_u32 vcc, 0, v204
  s_nop 1
  v_cndmask_b32 v84, v13, v84, vcc
  v_cmp_eq_u32 vcc, 0, v205
  s_nop 1
  v_cndmask_b32 v85, v13, v85, vcc
  v_cmp_eq_u32 vcc, 0, v206
  s_nop 1
  v_cndmask_b32 v86, v13, v86, vcc
  v_cmp_eq_u32 vcc, 0, v207
  s_nop 1
  v_cndmask_b32 v87, v13, v87, vcc
  v_cmp_eq_u32 vcc, 0, v208
  s_nop 1
  v_cndmask_b32 v88, v13, v88, vcc
  v_cmp_eq_u32 vcc, 0, v209
  s_nop 1
  v_cndmask_b32 v89, v13, v89, vcc
  v_cmp_eq_u32 vcc, 0, v210
  s_nop 1
  v_cndmask_b32 v90, v13, v90, vcc
  v_cmp_eq_u32 vcc, 0, v211
  s_nop 1
  v_cndmask_b32 v91, v13, v91, vcc
  v_cmp_eq_u32 vcc, 0, v212
  s_nop 1
  v_cndmask_b32 v92, v13, v92, vcc
  v_cmp_eq_u32 vcc, 0, v213
  s_nop 1
  v_cndmask_b32 v93, v13, v93, vcc
  v_cmp_eq_u32 vcc, 0, v214
  s_nop 1
  v_cndmask_b32 v94, v13, v94, vcc
  v_cmp_eq_u32 vcc, 0, v215
  s_nop 1
  v_cndmask_b32 v95, v13, v95, vcc
Lfbnd_147:
  s_cmp_lg_u32 s72, 8
  s_cbranch_scc1 Lfbnf_148
  v_cmp_eq_u32 vcc, 0, v230
  s_nop 1
  v_cndmask_b32 v80, v13, v80, vcc
  v_cmp_eq_u32 vcc, 0, v231
  s_nop 1
  v_cndmask_b32 v81, v13, v81, vcc
  v_cmp_eq_u32 vcc, 0, v232
  s_nop 1
  v_cndmask_b32 v82, v13, v82, vcc
  v_cmp_eq_u32 vcc, 0, v233
  s_nop 1
  v_cndmask_b32 v83, v13, v83, vcc
  v_cmp_eq_u32 vcc, 0, v234
  s_nop 1
  v_cndmask_b32 v84, v13, v84, vcc
  v_cmp_eq_u32 vcc, 0, v235
  s_nop 1
  v_cndmask_b32 v85, v13, v85, vcc
  v_cmp_eq_u32 vcc, 0, v236
  s_nop 1
  v_cndmask_b32 v86, v13, v86, vcc
  v_cmp_eq_u32 vcc, 0, v237
  s_nop 1
  v_cndmask_b32 v87, v13, v87, vcc
  v_cmp_eq_u32 vcc, 0, v238
  s_nop 1
  v_cndmask_b32 v88, v13, v88, vcc
  v_cmp_eq_u32 vcc, 0, v239
  s_nop 1
  v_cndmask_b32 v89, v13, v89, vcc
  v_cmp_eq_u32 vcc, 0, v240
  s_nop 1
  v_cndmask_b32 v90, v13, v90, vcc
  v_cmp_eq_u32 vcc, 0, v241
  s_nop 1
  v_cndmask_b32 v91, v13, v91, vcc
  v_cmp_eq_u32 vcc, 0, v242
  s_nop 1
  v_cndmask_b32 v92, v13, v92, vcc
  v_cmp_eq_u32 vcc, 0, v243
  s_nop 1
  v_cndmask_b32 v93, v13, v93, vcc
  v_cmp_eq_u32 vcc, 0, v244
  s_nop 1
  v_cndmask_b32 v94, v13, v94, vcc
  v_cmp_eq_u32 vcc, 0, v245
  s_nop 1
  v_cndmask_b32 v95, v13, v95, vcc
Lfbnf_148:
  s_cmp_lg_u32 s74, 0
  s_cbranch_scc1 Lfbp2_149
  v_max3_f32 v12, v80, v81, v12
  v_max3_f32 v12, v82, v83, v12
  v_max3_f32 v12, v84, v85, v12
  v_max3_f32 v12, v86, v87, v12
  v_max3_f32 v12, v88, v89, v12
  v_max3_f32 v12, v90, v91, v12
  v_max3_f32 v12, v92, v93, v12
  v_max3_f32 v12, v94, v95, v12
  s_branch Lfbnx_150
Lfbp2_149:
  v_sub_f32 v80, v80, v12
  v_sub_f32 v81, v81, v12
  v_sub_f32 v82, v82, v12
  v_sub_f32 v83, v83, v12
  v_sub_f32 v84, v84, v12
  v_sub_f32 v85, v85, v12
  v_sub_f32 v86, v86, v12
  v_sub_f32 v87, v87, v12
  v_sub_f32 v88, v88, v12
  v_sub_f32 v89, v89, v12
  v_sub_f32 v90, v90, v12
  v_sub_f32 v91, v91, v12
  v_sub_f32 v92, v92, v12
  v_sub_f32 v93, v93, v12
  v_sub_f32 v94, v94, v12
  v_sub_f32 v95, v95, v12
  v_exp_f32 v80, v80
  v_exp_f32 v81, v81
  v_exp_f32 v82, v82
  v_exp_f32 v83, v83
  v_exp_f32 v84, v84
  v_exp_f32 v85, v85
  v_exp_f32 v86, v86
  v_exp_f32 v87, v87
  v_exp_f32 v88, v88
  v_exp_f32 v89, v89
  v_exp_f32 v90, v90
  v_exp_f32 v91, v91
  v_exp_f32 v92, v92
  v_exp_f32 v93, v93
  v_exp_f32 v94, v94
  v_exp_f32 v95, v95
  s_nop 0
  v_cvt_pk_bf16_f32 v40, v80, v81
  v_cvt_pk_bf16_f32 v41, v82, v83
  v_cvt_pk_bf16_f32 v42, v84, v85
  v_cvt_pk_bf16_f32 v43, v86, v87
  v_cvt_pk_bf16_f32 v44, v88, v89
  v_cvt_pk_bf16_f32 v45, v90, v91
  v_cvt_pk_bf16_f32 v46, v92, v93
  v_cvt_pk_bf16_f32 v47, v94, v95
  s_nop 1
  v_mfma_f32_32x32x16_bf16 v[112:127], v[54:57], v[40:43], v[112:127]
  v_mfma_f32_32x32x16_bf16 v[112:127], v[58:61], v[44:47], v[112:127]
  s_nop 11
Lfbnx_150:
  s_sub_u32 s71, s71, 1
  s_add_u32 s72, s72, 1
  s_cmp_lt_u32 s72, s73
  s_cbranch_scc1 Lfb_146
  s_cmp_lg_u32 s74, 0
  s_cbranch_scc1 Lfbdn_152
  v_mov_b32 v13, v12
  s_mov_b32 s74, 1
  s_nop 0
  v_permlane32_swap_b32 v13, v12
  s_nop 1
  v_max_f32 v12, v12, v13
  s_branch Lfbps_151
Lfbdn_152:
  v_mov_b32 v128, 0
  v_mov_b32 v129, 0
  v_mov_b32 v130, 0
  v_mov_b32 v131, 0
  v_mov_b32 v132, 0
  v_mov_b32 v133, 0
  v_mov_b32 v134, 0
  v_mov_b32 v135, 0
  v_mov_b32 v136, 0
  v_mov_b32 v137, 0
  v_mov_b32 v138, 0
  v_mov_b32 v139, 0
  v_mov_b32 v140, 0
  v_mov_b32 v141, 0
  v_mov_b32 v142, 0
  v_mov_b32 v143, 0
  v_mov_b32 v12, 0xff800000
  s_mov_b32 s74, 0
Lfbps_158:
  s_add_u32 s71, 8, s44
  s_sub_u32 s73, s71, 7
  s_cmp_eq_u32 s23, 0
  s_cselect_b32 s73, s73, 9
  s_mov_b32 s72, 0
Lfb_153:
  s_lshr_b32 s61, s71, 1
  s_mul_i32 s61, s61, 5632
  s_bitcmp1_b32 s71, 0
  s_cselect_b64 vcc, -1, 0
  s_nop 0
  v_cndmask_b32 v13, v248, v216, vcc
  v_cndmask_b32 v14, v249, v217, vcc
  v_cndmask_b32 v15, v250, v218, vcc
  v_add_u32 v13, s61, v13
  v_add_u32 v14, s61, v14
  v_add_u32 v15, s61, v15
  ds_read_b128 v[48:51], v13
  ds_read_b64 v[52:53], v14
  s_mov_b64 exec, s[78:79]
  ds_read_b128 v[54:57], v15
  ds_read_b128 v[58:61], v15 offset:640
  s_mov_b64 exec, -1
  s_waitcnt lgkmcnt(0)
  v_mfma_f32_32x32x16_bf16 v[80:95], v[48:51], v[34:37], 0
  v_mfma_f32_32x32x8_bf16 v[80:95], v[52:53], v[38:39], v[80:95]
  v_mov_b32 v13, 0xff800000
  s_nop 11
  s_cmp_lg_u32 s72, 0
  s_cbranch_scc1 Lfbnd_154
  v_cmp_eq_u32 vcc, 0, v200
  s_nop 1
  v_cndmask_b32 v80, v13, v80, vcc
  v_cmp_eq_u32 vcc, 0, v201
  s_nop 1
  v_cndmask_b32 v81, v13, v81, vcc
  v_cmp_eq_u32 vcc, 0, v202
  s_nop 1
  v_cndmask_b32 v82, v13, v82, vcc
  v_cmp_eq_u32 vcc, 0, v203
  s_nop 1
  v_cndmask_b32 v83, v13, v83, vcc
  v_cmp_eq_u32 vcc, 0, v204
  s_nop 1
  v_cndmask_b32 v84, v13, v84, vcc
  v_cmp_eq_u32 vcc, 0, v205
  s_nop 1
  v_cndmask_b32 v85, v13, v85, vcc
  v_cmp_eq_u32 vcc, 0, v206
  s_nop 1
  v_cndmask_b32 v86, v13, v86, vcc
  v_cmp_eq_u32 vcc, 0, v207
  s_nop 1
  v_cndmask_b32 v87, v13, v87, vcc
  v_cmp_eq_u32 vcc, 0, v208
  s_nop 1
  v_cndmask_b32 v88, v13, v88, vcc
  v_cmp_eq_u32 vcc, 0, v209
  s_nop 1
  v_cndmask_b32 v89, v13, v89, vcc
  v_cmp_eq_u32 vcc, 0, v210
  s_nop 1
  v_cndmask_b32 v90, v13, v90, vcc
  v_cmp_eq_u32 vcc, 0, v211
  s_nop 1
  v_cndmask_b32 v91, v13, v91, vcc
  v_cmp_eq_u32 vcc, 0, v212
  s_nop 1
  v_cndmask_b32 v92, v13, v92, vcc
  v_cmp_eq_u32 vcc, 0, v213
  s_nop 1
  v_cndmask_b32 v93, v13, v93, vcc
  v_cmp_eq_u32 vcc, 0, v214
  s_nop 1
  v_cndmask_b32 v94, v13, v94, vcc
  v_cmp_eq_u32 vcc, 0, v215
  s_nop 1
  v_cndmask_b32 v95, v13, v95, vcc
Lfbnd_154:
  s_cmp_lg_u32 s72, 8
  s_cbranch_scc1 Lfbnf_155
  v_cmp_eq_u32 vcc, 0, v230
  s_nop 1
  v_cndmask_b32 v80, v13, v80, vcc
  v_cmp_eq_u32 vcc, 0, v231
  s_nop 1
  v_cndmask_b32 v81, v13, v81, vcc
  v_cmp_eq_u32 vcc, 0, v232
  s_nop 1
  v_cndmask_b32 v82, v13, v82, vcc
  v_cmp_eq_u32 vcc, 0, v233
  s_nop 1
  v_cndmask_b32 v83, v13, v83, vcc
  v_cmp_eq_u32 vcc, 0, v234
  s_nop 1
  v_cndmask_b32 v84, v13, v84, vcc
  v_cmp_eq_u32 vcc, 0, v235
  s_nop 1
  v_cndmask_b32 v85, v13, v85, vcc
  v_cmp_eq_u32 vcc, 0, v236
  s_nop 1
  v_cndmask_b32 v86, v13, v86, vcc
  v_cmp_eq_u32 vcc, 0, v237
  s_nop 1
  v_cndmask_b32 v87, v13, v87, vcc
  v_cmp_eq_u32 vcc, 0, v238
  s_nop 1
  v_cndmask_b32 v88, v13, v88, vcc
  v_cmp_eq_u32 vcc, 0, v239
  s_nop 1
  v_cndmask_b32 v89, v13, v89, vcc
  v_cmp_eq_u32 vcc, 0, v240
  s_nop 1
  v_cndmask_b32 v90, v13, v90, vcc
  v_cmp_eq_u32 vcc, 0, v241
  s_nop 1
  v_cndmask_b32 v91, v13, v91, vcc
  v_cmp_eq_u32 vcc, 0, v242
  s_nop 1
  v_cndmask_b32 v92, v13, v92, vcc
  v_cmp_eq_u32 vcc, 0, v243
  s_nop 1
  v_cndmask_b32 v93, v13, v93, vcc
  v_cmp_eq_u32 vcc, 0, v244
  s_nop 1
  v_cndmask_b32 v94, v13, v94, vcc
  v_cmp_eq_u32 vcc, 0, v245
  s_nop 1
  v_cndmask_b32 v95, v13, v95, vcc
Lfbnf_155:
  s_cmp_lg_u32 s74, 0
  s_cbranch_scc1 Lfbp2_156
  v_max3_f32 v12, v80, v81, v12
  v_max3_f32 v12, v82, v83, v12
  v_max3_f32 v12, v84, v85, v12
  v_max3_f32 v12, v86, v87, v12
  v_max3_f32 v12, v88, v89, v12
  v_max3_f32 v12, v90, v91, v12
  v_max3_f32 v12, v92, v93, v12
  v_max3_f32 v12, v94, v95, v12
  s_branch Lfbnx_157
Lfbp2_156:
  v_sub_f32 v80, v80, v12
  v_sub_f32 v81, v81, v12
  v_sub_f32 v82, v82, v12
  v_sub_f32 v83, v83, v12
  v_sub_f32 v84, v84, v12
  v_sub_f32 v85, v85, v12
  v_sub_f32 v86, v86, v12
  v_sub_f32 v87, v87, v12
  v_sub_f32 v88, v88, v12
  v_sub_f32 v89, v89, v12
  v_sub_f32 v90, v90, v12
  v_sub_f32 v91, v91, v12
  v_sub_f32 v92, v92, v12
  v_sub_f32 v93, v93, v12
  v_sub_f32 v94, v94, v12
  v_sub_f32 v95, v95, v12
  v_exp_f32 v80, v80
  v_exp_f32 v81, v81
  v_exp_f32 v82, v82
  v_exp_f32 v83, v83
  v_exp_f32 v84, v84
  v_exp_f32 v85, v85
  v_exp_f32 v86, v86
  v_exp_f32 v87, v87
  v_exp_f32 v88, v88
  v_exp_f32 v89, v89
  v_exp_f32 v90, v90
  v_exp_f32 v91, v91
  v_exp_f32 v92, v92
  v_exp_f32 v93, v93
  v_exp_f32 v94, v94
  v_exp_f32 v95, v95
  s_nop 0
  v_cvt_pk_bf16_f32 v40, v80, v81
  v_cvt_pk_bf16_f32 v41, v82, v83
  v_cvt_pk_bf16_f32 v42, v84, v85
  v_cvt_pk_bf16_f32 v43, v86, v87
  v_cvt_pk_bf16_f32 v44, v88, v89
  v_cvt_pk_bf16_f32 v45, v90, v91
  v_cvt_pk_bf16_f32 v46, v92, v93
  v_cvt_pk_bf16_f32 v47, v94, v95
  s_nop 1
  v_mfma_f32_32x32x16_bf16 v[128:143], v[54:57], v[40:43], v[128:143]
  v_mfma_f32_32x32x16_bf16 v[128:143], v[58:61], v[44:47], v[128:143]
  s_nop 11
Lfbnx_157:
  s_sub_u32 s71, s71, 1
  s_add_u32 s72, s72, 1
  s_cmp_lt_u32 s72, s73
  s_cbranch_scc1 Lfb_153
  s_cmp_lg_u32 s74, 0
  s_cbranch_scc1 Lfbdn_159
  v_mov_b32 v13, v12
  s_mov_b32 s74, 1
  s_nop 0
  v_permlane32_swap_b32 v13, v12
  s_nop 1
  v_max_f32 v12, v12, v13
  s_branch Lfbps_158
Lfbdn_159:
  s_branch L_afin
L_gS:
  s_lshl_b32 s64, s54, 13
  v_bfe_u32 v10, v0, 1, 3
  v_lshlrev_b32 v10, 4, v10
  v_lshl_add_u32 v10, v0, 7, v10
  v_add_u32 v20, s64, v10
  v_mov_b32 v32, 0x3f803f80
  s_lshl_b32 s64, s45, 2
  s_add_u32 s64, s64, s49
  s_lshl_b32 s64, s64, 14
  s_lshl_b32 s65, s54, 10
  s_add_u32 s64, s64, s65
  s_add_u32 s64, s64, 23597056
  v_lshlrev_b32 v10, 4, v0
  v_xor_b32 v21, 16, v20
  v_xor_b32 v22, 32, v20
  v_xor_b32 v23, 48, v20
  v_xor_b32 v24, 64, v20
  v_xor_b32 v25, 80, v20
  v_xor_b32 v26, 96, v20
  v_xor_b32 v27, 112, v20
  v_mov_b32 v28, 0
  v_mov_b32 v29, 0
  v_mov_b32 v30, 0
  v_mov_b32 v31, 0
  s_barrier
  ds_read_b128 v[64:67], v20 offset:0
  ds_read_b128 v[68:71], v21 offset:0
  ds_read_b128 v[72:75], v22 offset:0
  ds_read_b128 v[76:79], v23 offset:0
  ds_read_b128 v[80:83], v24 offset:0
  ds_read_b128 v[84:87], v25 offset:0
  ds_read_b128 v[88:91], v26 offset:0
  ds_read_b128 v[92:95], v27 offset:0
  s_waitcnt lgkmcnt(7)
  v_dot2_f32_bf16 v28, v64, v32, v28
  v_dot2_f32_bf16 v30, v64, v64, v30
  v_dot2_f32_bf16 v29, v65, v32, v29
  v_dot2_f32_bf16 v31, v65, v65, v31
  v_dot2_f32_bf16 v28, v66, v32, v28
  v_dot2_f32_bf16 v30, v66, v66, v30
  v_dot2_f32_bf16 v29, v67, v32, v29
  v_dot2_f32_bf16 v31, v67, v67, v31
  s_waitcnt lgkmcnt(6)
  v_dot2_f32_bf16 v28, v68, v32, v28
  v_dot2_f32_bf16 v30, v68, v68, v30
  v_dot2_f32_bf16 v29, v69, v32, v29
  v_dot2_f32_bf16 v31, v69, v69, v31
  v_dot2_f32_bf16 v28, v70, v32, v28
  v_dot2_f32_bf16 v30, v70, v70, v30
  v_dot2_f32_bf16 v29, v71, v32, v29
  v_dot2_f32_bf16 v31, v71, v71, v31
  s_waitcnt lgkmcnt(5)
  v_dot2_f32_bf16 v28, v72, v32, v28
  v_dot2_f32_bf16 v30, v72, v72, v30
  v_dot2_f32_bf16 v29, v73, v32, v29
  v_dot2_f32_bf16 v31, v73, v73, v31
  v_dot2_f32_bf16 v28, v74, v32, v28
  v_dot2_f32_bf16 v30, v74, v74, v30
  v_dot2_f32_bf16 v29, v75, v32, v29
  v_dot2_f32_bf16 v31, v75, v75, v31
  s_waitcnt lgkmcnt(4)
  v_dot2_f32_bf16 v28, v76, v32, v28
  v_dot2_f32_bf16 v30, v76, v76, v30
  v_dot2_f32_bf16 v29, v77, v32, v29
  v_dot2_f32_bf16 v31, v77, v77, v31
  v_dot2_f32_bf16 v28, v78, v32, v28
  v_dot2_f32_bf16 v30, v78, v78, v30
  v_dot2_f32_bf16 v29, v79, v32, v29
  v_dot2_f32_bf16 v31, v79, v79, v31
  s_waitcnt lgkmcnt(3)
  v_dot2_f32_bf16 v28, v80, v32, v28
  v_dot2_f32_bf16 v30, v80, v80, v30
  v_dot2_f32_bf16 v29, v81, v32, v29
  v_dot2_f32_bf16 v31, v81, v81, v31
  v_dot2_f32_bf16 v28, v82, v32, v28
  v_dot2_f32_bf16 v30, v82, v82, v30
  v_dot2_f32_bf16 v29, v83, v32, v29
  v_dot2_f32_bf16 v31, v83, v83, v31
  s_waitcnt lgkmcnt(2)
  v_dot2_f32_bf16 v28, v84, v32, v28
  v_dot2_f32_bf16 v30, v84, v84, v30
  v_dot2_f32_bf16 v29, v85, v32, v29
  v_dot2_f32_bf16 v31, v85, v85, v31
  v_dot2_f32_bf16 v28, v86, v32, v28
  v_dot2_f32_bf16 v30, v86, v86, v30
  v_dot2_f32_bf16 v29, v87, v32, v29
  v_dot2_f32_bf16 v31, v87, v87, v31
  s_waitcnt lgkmcnt(1)
  v_dot2_f32_bf16 v28, v88, v32, v28
  v_dot2_f32_bf16 v30, v88, v88, v30
  v_dot2_f32_bf16 v29, v89, v32, v29
  v_dot2_f32_bf16 v31, v89, v89, v31
  v_dot2_f32_bf16 v28, v90, v32, v28
  v_dot2_f32_bf16 v30, v90, v90, v30
  v_dot2_f32_bf16 v29, v91, v32, v29
  v_dot2_f32_bf16 v31, v91, v91, v31
  s_waitcnt lgkmcnt(0)
  v_dot2_f32_bf16 v28, v92, v32, v28
  v_dot2_f32_bf16 v30, v92, v92, v30
  v_dot2_f32_bf16 v29, v93, v32, v29
  v_dot2_f32_bf16 v31, v93, v93, v31
  v_dot2_f32_bf16 v28, v94, v32, v28
  v_dot2_f32_bf16 v30, v94, v94, v30
  v_dot2_f32_bf16 v29, v95, v32, v29
  v_dot2_f32_bf16 v31, v95, v95, v31
  s_waitcnt vmcnt(0)
  s_barrier
  ds_read_b128 v[64:67], v20 offset:32768
  ds_read_b128 v[68:71], v21 offset:32768
  ds_read_b128 v[72:75], v22 offset:32768
  ds_read_b128 v[76:79], v23 offset:32768
  ds_read_b128 v[80:83], v24 offset:32768
  ds_read_b128 v[84:87], v25 offset:32768
  ds_read_b128 v[88:91], v26 offset:32768
  ds_read_b128 v[92:95], v27 offset:32768
  s_waitcnt lgkmcnt(7)
  v_dot2_f32_bf16 v28, v64, v32, v28
  v_dot2_f32_bf16 v30, v64, v64, v30
  v_dot2_f32_bf16 v29, v65, v32, v29
  v_dot2_f32_bf16 v31, v65, v65, v31
  v_dot2_f32_bf16 v28, v66, v32, v28
  v_dot2_f32_bf16 v30, v66, v66, v30
  v_dot2_f32_bf16 v29, v67, v32, v29
  v_dot2_f32_bf16 v31, v67, v67, v31
  s_waitcnt lgkmcnt(6)
  v_dot2_f32_bf16 v28, v68, v32, v28
  v_dot2_f32_bf16 v30, v68, v68, v30
  v_dot2_f32_bf16 v29, v69, v32, v29
  v_dot2_f32_bf16 v31, v69, v69, v31
  v_dot2_f32_bf16 v28, v70, v32, v28
  v_dot2_f32_bf16 v30, v70, v70, v30
  v_dot2_f32_bf16 v29, v71, v32, v29
  v_dot2_f32_bf16 v31, v71, v71, v31
  s_waitcnt lgkmcnt(5)
  v_dot2_f32_bf16 v28, v72, v32, v28
  v_dot2_f32_bf16 v30, v72, v72, v30
  v_dot2_f32_bf16 v29, v73, v32, v29
  v_dot2_f32_bf16 v31, v73, v73, v31
  v_dot2_f32_bf16 v28, v74, v32, v28
  v_dot2_f32_bf16 v30, v74, v74, v30
  v_dot2_f32_bf16 v29, v75, v32, v29
  v_dot2_f32_bf16 v31, v75, v75, v31
  s_waitcnt lgkmcnt(4)
  v_dot2_f32_bf16 v28, v76, v32, v28
  v_dot2_f32_bf16 v30, v76, v76, v30
  v_dot2_f32_bf16 v29, v77, v32, v29
  v_dot2_f32_bf16 v31, v77, v77, v31
  v_dot2_f32_bf16 v28, v78, v32, v28
  v_dot2_f32_bf16 v30, v78, v78, v30
  v_dot2_f32_bf16 v29, v79, v32, v29
  v_dot2_f32_bf16 v31, v79, v79, v31
  s_waitcnt lgkmcnt(3)
  v_dot2_f32_bf16 v28, v80, v32, v28
  v_dot2_f32_bf16 v30, v80, v80, v30
  v_dot2_f32_bf16 v29, v81, v32, v29
  v_dot2_f32_bf16 v31, v81, v81, v31
  v_dot2_f32_bf16 v28, v82, v32, v28
  v_dot2_f32_bf16 v30, v82, v82, v30
  v_dot2_f32_bf16 v29, v83, v32, v29
  v_dot2_f32_bf16 v31, v83, v83, v31
  s_waitcnt lgkmcnt(2)
  v_dot2_f32_bf16 v28, v84, v32, v28
  v_dot2_f32_bf16 v30, v84, v84, v30
  v_dot2_f32_bf16 v29, v85, v32, v29
  v_dot2_f32_bf16 v31, v85, v85, v31
  v_dot2_f32_bf16 v28, v86, v32, v28
  v_dot2_f32_bf16 v30, v86, v86, v30
  v_dot2_f32_bf16 v29, v87, v32, v29
  v_dot2_f32_bf16 v31, v87, v87, v31
  s_waitcnt lgkmcnt(1)
  v_dot2_f32_bf16 v28, v88, v32, v28
  v_dot2_f32_bf16 v30, v88, v88, v30
  v_dot2_f32_bf16 v29, v89, v32, v29
  v_dot2_f32_bf16 v31, v89, v89, v31
  v_dot2_f32_bf16 v28, v90, v32, v28
  v_dot2_f32_bf16 v30, v90, v90, v30
  v_dot2_f32_bf16 v29, v91, v32, v29
  v_dot2_f32_bf16 v31, v91, v91, v31
  s_waitcnt lgkmcnt(0)
  v_dot2_f32_bf16 v28, v92, v32, v28
  v_dot2_f32_bf16 v30, v92, v92, v30
  v_dot2_f32_bf16 v29, v93, v32, v29
  v_dot2_f32_bf16 v31, v93, v93, v31
  v_dot2_f32_bf16 v28, v94, v32, v28
  v_dot2_f32_bf16 v30, v94, v94, v30
  v_dot2_f32_bf16 v29, v95, v32, v29
  v_dot2_f32_bf16 v31, v95, v95, v31
  s_barrier
  v_add_u32 v20, 0x10000, v20
  v_add_u32 v21, 0x10000, v21
  v_add_u32 v22, 0x10000, v22
  v_add_u32 v23, 0x10000, v23
  v_add_u32 v24, 0x10000, v24
  v_add_u32 v25, 0x10000, v25
  v_add_u32 v26, 0x10000, v26
  v_add_u32 v27, 0x10000, v27
  ds_read_b128 v[64:67], v20 offset:0
  ds_read_b128 v[68:71], v21 offset:0
  ds_read_b128 v[72:75], v22 offset:0
  ds_read_b128 v[76:79], v23 offset:0
  ds_read_b128 v[80:83], v24 offset:0
  ds_read_b128 v[84:87], v25 offset:0
  ds_read_b128 v[88:91], v26 offset:0
  ds_read_b128 v[92:95], v27 offset:0
  s_waitcnt lgkmcnt(7)
  v_dot2_f32_bf16 v28, v64, v32, v28
  v_dot2_f32_bf16 v30, v64, v64, v30
  v_dot2_f32_bf16 v29, v65, v32, v29
  v_dot2_f32_bf16 v31, v65, v65, v31
  v_dot2_f32_bf16 v28, v66, v32, v28
  v_dot2_f32_bf16 v30, v66, v66, v30
  v_dot2_f32_bf16 v29, v67, v32, v29
  v_dot2_f32_bf16 v31, v67, v67, v31
  s_waitcnt lgkmcnt(6)
  v_dot2_f32_bf16 v28, v68, v32, v28
  v_dot2_f32_bf16 v30, v68, v68, v30
  v_dot2_f32_bf16 v29, v69, v32, v29
  v_dot2_f32_bf16 v31, v69, v69, v31
  v_dot2_f32_bf16 v28, v70, v32, v28
  v_dot2_f32_bf16 v30, v70, v70, v30
  v_dot2_f32_bf16 v29, v71, v32, v29
  v_dot2_f32_bf16 v31, v71, v71, v31
  s_waitcnt lgkmcnt(5)
  v_dot2_f32_bf16 v28, v72, v32, v28
  v_dot2_f32_bf16 v30, v72, v72, v30
  v_dot2_f32_bf16 v29, v73, v32, v29
  v_dot2_f32_bf16 v31, v73, v73, v31
  v_dot2_f32_bf16 v28, v74, v32, v28
  v_dot2_f32_bf16 v30, v74, v74, v30
  v_dot2_f32_bf16 v29, v75, v32, v29
  v_dot2_f32_bf16 v31, v75, v75, v31
  s_waitcnt lgkmcnt(4)
  v_dot2_f32_bf16 v28, v76, v32, v28
  v_dot2_f32_bf16 v30, v76, v76, v30
  v_dot2_f32_bf16 v29, v77, v32, v29
  v_dot2_f32_bf16 v31, v77, v77, v31
  v_dot2_f32_bf16 v28, v78, v32, v28
  v_dot2_f32_bf16 v30, v78, v78, v30
  v_dot2_f32_bf16 v29, v79, v32, v29
  v_dot2_f32_bf16 v31, v79, v79, v31
  s_waitcnt lgkmcnt(3)
  v_dot2_f32_bf16 v28, v80, v32, v28
  v_dot2_f32_bf16 v30, v80, v80, v30
  v_dot2_f32_bf16 v29, v81, v32, v29
  v_dot2_f32_bf16 v31, v81, v81, v31
  v_dot2_f32_bf16 v28, v82, v32, v28
  v_dot2_f32_bf16 v30, v82, v82, v30
  v_dot2_f32_bf16 v29, v83, v32, v29
  v_dot2_f32_bf16 v31, v83, v83, v31
  s_waitcnt lgkmcnt(2)
  v_dot2_f32_bf16 v28, v84, v32, v28
  v_dot2_f32_bf16 v30, v84, v84, v30
  v_dot2_f32_bf16 v29, v85, v32, v29
  v_dot2_f32_bf16 v31, v85, v85, v31
  v_dot2_f32_bf16 v28, v86, v32, v28
  v_dot2_f32_bf16 v30, v86, v86, v30
  v_dot2_f32_bf16 v29, v87, v32, v29
  v_dot2_f32_bf16 v31, v87, v87, v31
  s_waitcnt lgkmcnt(1)
  v_dot2_f32_bf16 v28, v88, v32, v28
  v_dot2_f32_bf16 v30, v88, v88, v30
  v_dot2_f32_bf16 v29, v89, v32, v29
  v_dot2_f32_bf16 v31, v89, v89, v31
  v_dot2_f32_bf16 v28, v90, v32, v28
  v_dot2_f32_bf16 v30, v90, v90, v30
  v_dot2_f32_bf16 v29, v91, v32, v29
  v_dot2_f32_bf16 v31, v91, v91, v31
  s_waitcnt lgkmcnt(0)
  v_dot2_f32_bf16 v28, v92, v32, v28
  v_dot2_f32_bf16 v30, v92, v92, v30
  v_dot2_f32_bf16 v29, v93, v32, v29
  v_dot2_f32_bf16 v31, v93, v93, v31
  v_dot2_f32_bf16 v28, v94, v32, v28
  v_dot2_f32_bf16 v30, v94, v94, v30
  v_dot2_f32_bf16 v29, v95, v32, v29
  v_dot2_f32_bf16 v31, v95, v95, v31
  s_nop 1
  v_add_f32 v28, v28, v29
  v_add_f32 v29, v30, v31
  v_mov_b32 v30, s53
  buffer_store_dwordx4 v[28:31], v10, s[32:35], s64 offen sc1
  s_barrier
  s_barrier
  s_barrier
  s_barrier
  s_barrier
  s_barrier
  s_barrier
  s_barrier
  s_barrier
  v_mov_b32 v10, 159744
  ds_read_b32 v11, v10
  s_waitcnt lgkmcnt(0)
  v_readfirstlane_b32 s51, v11
  s_branch L_att
Lstrt_5:
  s_sub_u32 s62, s62, 1
  s_cbranch_scc1 Lstok_4
  s_sleep 1
  s_add_u32 s38, s37, 0
  buffer_load_dwordx4 v[64:67], v48, s[32:35], s38 offen sc1
  s_add_u32 s38, s37, 4096
  buffer_load_dwordx4 v[68:71], v48, s[32:35], s38 offen sc1
  s_add_u32 s38, s37, 8192
  buffer_load_dwordx4 v[72:75], v48, s[32:35], s38 offen sc1
  s_add_u32 s38, s37, 12288
  buffer_load_dwordx4 v[76:79], v48, s[32:35], s38 offen sc1
  s_waitcnt vmcnt(0)
  s_branch Lstl_3
Lstrt_24:
  s_sub_u32 s62, s62, 1
  s_cbranch_scc1 Lstok_23
  s_sleep 1
  s_add_u32 s38, s37, 0
  buffer_load_dwordx4 v[64:67], v48, s[32:35], s38 offen sc1
  s_add_u32 s38, s37, 4096
  buffer_load_dwordx4 v[68:71], v48, s[32:35], s38 offen sc1
  s_add_u32 s38, s37, 8192
  buffer_load_dwordx4 v[72:75], v48, s[32:35], s38 offen sc1
  s_add_u32 s38, s37, 12288
  buffer_load_dwordx4 v[76:79], v48, s[32:35], s38 offen sc1
  s_waitcnt vmcnt(0)
  s_branch Lstl_22
Lhello_56:
  s_getreg_b32 s65, hwreg(HW_REG_XCC_ID, 0, 4)
  s_or_b32 s65, s65, s53
  v_mov_b32 v2, s65
  s_lshl_b32 s65, s2, 2
  s_add_u32 s65, s65, 19398656
  v_mov_b32 v3, 0
  s_mov_b64 exec, 1
  buffer_store_dword v2, v3, s[32:35], s65 offen sc1
  s_mov_b64 exec, -1
  s_branch Lhellor_57
Lcw_58:
  s_waitcnt vmcnt(0)
  s_branch Lcwr_59
Lqslow_60:
  buffer_store_dwordx4 v[64:67], v174, s[32:35], s58 offen sc1
  buffer_store_dwordx4 v[68:71], v175, s[32:35], s58 offen sc1
  buffer_store_dwordx4 v[80:83], v176, s[32:35], s58 offen sc1
  buffer_store_dwordx4 v[84:87], v177, s[32:35], s58 offen sc1
  buffer_store_dwordx4 v[96:99], v174, s[32:35], s61 offen sc1
  buffer_store_dwordx4 v[100:103], v175, s[32:35], s61 offen sc1
  buffer_store_dwordx4 v[112:115], v176, s[32:35], s61 offen sc1
  buffer_store_dwordx4 v[116:119], v177, s[32:35], s61 offen sc1
  s_branch Lqjn_61
Lhello_69:
  s_getreg_b32 s65, hwreg(HW_REG_XCC_ID, 0, 4)
  s_or_b32 s65, s65, s53
  v_mov_b32 v2, s65
  s_lshl_b32 s65, s2, 2
  s_add_u32 s65, s65, 19398656
  v_mov_b32 v3, 0
  s_mov_b64 exec, 1
  buffer_store_dword v2, v3, s[32:35], s65 offen sc1
  s_mov_b64 exec, -1
  s_branch Lhellor_70
Lcw_71:
  s_waitcnt vmcnt(0)
  s_branch Lcwr_72
Lqslow_73:
  buffer_store_dwordx4 v[64:67], v174, s[32:35], s58 offen sc1
  buffer_store_dwordx4 v[68:71], v175, s[32:35], s58 offen sc1
  buffer_store_dwordx4 v[80:83], v176, s[32:35], s58 offen sc1
  buffer_store_dwordx4 v[84:87], v177, s[32:35], s58 offen sc1
  buffer_store_dwordx4 v[96:99], v174, s[32:35], s61 offen sc1
  buffer_store_dwordx4 v[100:103], v175, s[32:35], s61 offen sc1
  buffer_store_dwordx4 v[112:115], v176, s[32:35], s61 offen sc1
  buffer_store_dwordx4 v[116:119], v177, s[32:35], s61 offen sc1
  s_branch Lqjn_74
L_plsl:
  s_lshr_b32 s61, s55, 1
  s_lshl_b32 s61, s61, 12
  s_lshl_b32 s62, s48, 11
  s_add_u32 s61, s61, 24117248
  s_add_u32 s70, s61, s62
  s_xor_b32 s72, s70, 2048
  v_mov_b32 v3, s53
  s_mov_b64 exec, 3
  s_waitcnt vmcnt(0)
  buffer_store_dword v3, v226, s[32:35], 0 offen sc1
  s_mov_b64 exec, -1
  s_mov_b32 s71, 262144
Lfp_101:
  buffer_load_dword v6, v227, s[32:35], s70 offen sc1
  s_waitcnt vmcnt(0)
  v_cmp_ne_u32 vcc, s53, v6
  s_nop 0
  s_cbranch_vccz Lfpok_102
  s_sub_u32 s71, s71, 1
  s_cbranch_scc1 Lfpok_102
  s_branch Lfp_101
Lfpok_102:
  s_mov_b32 s71, 262144
Lfp_103:
  buffer_load_dword v6, v227, s[32:35], s72 offen sc1
  s_waitcnt vmcnt(0)
  v_cmp_ne_u32 vcc, s53, v6
  s_nop 0
  s_cbranch_vccz Lfpok_104
  s_sub_u32 s71, s71, 1
  s_cbranch_scc1 Lfpok_104
  s_branch Lfp_103
Lfpok_104:
  s_branch L_plr
L_pssc:
  buffer_store_dwordx4 v[4:7], v197, s[32:35], s61 offen sc1
  s_branch L_psr
L_exit:
  s_endpgm
.section .rodata,"a"
.p2align 6
.amdhsa_kernel sequential_preLN__sliding_block__moe_arch_mod__prompt_kernel
  .amdhsa_next_free_vgpr 256
  .amdhsa_next_free_sgpr 102
  .amdhsa_accum_offset 256
  .amdhsa_group_segment_fixed_size 0
  .amdhsa_kernarg_size 88
  .amdhsa_user_sgpr_count 2
  .amdhsa_user_sgpr_kernarg_segment_ptr 1
  .amdhsa_system_sgpr_workgroup_id_x 1
.end_amdhsa_kernel
```
